```python
import torch

def _softmax(x, axis=-1):
    return torch.softmax(x, dim=axis)
def _gelu(x):
    return torch.nn.functional.gelu(x, approximate="tanh")
def _silu(x):
    return torch.nn.functional.silu(x)
def _sigmoid(x):
    return torch.sigmoid(x)
def _layernorm(x, axis=-1, eps=1e-5):
    m = x.mean(dim=axis, keepdim=True)
    v = x.var(dim=axis, keepdim=True, unbiased=False)
    return (x - m) / torch.sqrt(v + eps)
def _scatter_add(tgt, idx, src, axis=0):
    return tgt.clone().index_add_(axis, idx, src)
def _segment_sum(src, seg, n):
    out = torch.zeros((n,) + src.shape[1:], dtype=src.dtype)
    return out.index_add_(0, seg, src)
def _pad(x, pw):
    flat = tuple(v for pair in reversed(pw) for v in pair)
    return torch.nn.functional.pad(x, flat)

kernel_name = 'parallel_sum__ssm_conv_h3__mixer_channel_mlp__prompt'

def setup_inputs():

    _w = (lambda a: (lambda t: t.to(torch.bfloat16) if t.is_floating_point() else t)(torch.as_tensor(a)))
    def _A_setup():
        B, S, D = 1, 2048, 1024
        ks = 4
        return {
            "q": _w((lambda *s: torch.randn(*s, dtype=torch.bfloat16) * 0.05)(B, S, D)),
            "k": _w((lambda *s: torch.randn(*s, dtype=torch.bfloat16) * 0.2)(B, S, D)),
            "v": _w((lambda *s: torch.randn(*s, dtype=torch.bfloat16) * 0.2)(B, S, D)),
            "shift_k": _w((lambda *s: torch.randn(*s, dtype=torch.bfloat16) * 0.2)(D, ks) * 0.5),
            "ssm_k": _w((lambda *s: torch.randn(*s, dtype=torch.bfloat16) * 0.8)(D, S) * (1.0 / S ** 0.5)),
            "ssm_D": _w((lambda *s: torch.randn(*s, dtype=torch.bfloat16) * 0.2)(D)),
        }
    _A_in = _A_setup()

    def _B_setup():
        B, S, D, F = 1, 2048, 1024, 3584
        return {
            "x": _w((lambda *s: torch.randn(*s, dtype=torch.bfloat16) * 0.05)(B, S, D)),
            "w1": _w((lambda *s: torch.randn(*s, dtype=torch.bfloat16) * 0.8)(D, F) * (D ** -0.5)),
            "b1": _w((lambda *s: torch.randn(*s, dtype=torch.bfloat16) * 0.4)(F)),
            "w2": _w((lambda *s: torch.randn(*s, dtype=torch.bfloat16) * 0.05)(F, D) * (F ** -0.5)),
            "b2": _w((lambda *s: torch.randn(*s, dtype=torch.bfloat16) * 0.05)(D)),
        }
    _B_in = _B_setup()

    return {
        "A_q": _A_in["q"],
        "A_k": _A_in["k"],
        "A_v": _A_in["v"],
        "A_shift_k": _A_in["shift_k"],
        "A_ssm_k": _A_in["ssm_k"],
        "A_ssm_D": _A_in["ssm_D"],
        "B_x": _B_in["x"],
        "B_w1": _B_in["w1"],
        "B_b1": _B_in["b1"],
        "B_w2": _B_in["w2"],
        "B_b2": _B_in["b2"],
    }

def reference(A_q, A_k, A_v, A_shift_k, A_ssm_k, A_ssm_D, B_x, B_w1, B_b1, B_w2, B_b2):
    def _A_ref(q, k, v, shift_k, ssm_k, ssm_D):
        B, S, D = q.shape
        ks = shift_k.shape[-1]
        k_pad = _pad(k, ((0, 0), (ks - 1, 0), (0, 0)))
        k_shift = torch.zeros_like(k)
        for t in range(ks):
            k_shift = k_shift + k_pad[:, t:t + S, :] * shift_k[:, ks - 1 - t][None, None, :]
        kv = k_shift * v
        L = 2 * S
        kv_pad = _pad(kv, ((0, 0), (0, S), (0, 0)))
        kf_pad = _pad(ssm_k, ((0, 0), (0, S)))
        kv_f = (lambda x, axes=(-2,-1): torch.fft.rfft2(x.float(), dim=axes))(kv_pad[:, None, :, :], axes=(1, 2))
        kf_f = (lambda x, axes=(-2,-1): torch.fft.rfft2(x.float(), dim=axes))(kf_pad[:, None, :], axes=(1, 2))
        kf_f = (lambda x, *d: x.permute(*d))(kf_f, 1, 2, 0)
        y_f = kv_f * kf_f[None, :, :, :]
        y = (lambda x, s, axes=(-2,-1): torch.fft.irfft2(x, s=s, dim=axes).to(torch.bfloat16))(y_f, (1, L), axes=(1, 2))[:, 0, :S, :]
        y = y + kv * ssm_D[None, None, :]
        return q * y

    def _B_ref(x, w1, b1, w2, b2):
        y = _layernorm(x, axis=-1)
        h = _gelu(torch.einsum("bsd,df->bsf", y, w1) + b1)
        return torch.einsum("bsf,fd->bsd", h, w2) + b2

    x = A_q
    xn = _layernorm(x, axis=-1)
    return x + _A_ref(xn, A_k, A_v, A_shift_k, A_ssm_k, A_ssm_D) + _B_ref(xn, B_w1, B_b1, B_w2, B_b2)
```

```asm
; @launch grid=(256,1,1) block=(256,1,1) lds=163840
.amdgcn_target "amdgcn-amd-amdhsa--gfx950"
.text
.globl parallel_sum__ssm_conv_h3__mixer_channel_mlp__prompt_kernel
.p2align 8
.type parallel_sum__ssm_conv_h3__mixer_channel_mlp__prompt_kernel,@function
parallel_sum__ssm_conv_h3__mixer_channel_mlp__prompt_kernel:

    s_cmp_ge_u32 s2, 256
    s_cbranch_scc1 L_end
    s_load_dwordx16 s[76:91], s[0:1], 0
    s_load_dwordx8 s[92:99], s[0:1], 64
    s_load_dwordx4 s[60:63], s[0:1], 96
    s_getpc_b64 s[58:59]
L_pc:
    s_lshr_b32 s57, s2, 3
    v_lshrrev_b32 v4, 6, v0
    v_lshlrev_b32 v4, 2, v4
    v_and_b32 v5, 3, v0
    v_add_u32 v4, v4, v5
    s_lshl_b32 s57, s57, 4
    v_add_u32 v4, s57, v4
    v_lshlrev_b32 v4, 7, v4
    v_min_u32 v4, (L_end-L_pc), v4
    v_mov_b32 v7, s59
    v_add_co_u32 v6, vcc, s58, v4
    v_and_b32 v4, 63, v0
    s_nop 0
    v_addc_co_u32 v7, vcc, 0, v7, vcc
    v_cmp_gt_u32 vcc, 4, v4
    s_and_saveexec_b64 s[56:57], vcc
    global_load_dword v127, v[6:7], off
    s_mov_b64 exec, s[56:57]
    v_and_b32 v1, 63, v0
    v_lshrrev_b32 v240, 6, v0
    s_and_b32 s4, s2, 7
    v_readfirstlane_b32 s66, v240
    s_lshr_b32 s5, s2, 3
    s_and_b32 s64, s4, 1
    s_lshl_b32 s64, s64, 3
    s_and_b32 s6, s5, 7
    s_add_u32 s64, s64, s6
    s_lshr_b32 s65, s4, 1
    s_lshl_b32 s65, s65, 2
    s_lshr_b32 s6, s5, 3
    s_add_u32 s65, s65, s6
    s_lshr_b32 s67, s66, 1
    s_and_b32 s68, s66, 1
    s_lshl_b32 s75, s65, 6
    s_lshl_b32 s4, s64, 2
    s_add_u32 s75, s75, s4
    s_add_u32 s75, s75, s66
    s_lshr_b32 s100, s65, 3
    s_and_b32 s101, s65, 7
    s_xor_b32 s101, s101, 0
    v_mov_b32 v124, 0
    s_and_b32 s4, s65, 3
    s_mul_i32 s4, s4, 1
    s_and_b32 s5, s64, 7
    s_lshr_b32 s5, s5, 1
    s_add_u32 s4, s4, s5
    s_lshr_b32 s5, s64, 3
    s_mul_i32 s5, s5, 8
    s_add_u32 s4, s4, s5
    s_and_b32 s71, s4, 15
    s_and_b32 s74, s64, 1
    s_lshl_b32 s74, s74, 2
    s_lshl_b32 s69, s71, 7
    s_mul_i32 s70, s71, 458752
    s_lshl_b32 s73, s66, 12
    s_mul_i32 s56, s66, 7168
    s_add_u32 s56, s56, 16384
    v_lshrrev_b32 v240, 3, v1
    v_and_b32 v241, 7, v1
    v_xor_b32 v241, v241, v240
    v_lshlrev_b32 v241, 4, v241
    s_lshl_b32 s4, s64, 7
    s_lshl_b32 s5, s66, 5
    s_add_u32 s4, s4, s5
    v_add_u32 v240, s4, v240
    v_lshl_add_u32 v2, v240, 11, v241
    v_add_u32 v3, 15360, v2
    v_add_u32 v4, 30720, v2
    v_add_u32 v5, 46080, v2
    s_mul_i32 s4, s66, 114688
    s_mul_i32 s5, s65, 448
    s_add_u32 s4, s4, s5
    v_add_u32 v240, 0, v1
    v_mul_u32_u24 v241, 2341, v240
    v_lshrrev_b32 v241, 16, v241
    v_mul_u32_u24 v242, 28, v241
    v_sub_u32 v242, v240, v242
    v_lshrrev_b32 v243, 2, v241
    v_and_b32 v243, 2, v243
    v_xor_b32 v242, v242, v243
    v_mul_u32_u24 v241, 7168, v241
    v_lshl_add_u32 v241, v242, 4, v241
    v_add_u32 v241, s4, v241
    v_subrev_u32 v6, 0, v241
    v_add_u32 v240, 64, v1
    v_mul_u32_u24 v241, 2341, v240
    v_lshrrev_b32 v241, 16, v241
    v_mul_u32_u24 v242, 28, v241
    v_sub_u32 v242, v240, v242
    v_lshrrev_b32 v243, 2, v241
    v_and_b32 v243, 2, v243
    v_xor_b32 v242, v242, v243
    v_mul_u32_u24 v241, 7168, v241
    v_lshl_add_u32 v241, v242, 4, v241
    v_add_u32 v241, s4, v241
    v_subrev_u32 v7, 1024, v241
    v_add_u32 v240, 128, v1
    v_mul_u32_u24 v241, 2341, v240
    v_lshrrev_b32 v241, 16, v241
    v_mul_u32_u24 v242, 28, v241
    v_sub_u32 v242, v240, v242
    v_lshrrev_b32 v243, 2, v241
    v_and_b32 v243, 2, v243
    v_xor_b32 v242, v242, v243
    v_mul_u32_u24 v241, 7168, v241
    v_lshl_add_u32 v241, v242, 4, v241
    v_add_u32 v241, s4, v241
    v_subrev_u32 v8, 2048, v241
    v_add_u32 v240, 192, v1
    v_mul_u32_u24 v241, 2341, v240
    v_lshrrev_b32 v241, 16, v241
    v_mul_u32_u24 v242, 28, v241
    v_sub_u32 v242, v240, v242
    v_lshrrev_b32 v243, 2, v241
    v_and_b32 v243, 2, v243
    v_xor_b32 v242, v242, v243
    v_mul_u32_u24 v241, 7168, v241
    v_lshl_add_u32 v241, v242, 4, v241
    v_add_u32 v241, s4, v241
    v_subrev_u32 v9, 3072, v241
    v_add_u32 v240, 256, v1
    v_mul_u32_u24 v241, 2341, v240
    v_lshrrev_b32 v241, 16, v241
    v_mul_u32_u24 v242, 28, v241
    v_sub_u32 v242, v240, v242
    v_lshrrev_b32 v243, 2, v241
    v_and_b32 v243, 2, v243
    v_xor_b32 v242, v242, v243
    v_mul_u32_u24 v241, 7168, v241
    v_lshl_add_u32 v241, v242, 4, v241
    v_add_u32 v241, s4, v241
    v_subrev_u32 v10, 0, v241
    v_add_u32 v240, 320, v1
    v_mul_u32_u24 v241, 2341, v240
    v_lshrrev_b32 v241, 16, v241
    v_mul_u32_u24 v242, 28, v241
    v_sub_u32 v242, v240, v242
    v_lshrrev_b32 v243, 2, v241
    v_and_b32 v243, 2, v243
    v_xor_b32 v242, v242, v243
    v_mul_u32_u24 v241, 7168, v241
    v_lshl_add_u32 v241, v242, 4, v241
    v_add_u32 v241, s4, v241
    v_subrev_u32 v11, 1024, v241
    v_add_u32 v240, 384, v1
    v_mul_u32_u24 v241, 2341, v240
    v_lshrrev_b32 v241, 16, v241
    v_mul_u32_u24 v242, 28, v241
    v_sub_u32 v242, v240, v242
    v_lshrrev_b32 v243, 2, v241
    v_and_b32 v243, 2, v243
    v_xor_b32 v242, v242, v243
    v_mul_u32_u24 v241, 7168, v241
    v_lshl_add_u32 v241, v242, 4, v241
    v_add_u32 v241, s4, v241
    v_subrev_u32 v12, 2048, v241
    s_mov_b32 s6, 0x400000
    s_mov_b32 s7, 0x20000
    s_mov_b32 s10, 0x700000
    s_mov_b32 s11, 0x20000
    s_mov_b32 s14, 0x10000000
    s_mov_b32 s15, 0x20000
    s_mov_b32 s18, 0x400000
    s_mov_b32 s19, 0x20000
    s_mov_b32 s22, 0x400000
    s_mov_b32 s23, 0x20000
    s_mov_b32 s26, 0x2000
    s_mov_b32 s27, 0x20000
    s_mov_b32 s30, 0x400000
    s_mov_b32 s31, 0x20000
    s_mov_b32 s34, 0x800
    s_mov_b32 s35, 0x20000
    s_mov_b32 s38, 0x1c00
    s_mov_b32 s39, 0x20000
    s_mov_b32 s42, 0x700000
    s_mov_b32 s43, 0x20000
    s_mov_b32 s46, 0x800
    s_mov_b32 s47, 0x20000
    s_mov_b32 s50, 0x400000
    s_mov_b32 s51, 0x20000
    s_mov_b32 s54, 0x100
    s_mov_b32 s55, 0x20000
    s_waitcnt lgkmcnt(0)
    s_mov_b32 s4, s76
    s_mov_b32 s5, s77
    s_mov_b32 s8, s90
    s_mov_b32 s9, s91
    s_add_u32 m0, s73, 0
    s_nop 0
    buffer_load_dwordx4 v2, s[4:7], s69 offen offset:0  lds
    buffer_load_dwordx4 v3, s[4:7], s69 offen offset:1024  lds
    buffer_load_dwordx4 v4, s[4:7], s69 offen offset:2048  lds
    buffer_load_dwordx4 v5, s[4:7], s69 offen offset:3072  lds
    s_add_u32 m0, s56, 0
    s_nop 0
    buffer_load_dwordx4 v6, s[8:11], s70 offen offset:0  lds
    buffer_load_dwordx4 v7, s[8:11], s70 offen offset:1024  lds
    buffer_load_dwordx4 v8, s[8:11], s70 offen offset:2048  lds
    buffer_load_dwordx4 v9, s[8:11], s70 offen offset:3072  lds
    s_add_u32 m0, s56, 4096
    s_nop 0
    buffer_load_dwordx4 v10, s[8:11], s70 offen offset:0  lds
    buffer_load_dwordx4 v11, s[8:11], s70 offen offset:1024  lds
    buffer_load_dwordx4 v12, s[8:11], s70 offen offset:2048  lds
    s_add_u32 s71, s71, 1
    s_and_b32 s71, s71, 15
    s_lshl_b32 s69, s71, 7
    s_mul_i32 s70, s71, 458752
    s_add_u32 m0, s73, 45056
    s_nop 0
    buffer_load_dwordx4 v2, s[4:7], s69 offen offset:0  lds
    buffer_load_dwordx4 v3, s[4:7], s69 offen offset:1024  lds
    buffer_load_dwordx4 v4, s[4:7], s69 offen offset:2048  lds
    buffer_load_dwordx4 v5, s[4:7], s69 offen offset:3072  lds
    s_add_u32 m0, s56, 45056
    s_nop 0
    buffer_load_dwordx4 v6, s[8:11], s70 offen offset:0  lds
    buffer_load_dwordx4 v7, s[8:11], s70 offen offset:1024  lds
    buffer_load_dwordx4 v8, s[8:11], s70 offen offset:2048  lds
    buffer_load_dwordx4 v9, s[8:11], s70 offen offset:3072  lds
    s_add_u32 m0, s56, 49152
    s_nop 0
    buffer_load_dwordx4 v10, s[8:11], s70 offen offset:0  lds
    buffer_load_dwordx4 v11, s[8:11], s70 offen offset:1024  lds
    buffer_load_dwordx4 v12, s[8:11], s70 offen offset:2048  lds
    s_add_u32 s71, s71, 1
    s_and_b32 s71, s71, 15
    s_lshl_b32 s69, s71, 7
    s_mul_i32 s70, s71, 458752
    s_mov_b32 s12, s62
    s_mov_b32 s13, s63
    s_mov_b32 s16, s78
    s_mov_b32 s17, s79
    s_mov_b32 s20, s80
    s_mov_b32 s21, s81
    s_mov_b32 s24, s82
    s_mov_b32 s25, s83
    s_mov_b32 s28, s84
    s_mov_b32 s29, s85
    s_mov_b32 s32, s86
    s_mov_b32 s33, s87
    s_mov_b32 s36, s92
    s_mov_b32 s37, s93
    s_mov_b32 s40, s94
    s_mov_b32 s41, s95
    s_mov_b32 s44, s96
    s_mov_b32 s45, s97
    s_mov_b32 s48, s98
    s_mov_b32 s49, s99
    s_mov_b32 s52, s60
    s_mov_b32 s53, s61
    s_or_b32 s76, s2, s66
    s_cmp_lg_u32 s76, 0
    s_cbranch_scc1 L_nononce
    s_memrealtime s[78:79]
    s_waitcnt lgkmcnt(0)
    s_or_b32 s78, s78, 1
    v_mov_b32 v240, s78
    v_mov_b32 v241, s79
    s_mov_b64 exec, 1
    buffer_store_dwordx2 v[240:241], v124, s[52:55], 0 offen sc1
    s_mov_b64 exec, -1
L_nononce:
    v_and_b32 v240, 15, v1
    v_lshrrev_b32 v241, 4, v1
    v_and_b32 v242, 7, v240
    v_xor_b32 v242, v242, v241
    s_lshl_b32 s76, s67, 6
    v_add_u32 v240, s76, v240
    v_lshlrev_b32 v240, 7, v240
    v_lshlrev_b32 v243, 4, v242
    v_add_u32 v17, v240, v243
    v_xor_b32 v243, 64, v243
    v_add_u32 v18, v240, v243
    v_lshrrev_b32 v242, 2, v1
    v_and_b32 v242, 3, v242
    v_lshl_add_u32 v242, v241, 3, v242
    v_mul_u32_u24 v242, 448, v242
    v_and_b32 v243, 3, v1
    v_lshl_add_u32 v242, v243, 3, v242
    v_and_b32 v241, 1, v241
    v_lshlrev_b32 v241, 5, v241
    v_add_u32 v243, v242, v241
    v_sub_u32 v244, v242, v241
    s_lshl_b32 s76, s68, 8
    s_add_u32 s76, s76, 16384
    v_add_u32 v19, s76, v243
    v_add_u32 v20, s76, v244
    s_cmp_eq_u32 s68, 0
    s_cselect_b64 vcc, -1, 0
    s_mul_i32 s76, s68, 32
    s_add_u32 s76, s76, 16576
    v_cndmask_b32 v21, v244, v243, vcc
    v_add_u32 v21, s76, v21
    v_add_u32 v22, 45056, v17
    v_add_u32 v23, 45056, v18
    v_add_u32 v24, 45056, v19
    v_add_u32 v25, 45056, v20
    v_add_u32 v26, 45056, v21
    v_add_u32 v27, 90112, v17
    v_add_u32 v28, 90112, v18
    v_add_u32 v29, 90112, v19
    v_add_u32 v30, 90112, v20
    v_add_u32 v31, 90112, v21
    v_mov_b32 v120, 0x3f803f80
    v_mov_b32 v121, 0x3f803f80
    v_mov_b32 v122, 0x3f803f80
    v_mov_b32 v123, 0x3f803f80
    s_waitcnt vmcnt(11)
    s_barrier
    ds_read_b128 v[88:91], v17 offset:0
    ds_read_b64_tr_b16 v[32:33], v19 offset:0
    ds_read_b64_tr_b16 v[34:35], v19 offset:1792
    ds_read_b128 v[92:95], v17 offset:2048
    ds_read_b128 v[96:99], v17 offset:4096
    ds_read_b128 v[100:103], v17 offset:6144
    ds_read_b64_tr_b16 v[36:37], v20 offset:32
    ds_read_b64_tr_b16 v[38:39], v20 offset:1824
    ds_read_b64_tr_b16 v[40:41], v19 offset:64
    ds_read_b64_tr_b16 v[42:43], v19 offset:1856
    ds_read_b64_tr_b16 v[44:45], v20 offset:96
    ds_read_b64_tr_b16 v[46:47], v20 offset:1888
    ds_read_b64_tr_b16 v[48:49], v19 offset:128
    ds_read_b64_tr_b16 v[50:51], v19 offset:1920
    ds_read_b64_tr_b16 v[52:53], v20 offset:160
    ds_read_b64_tr_b16 v[54:55], v20 offset:1952
    ds_read_b64_tr_b16 v[56:57], v21 offset:0
    ds_read_b64_tr_b16 v[58:59], v21 offset:1792
    s_waitcnt lgkmcnt(0)
    v_mfma_f32_16x16x32_bf16 a[0:3], v[32:35], v[88:91], 0
    ds_read_b128 v[104:107], v18 offset:0
    v_mfma_f32_16x16x32_bf16 a[4:7], v[32:35], v[92:95], 0
    ds_read_b64_tr_b16 v[60:61], v19 offset:14336
    s_add_u32 m0, s73, 90112
    v_mfma_f32_16x16x32_bf16 a[8:11], v[32:35], v[96:99], 0
    buffer_load_dwordx4 v2, s[4:7], s69 offen offset:0  lds
    v_mfma_f32_16x16x32_bf16 a[12:15], v[32:35], v[100:103], 0
    ds_read_b64_tr_b16 v[62:63], v19 offset:16128
    v_mfma_f32_16x16x32_bf16 a[16:19], v[36:39], v[88:91], 0
    ds_read_b128 v[108:111], v18 offset:2048
    buffer_load_dwordx4 v3, s[4:7], s69 offen offset:1024  lds
    v_mfma_f32_16x16x32_bf16 a[20:23], v[36:39], v[92:95], 0
    ds_read_b128 v[112:115], v18 offset:4096
    v_mfma_f32_16x16x32_bf16 a[24:27], v[36:39], v[96:99], 0
    ds_read_b128 v[116:119], v18 offset:6144
    v_mfma_f32_16x16x32_bf16 a[28:31], v[36:39], v[100:103], 0
    buffer_load_dwordx4 v4, s[4:7], s69 offen offset:2048  lds
    v_mfma_f32_16x16x32_bf16 a[32:35], v[40:43], v[88:91], 0
    ds_read_b64_tr_b16 v[64:65], v20 offset:14368
    v_mfma_f32_16x16x32_bf16 a[36:39], v[40:43], v[92:95], 0
    ds_read_b64_tr_b16 v[66:67], v20 offset:16160
    buffer_load_dwordx4 v5, s[4:7], s69 offen offset:3072  lds
    v_mfma_f32_16x16x32_bf16 a[40:43], v[40:43], v[96:99], 0
    ds_read_b64_tr_b16 v[68:69], v19 offset:14400
    v_mfma_f32_16x16x32_bf16 a[44:47], v[40:43], v[100:103], 0
    ds_read_b64_tr_b16 v[70:71], v19 offset:16192
    s_add_u32 m0, s56, 90112
    v_mfma_f32_16x16x32_bf16 a[48:51], v[44:47], v[88:91], 0
    buffer_load_dwordx4 v6, s[8:11], s70 offen offset:0  lds
    v_mfma_f32_16x16x32_bf16 a[52:55], v[44:47], v[92:95], 0
    ds_read_b64_tr_b16 v[72:73], v20 offset:14432
    v_mfma_f32_16x16x32_bf16 a[56:59], v[44:47], v[96:99], 0
    ds_read_b64_tr_b16 v[74:75], v20 offset:16224
    buffer_load_dwordx4 v7, s[8:11], s70 offen offset:1024  lds
    v_mfma_f32_16x16x32_bf16 a[60:63], v[44:47], v[100:103], 0
    ds_read_b64_tr_b16 v[76:77], v19 offset:14464
    v_mfma_f32_16x16x32_bf16 a[64:67], v[48:51], v[88:91], 0
    ds_read_b64_tr_b16 v[78:79], v19 offset:16256
    v_mfma_f32_16x16x32_bf16 a[68:71], v[48:51], v[92:95], 0
    buffer_load_dwordx4 v8, s[8:11], s70 offen offset:2048  lds
    v_mfma_f32_16x16x32_bf16 a[72:75], v[48:51], v[96:99], 0
    ds_read_b64_tr_b16 v[80:81], v20 offset:14496
    v_mfma_f32_16x16x32_bf16 a[76:79], v[48:51], v[100:103], 0
    ds_read_b64_tr_b16 v[82:83], v20 offset:16288
    buffer_load_dwordx4 v9, s[8:11], s70 offen offset:3072  lds
    v_mfma_f32_16x16x32_bf16 a[80:83], v[52:55], v[88:91], 0
    ds_read_b64_tr_b16 v[84:85], v21 offset:14336
    s_add_u32 m0, s56, 94208
    v_mfma_f32_16x16x32_bf16 a[84:87], v[52:55], v[92:95], 0
    ds_read_b64_tr_b16 v[86:87], v21 offset:16128
    buffer_load_dwordx4 v10, s[8:11], s70 offen offset:0  lds
    v_mfma_f32_16x16x32_bf16 a[88:91], v[52:55], v[96:99], 0
    v_mfma_f32_16x16x32_bf16 a[92:95], v[52:55], v[100:103], 0
    buffer_load_dwordx4 v11, s[8:11], s70 offen offset:1024  lds
    v_mfma_f32_16x16x32_bf16 a[96:99], v[56:59], v[88:91], 0
    v_mfma_f32_16x16x32_bf16 a[100:103], v[56:59], v[92:95], 0
    buffer_load_dwordx4 v12, s[8:11], s70 offen offset:2048  lds
    v_mfma_f32_16x16x32_bf16 a[104:107], v[56:59], v[96:99], 0
    s_add_u32 s71, s71, 1
    s_and_b32 s71, s71, 15
    v_mfma_f32_16x16x32_bf16 a[108:111], v[56:59], v[100:103], 0
    s_lshl_b32 s69, s71, 7
    s_mul_i32 s70, s71, 458752
    s_cmp_eq_u32 s74, 0
    s_cbranch_scc0 L_csA0
    v_mfma_f32_16x16x32_bf16 a[112:115], v[32:35], v[120:123], 0
    v_mfma_f32_16x16x32_bf16 a[116:119], v[36:39], v[120:123], 0
    v_mfma_f32_16x16x32_bf16 a[120:123], v[40:43], v[120:123], 0
    v_mfma_f32_16x16x32_bf16 a[124:127], v[44:47], v[120:123], 0
    v_mfma_f32_16x16x32_bf16 a[128:131], v[48:51], v[120:123], 0
    v_mfma_f32_16x16x32_bf16 a[132:135], v[52:55], v[120:123], 0
    v_mfma_f32_16x16x32_bf16 a[136:139], v[56:59], v[120:123], 0
L_csA0:
    s_waitcnt vmcnt(11) lgkmcnt(0)
    s_barrier
    v_mfma_f32_16x16x32_bf16 a[0:3], v[60:63], v[104:107], a[0:3]
    ds_read_b128 v[88:91], v22 offset:0
    v_mfma_f32_16x16x32_bf16 a[4:7], v[60:63], v[108:111], a[4:7]
    ds_read_b64_tr_b16 v[32:33], v24 offset:0
    s_add_u32 m0, s73, 0
    v_mfma_f32_16x16x32_bf16 a[8:11], v[60:63], v[112:115], a[8:11]
    buffer_load_dwordx4 v2, s[4:7], s69 offen offset:0  lds
    v_mfma_f32_16x16x32_bf16 a[12:15], v[60:63], v[116:119], a[12:15]
    ds_read_b64_tr_b16 v[34:35], v24 offset:1792
    v_mfma_f32_16x16x32_bf16 a[16:19], v[64:67], v[104:107], a[16:19]
    ds_read_b128 v[92:95], v22 offset:2048
    v_mfma_f32_16x16x32_bf16 a[20:23], v[64:67], v[108:111], a[20:23]
    ds_read_b128 v[96:99], v22 offset:4096
    v_mfma_f32_16x16x32_bf16 a[24:27], v[64:67], v[112:115], a[24:27]
    ds_read_b128 v[100:103], v22 offset:6144
    v_mfma_f32_16x16x32_bf16 a[28:31], v[64:67], v[116:119], a[28:31]
    buffer_load_dwordx4 v3, s[4:7], s69 offen offset:1024  lds
    v_mfma_f32_16x16x32_bf16 a[32:35], v[68:71], v[104:107], a[32:35]
    ds_read_b64_tr_b16 v[36:37], v25 offset:32
    v_mfma_f32_16x16x32_bf16 a[36:39], v[68:71], v[108:111], a[36:39]
    ds_read_b64_tr_b16 v[38:39], v25 offset:1824
    v_mfma_f32_16x16x32_bf16 a[40:43], v[68:71], v[112:115], a[40:43]
    ds_read_b64_tr_b16 v[40:41], v24 offset:64
    v_mfma_f32_16x16x32_bf16 a[44:47], v[68:71], v[116:119], a[44:47]
    ds_read_b64_tr_b16 v[42:43], v24 offset:1856
    v_mfma_f32_16x16x32_bf16 a[48:51], v[72:75], v[104:107], a[48:51]
    buffer_load_dwordx4 v4, s[4:7], s69 offen offset:2048  lds
    v_mfma_f32_16x16x32_bf16 a[52:55], v[72:75], v[108:111], a[52:55]
    ds_read_b64_tr_b16 v[44:45], v25 offset:96
    v_mfma_f32_16x16x32_bf16 a[56:59], v[72:75], v[112:115], a[56:59]
    ds_read_b64_tr_b16 v[46:47], v25 offset:1888
    v_mfma_f32_16x16x32_bf16 a[60:63], v[72:75], v[116:119], a[60:63]
    ds_read_b64_tr_b16 v[48:49], v24 offset:128
    v_mfma_f32_16x16x32_bf16 a[64:67], v[76:79], v[104:107], a[64:67]
    ds_read_b64_tr_b16 v[50:51], v24 offset:1920
    v_mfma_f32_16x16x32_bf16 a[68:71], v[76:79], v[108:111], a[68:71]
    buffer_load_dwordx4 v5, s[4:7], s69 offen offset:3072  lds
    v_mfma_f32_16x16x32_bf16 a[72:75], v[76:79], v[112:115], a[72:75]
    ds_read_b64_tr_b16 v[52:53], v25 offset:160
    v_mfma_f32_16x16x32_bf16 a[76:79], v[76:79], v[116:119], a[76:79]
    ds_read_b64_tr_b16 v[54:55], v25 offset:1952
    v_mfma_f32_16x16x32_bf16 a[80:83], v[80:83], v[104:107], a[80:83]
    ds_read_b64_tr_b16 v[56:57], v26 offset:0
    v_mfma_f32_16x16x32_bf16 a[84:87], v[80:83], v[108:111], a[84:87]
    ds_read_b64_tr_b16 v[58:59], v26 offset:1792
    s_add_u32 m0, s56, 0
    v_mfma_f32_16x16x32_bf16 a[88:91], v[80:83], v[112:115], a[88:91]
    buffer_load_dwordx4 v6, s[8:11], s70 offen offset:0  lds
    v_mfma_f32_16x16x32_bf16 a[92:95], v[80:83], v[116:119], a[92:95]
    v_mfma_f32_16x16x32_bf16 a[96:99], v[84:87], v[104:107], a[96:99]
    v_mfma_f32_16x16x32_bf16 a[100:103], v[84:87], v[108:111], a[100:103]
    v_mfma_f32_16x16x32_bf16 a[104:107], v[84:87], v[112:115], a[104:107]
    buffer_load_dwordx4 v7, s[8:11], s70 offen offset:1024  lds
    v_mfma_f32_16x16x32_bf16 a[108:111], v[84:87], v[116:119], a[108:111]
    s_cmp_eq_u32 s74, 0
    s_cbranch_scc0 L_csB0
    v_mfma_f32_16x16x32_bf16 a[112:115], v[60:63], v[120:123], a[112:115]
    v_mfma_f32_16x16x32_bf16 a[116:119], v[64:67], v[120:123], a[116:119]
    v_mfma_f32_16x16x32_bf16 a[120:123], v[68:71], v[120:123], a[120:123]
    v_mfma_f32_16x16x32_bf16 a[124:127], v[72:75], v[120:123], a[124:127]
    v_mfma_f32_16x16x32_bf16 a[128:131], v[76:79], v[120:123], a[128:131]
    v_mfma_f32_16x16x32_bf16 a[132:135], v[80:83], v[120:123], a[132:135]
    v_mfma_f32_16x16x32_bf16 a[136:139], v[84:87], v[120:123], a[136:139]
L_csB0:
    s_waitcnt lgkmcnt(0)
    v_mfma_f32_16x16x32_bf16 a[0:3], v[32:35], v[88:91], a[0:3]
    ds_read_b128 v[104:107], v23 offset:0
    v_mfma_f32_16x16x32_bf16 a[4:7], v[32:35], v[92:95], a[4:7]
    ds_read_b64_tr_b16 v[60:61], v24 offset:14336
    s_add_u32 m0, s56, 0
    v_mfma_f32_16x16x32_bf16 a[8:11], v[32:35], v[96:99], a[8:11]
    buffer_load_dwordx4 v8, s[8:11], s70 offen offset:2048  lds
    s_lshr_b32 s81, s2, 3
    v_mfma_f32_16x16x32_bf16 a[12:15], v[32:35], v[100:103], a[12:15]
    ds_read_b64_tr_b16 v[62:63], v24 offset:16128
    s_lshl_b32 s81, s81, 2
    v_mfma_f32_16x16x32_bf16 a[16:19], v[36:39], v[88:91], a[16:19]
    ds_read_b128 v[108:111], v23 offset:2048
    v_mfma_f32_16x16x32_bf16 a[20:23], v[36:39], v[92:95], a[20:23]
    ds_read_b128 v[112:115], v23 offset:4096
    s_add_u32 s81, s81, s66
    v_mfma_f32_16x16x32_bf16 a[24:27], v[36:39], v[96:99], a[24:27]
    ds_read_b128 v[116:119], v23 offset:6144
    v_mfma_f32_16x16x32_bf16 a[28:31], v[36:39], v[100:103], a[28:31]
    buffer_load_dwordx4 v9, s[8:11], s70 offen offset:3072  lds
    s_lshl_b32 s81, s81, 8
    v_mfma_f32_16x16x32_bf16 a[32:35], v[40:43], v[88:91], a[32:35]
    ds_read_b64_tr_b16 v[64:65], v25 offset:14368
    v_mfma_f32_16x16x32_bf16 a[36:39], v[40:43], v[92:95], a[36:39]
    ds_read_b64_tr_b16 v[66:67], v25 offset:16160
    s_add_u32 s81, s81, (L_step5-L_pc)
    v_mfma_f32_16x16x32_bf16 a[40:43], v[40:43], v[96:99], a[40:43]
    ds_read_b64_tr_b16 v[68:69], v24 offset:14400
    v_mfma_f32_16x16x32_bf16 a[44:47], v[40:43], v[100:103], a[44:47]
    ds_read_b64_tr_b16 v[70:71], v24 offset:16192
    s_add_u32 m0, s56, 4096
    v_mfma_f32_16x16x32_bf16 a[48:51], v[44:47], v[88:91], a[48:51]
    buffer_load_dwordx4 v10, s[8:11], s70 offen offset:0  lds
    v_and_b32 v236, 1, v1
    v_mfma_f32_16x16x32_bf16 a[52:55], v[44:47], v[92:95], a[52:55]
    ds_read_b64_tr_b16 v[72:73], v25 offset:14432
    v_lshl_add_u32 v236, v236, 7, s81
    v_mfma_f32_16x16x32_bf16 a[56:59], v[44:47], v[96:99], a[56:59]
    ds_read_b64_tr_b16 v[74:75], v25 offset:16224
    v_mfma_f32_16x16x32_bf16 a[60:63], v[44:47], v[100:103], a[60:63]
    ds_read_b64_tr_b16 v[76:77], v24 offset:14464
    v_min_u32 v236, (L_step10-L_pc), v236
    v_mfma_f32_16x16x32_bf16 a[64:67], v[48:51], v[88:91], a[64:67]
    ds_read_b64_tr_b16 v[78:79], v24 offset:16256
    v_mfma_f32_16x16x32_bf16 a[68:71], v[48:51], v[92:95], a[68:71]
    buffer_load_dwordx4 v11, s[8:11], s70 offen offset:1024  lds
    v_mov_b32 v239, s59
    v_mfma_f32_16x16x32_bf16 a[72:75], v[48:51], v[96:99], a[72:75]
    ds_read_b64_tr_b16 v[80:81], v25 offset:14496
    v_mfma_f32_16x16x32_bf16 a[76:79], v[48:51], v[100:103], a[76:79]
    ds_read_b64_tr_b16 v[82:83], v25 offset:16288
    v_add_co_u32 v238, vcc, s58, v236
    s_nop 1
    v_addc_co_u32 v239, vcc, 0, v239, vcc
    v_mfma_f32_16x16x32_bf16 a[80:83], v[52:55], v[88:91], a[80:83]
    ds_read_b64_tr_b16 v[84:85], v26 offset:14336
    v_mfma_f32_16x16x32_bf16 a[84:87], v[52:55], v[92:95], a[84:87]
    ds_read_b64_tr_b16 v[86:87], v26 offset:16128
    s_mov_b64 exec, 3
    global_load_dword v127, v[238:239], off
    s_mov_b64 exec, -1
    v_mfma_f32_16x16x32_bf16 a[88:91], v[52:55], v[96:99], a[88:91]
    buffer_load_dwordx4 v12, s[8:11], s70 offen offset:2048  lds
    v_mfma_f32_16x16x32_bf16 a[92:95], v[52:55], v[100:103], a[92:95]
    s_add_u32 s71, s71, 1
    s_and_b32 s71, s71, 15
    v_mfma_f32_16x16x32_bf16 a[96:99], v[56:59], v[88:91], a[96:99]
    s_lshl_b32 s69, s71, 7
    s_mul_i32 s70, s71, 458752
    v_mfma_f32_16x16x32_bf16 a[100:103], v[56:59], v[92:95], a[100:103]
    v_mfma_f32_16x16x32_bf16 a[104:107], v[56:59], v[96:99], a[104:107]
    v_mfma_f32_16x16x32_bf16 a[108:111], v[56:59], v[100:103], a[108:111]
    s_waitcnt vmcnt(12) lgkmcnt(0)
    s_barrier
    s_cmp_eq_u32 s74, 0
    s_cbranch_scc0 L_css1
    s_cmp_lt_u32 s66, 2
    s_cbranch_scc0 L_css1
    v_lshrrev_b32 v240, 4, v1
    v_lshlrev_b32 v240, 4, v240
    s_lshl_b32 s76, s65, 4
    s_add_u32 s76, s76, s64
    s_mul_i32 s76, s76, 896
    s_add_u32 s76, s76, 33619968
    s_lshl_b32 s77, s68, 9
    s_add_u32 s77, s77, s76
    s_lshl_b32 s78, s68, 6
    s_add_u32 s78, s78, s76
    s_mov_b32 exec_lo, 0x00010001
    s_mov_b32 exec_hi, 0x00010001
    buffer_store_dwordx4 a[112:115], v240, s[12:15], s77 offen offset:0 sc1
    buffer_store_dwordx4 a[116:119], v240, s[12:15], s77 offen offset:64 sc1
    buffer_store_dwordx4 a[120:123], v240, s[12:15], s77 offen offset:128 sc1
    buffer_store_dwordx4 a[124:127], v240, s[12:15], s77 offen offset:192 sc1
    buffer_store_dwordx4 a[128:131], v240, s[12:15], s77 offen offset:256 sc1
    buffer_store_dwordx4 a[132:135], v240, s[12:15], s77 offen offset:320 sc1
    buffer_store_dwordx4 a[136:139], v240, s[12:15], s78 offen offset:384 sc1
    s_mov_b64 exec, -1
L_css1:
    v_mfma_f32_16x16x32_bf16 a[0:3], v[60:63], v[104:107], a[0:3]
    ds_read_b128 v[88:91], v27 offset:0
    v_mfma_f32_16x16x32_bf16 a[4:7], v[60:63], v[108:111], a[4:7]
    ds_read_b64_tr_b16 v[32:33], v29 offset:0
    s_add_u32 m0, s73, 45056
    v_mfma_f32_16x16x32_bf16 a[8:11], v[60:63], v[112:115], a[8:11]
    buffer_load_dwordx4 v2, s[4:7], s69 offen offset:0  lds
    v_mfma_f32_16x16x32_bf16 a[12:15], v[60:63], v[116:119], a[12:15]
    ds_read_b64_tr_b16 v[34:35], v29 offset:1792
    v_mfma_f32_16x16x32_bf16 a[16:19], v[64:67], v[104:107], a[16:19]
    ds_read_b128 v[92:95], v27 offset:2048
    v_mfma_f32_16x16x32_bf16 a[20:23], v[64:67], v[108:111], a[20:23]
    ds_read_b128 v[96:99], v27 offset:4096
    v_mfma_f32_16x16x32_bf16 a[24:27], v[64:67], v[112:115], a[24:27]
    ds_read_b128 v[100:103], v27 offset:6144
    v_mfma_f32_16x16x32_bf16 a[28:31], v[64:67], v[116:119], a[28:31]
    buffer_load_dwordx4 v3, s[4:7], s69 offen offset:1024  lds
    v_mfma_f32_16x16x32_bf16 a[32:35], v[68:71], v[104:107], a[32:35]
    ds_read_b64_tr_b16 v[36:37], v30 offset:32
    v_mfma_f32_16x16x32_bf16 a[36:39], v[68:71], v[108:111], a[36:39]
    ds_read_b64_tr_b16 v[38:39], v30 offset:1824
    v_mfma_f32_16x16x32_bf16 a[40:43], v[68:71], v[112:115], a[40:43]
    ds_read_b64_tr_b16 v[40:41], v29 offset:64
    v_mfma_f32_16x16x32_bf16 a[44:47], v[68:71], v[116:119], a[44:47]
    ds_read_b64_tr_b16 v[42:43], v29 offset:1856
    v_mfma_f32_16x16x32_bf16 a[48:51], v[72:75], v[104:107], a[48:51]
    buffer_load_dwordx4 v4, s[4:7], s69 offen offset:2048  lds
    v_mfma_f32_16x16x32_bf16 a[52:55], v[72:75], v[108:111], a[52:55]
    ds_read_b64_tr_b16 v[44:45], v30 offset:96
    v_mfma_f32_16x16x32_bf16 a[56:59], v[72:75], v[112:115], a[56:59]
    ds_read_b64_tr_b16 v[46:47], v30 offset:1888
    v_mfma_f32_16x16x32_bf16 a[60:63], v[72:75], v[116:119], a[60:63]
    ds_read_b64_tr_b16 v[48:49], v29 offset:128
    v_mfma_f32_16x16x32_bf16 a[64:67], v[76:79], v[104:107], a[64:67]
    ds_read_b64_tr_b16 v[50:51], v29 offset:1920
    v_mfma_f32_16x16x32_bf16 a[68:71], v[76:79], v[108:111], a[68:71]
    buffer_load_dwordx4 v5, s[4:7], s69 offen offset:3072  lds
    v_mfma_f32_16x16x32_bf16 a[72:75], v[76:79], v[112:115], a[72:75]
    ds_read_b64_tr_b16 v[52:53], v30 offset:160
    v_mfma_f32_16x16x32_bf16 a[76:79], v[76:79], v[116:119], a[76:79]
    ds_read_b64_tr_b16 v[54:55], v30 offset:1952
    v_mfma_f32_16x16x32_bf16 a[80:83], v[80:83], v[104:107], a[80:83]
    ds_read_b64_tr_b16 v[56:57], v31 offset:0
    v_mfma_f32_16x16x32_bf16 a[84:87], v[80:83], v[108:111], a[84:87]
    ds_read_b64_tr_b16 v[58:59], v31 offset:1792
    s_add_u32 m0, s56, 45056
    v_mfma_f32_16x16x32_bf16 a[88:91], v[80:83], v[112:115], a[88:91]
    buffer_load_dwordx4 v6, s[8:11], s70 offen offset:0  lds
    v_mfma_f32_16x16x32_bf16 a[92:95], v[80:83], v[116:119], a[92:95]
    v_mfma_f32_16x16x32_bf16 a[96:99], v[84:87], v[104:107], a[96:99]
    v_mfma_f32_16x16x32_bf16 a[100:103], v[84:87], v[108:111], a[100:103]
    v_mfma_f32_16x16x32_bf16 a[104:107], v[84:87], v[112:115], a[104:107]
    buffer_load_dwordx4 v7, s[8:11], s70 offen offset:1024  lds
    v_mfma_f32_16x16x32_bf16 a[108:111], v[84:87], v[116:119], a[108:111]
    s_waitcnt lgkmcnt(0)
    v_mfma_f32_16x16x32_bf16 a[0:3], v[32:35], v[88:91], a[0:3]
    ds_read_b128 v[104:107], v28 offset:0
    v_mfma_f32_16x16x32_bf16 a[4:7], v[32:35], v[92:95], a[4:7]
    ds_read_b64_tr_b16 v[60:61], v29 offset:14336
    s_add_u32 m0, s56, 45056
    v_mfma_f32_16x16x32_bf16 a[8:11], v[32:35], v[96:99], a[8:11]
    buffer_load_dwordx4 v8, s[8:11], s70 offen offset:2048  lds
    v_mfma_f32_16x16x32_bf16 a[12:15], v[32:35], v[100:103], a[12:15]
    ds_read_b64_tr_b16 v[62:63], v29 offset:16128
    v_mfma_f32_16x16x32_bf16 a[16:19], v[36:39], v[88:91], a[16:19]
    ds_read_b128 v[108:111], v28 offset:2048
    v_mfma_f32_16x16x32_bf16 a[20:23], v[36:39], v[92:95], a[20:23]
    ds_read_b128 v[112:115], v28 offset:4096
    v_mfma_f32_16x16x32_bf16 a[24:27], v[36:39], v[96:99], a[24:27]
    ds_read_b128 v[116:119], v28 offset:6144
    v_mfma_f32_16x16x32_bf16 a[28:31], v[36:39], v[100:103], a[28:31]
    buffer_load_dwordx4 v9, s[8:11], s70 offen offset:3072  lds
    v_mfma_f32_16x16x32_bf16 a[32:35], v[40:43], v[88:91], a[32:35]
    ds_read_b64_tr_b16 v[64:65], v30 offset:14368
    v_mfma_f32_16x16x32_bf16 a[36:39], v[40:43], v[92:95], a[36:39]
    ds_read_b64_tr_b16 v[66:67], v30 offset:16160
    v_mfma_f32_16x16x32_bf16 a[40:43], v[40:43], v[96:99], a[40:43]
    ds_read_b64_tr_b16 v[68:69], v29 offset:14400
    v_mfma_f32_16x16x32_bf16 a[44:47], v[40:43], v[100:103], a[44:47]
    ds_read_b64_tr_b16 v[70:71], v29 offset:16192
    s_add_u32 m0, s56, 49152
    v_mfma_f32_16x16x32_bf16 a[48:51], v[44:47], v[88:91], a[48:51]
    buffer_load_dwordx4 v10, s[8:11], s70 offen offset:0  lds
    v_mfma_f32_16x16x32_bf16 a[52:55], v[44:47], v[92:95], a[52:55]
    ds_read_b64_tr_b16 v[72:73], v30 offset:14432
    v_mfma_f32_16x16x32_bf16 a[56:59], v[44:47], v[96:99], a[56:59]
    ds_read_b64_tr_b16 v[74:75], v30 offset:16224
    v_mfma_f32_16x16x32_bf16 a[60:63], v[44:47], v[100:103], a[60:63]
    ds_read_b64_tr_b16 v[76:77], v29 offset:14464
    v_mfma_f32_16x16x32_bf16 a[64:67], v[48:51], v[88:91], a[64:67]
    ds_read_b64_tr_b16 v[78:79], v29 offset:16256
    v_mfma_f32_16x16x32_bf16 a[68:71], v[48:51], v[92:95], a[68:71]
    buffer_load_dwordx4 v11, s[8:11], s70 offen offset:1024  lds
    v_mfma_f32_16x16x32_bf16 a[72:75], v[48:51], v[96:99], a[72:75]
    ds_read_b64_tr_b16 v[80:81], v30 offset:14496
    v_mfma_f32_16x16x32_bf16 a[76:79], v[48:51], v[100:103], a[76:79]
    ds_read_b64_tr_b16 v[82:83], v30 offset:16288
    v_mfma_f32_16x16x32_bf16 a[80:83], v[52:55], v[88:91], a[80:83]
    ds_read_b64_tr_b16 v[84:85], v31 offset:14336
    v_mfma_f32_16x16x32_bf16 a[84:87], v[52:55], v[92:95], a[84:87]
    ds_read_b64_tr_b16 v[86:87], v31 offset:16128
    v_mfma_f32_16x16x32_bf16 a[88:91], v[52:55], v[96:99], a[88:91]
    buffer_load_dwordx4 v12, s[8:11], s70 offen offset:2048  lds
    v_mfma_f32_16x16x32_bf16 a[92:95], v[52:55], v[100:103], a[92:95]
    s_add_u32 s71, s71, 1
    s_and_b32 s71, s71, 15
    v_mfma_f32_16x16x32_bf16 a[96:99], v[56:59], v[88:91], a[96:99]
    s_lshl_b32 s69, s71, 7
    s_mul_i32 s70, s71, 458752
    v_mfma_f32_16x16x32_bf16 a[100:103], v[56:59], v[92:95], a[100:103]
    v_mfma_f32_16x16x32_bf16 a[104:107], v[56:59], v[96:99], a[104:107]
    v_mfma_f32_16x16x32_bf16 a[108:111], v[56:59], v[100:103], a[108:111]
    s_waitcnt vmcnt(11) lgkmcnt(0)
    s_barrier
    v_mfma_f32_16x16x32_bf16 a[0:3], v[60:63], v[104:107], a[0:3]
    ds_read_b128 v[88:91], v17 offset:0
    s_lshl_b32 s82, s64, 7
    v_mfma_f32_16x16x32_bf16 a[4:7], v[60:63], v[108:111], a[4:7]
    ds_read_b64_tr_b16 v[32:33], v19 offset:0
    s_add_u32 m0, s73, 90112
    v_mfma_f32_16x16x32_bf16 a[8:11], v[60:63], v[112:115], a[8:11]
    buffer_load_dwordx4 v2, s[4:7], s69 offen offset:0  lds
    s_lshl_b32 s83, s65, 3
    v_mfma_f32_16x16x32_bf16 a[12:15], v[60:63], v[116:119], a[12:15]
    ds_read_b64_tr_b16 v[34:35], v19 offset:1792
    v_mfma_f32_16x16x32_bf16 a[16:19], v[64:67], v[104:107], a[16:19]
    ds_read_b128 v[92:95], v17 offset:2048
    s_add_u32 s82, s82, s83
    v_mfma_f32_16x16x32_bf16 a[20:23], v[64:67], v[108:111], a[20:23]
    ds_read_b128 v[96:99], v17 offset:4096
    v_mfma_f32_16x16x32_bf16 a[24:27], v[64:67], v[112:115], a[24:27]
    ds_read_b128 v[100:103], v17 offset:6144
    s_lshl_b32 s83, s66, 1
    v_mfma_f32_16x16x32_bf16 a[28:31], v[64:67], v[116:119], a[28:31]
    buffer_load_dwordx4 v3, s[4:7], s69 offen offset:1024  lds
    v_mfma_f32_16x16x32_bf16 a[32:35], v[68:71], v[104:107], a[32:35]
    ds_read_b64_tr_b16 v[36:37], v20 offset:32
    s_add_u32 s87, s82, s83
    v_mfma_f32_16x16x32_bf16 a[36:39], v[68:71], v[108:111], a[36:39]
    ds_read_b64_tr_b16 v[38:39], v20 offset:1824
    v_mfma_f32_16x16x32_bf16 a[40:43], v[68:71], v[112:115], a[40:43]
    ds_read_b64_tr_b16 v[40:41], v19 offset:64
    s_lshl_b32 s82, s87, 11
    v_mfma_f32_16x16x32_bf16 a[44:47], v[68:71], v[116:119], a[44:47]
    ds_read_b64_tr_b16 v[42:43], v19 offset:1856
    v_lshlrev_b32 v248, 4, v1
    v_mfma_f32_16x16x32_bf16 a[48:51], v[72:75], v[104:107], a[48:51]
    buffer_load_dwordx4 v4, s[4:7], s69 offen offset:2048  lds
    v_mfma_f32_16x16x32_bf16 a[52:55], v[72:75], v[108:111], a[52:55]
    ds_read_b64_tr_b16 v[44:45], v20 offset:96
    buffer_load_dwordx4 v[128:131], v248, s[4:7], s82 offen
    v_mfma_f32_16x16x32_bf16 a[56:59], v[72:75], v[112:115], a[56:59]
    ds_read_b64_tr_b16 v[46:47], v20 offset:1888
    v_mfma_f32_16x16x32_bf16 a[60:63], v[72:75], v[116:119], a[60:63]
    ds_read_b64_tr_b16 v[48:49], v19 offset:128
    buffer_load_dwordx4 v[132:135], v248, s[4:7], s82 offen offset:1024
    v_mfma_f32_16x16x32_bf16 a[64:67], v[76:79], v[104:107], a[64:67]
    ds_read_b64_tr_b16 v[50:51], v19 offset:1920
    v_mfma_f32_16x16x32_bf16 a[68:71], v[76:79], v[108:111], a[68:71]
    buffer_load_dwordx4 v5, s[4:7], s69 offen offset:3072  lds
    buffer_load_dwordx4 v[136:139], v248, s[4:7], s82 offen offset:2048
    v_mfma_f32_16x16x32_bf16 a[72:75], v[76:79], v[112:115], a[72:75]
    ds_read_b64_tr_b16 v[52:53], v20 offset:160
    v_mfma_f32_16x16x32_bf16 a[76:79], v[76:79], v[116:119], a[76:79]
    ds_read_b64_tr_b16 v[54:55], v20 offset:1952
    buffer_load_dwordx4 v[140:143], v248, s[4:7], s82 offen offset:3072
    v_mfma_f32_16x16x32_bf16 a[80:83], v[80:83], v[104:107], a[80:83]
    ds_read_b64_tr_b16 v[56:57], v21 offset:0
    v_mfma_f32_16x16x32_bf16 a[84:87], v[80:83], v[108:111], a[84:87]
    ds_read_b64_tr_b16 v[58:59], v21 offset:1792
    s_add_u32 m0, s56, 90112
    v_mfma_f32_16x16x32_bf16 a[88:91], v[80:83], v[112:115], a[88:91]
    buffer_load_dwordx4 v6, s[8:11], s70 offen offset:0  lds
    v_mfma_f32_16x16x32_bf16 a[92:95], v[80:83], v[116:119], a[92:95]
    v_mfma_f32_16x16x32_bf16 a[96:99], v[84:87], v[104:107], a[96:99]
    v_mfma_f32_16x16x32_bf16 a[100:103], v[84:87], v[108:111], a[100:103]
    v_mfma_f32_16x16x32_bf16 a[104:107], v[84:87], v[112:115], a[104:107]
    buffer_load_dwordx4 v7, s[8:11], s70 offen offset:1024  lds
    v_mfma_f32_16x16x32_bf16 a[108:111], v[84:87], v[116:119], a[108:111]
    s_waitcnt lgkmcnt(0)
    v_mfma_f32_16x16x32_bf16 a[0:3], v[32:35], v[88:91], a[0:3]
    ds_read_b128 v[104:107], v18 offset:0
    v_mfma_f32_16x16x32_bf16 a[4:7], v[32:35], v[92:95], a[4:7]
    ds_read_b64_tr_b16 v[60:61], v19 offset:14336
    s_add_u32 m0, s56, 90112
    v_mfma_f32_16x16x32_bf16 a[8:11], v[32:35], v[96:99], a[8:11]
    buffer_load_dwordx4 v8, s[8:11], s70 offen offset:2048  lds
    v_mfma_f32_16x16x32_bf16 a[12:15], v[32:35], v[100:103], a[12:15]
    ds_read_b64_tr_b16 v[62:63], v19 offset:16128
    v_mfma_f32_16x16x32_bf16 a[16:19], v[36:39], v[88:91], a[16:19]
    ds_read_b128 v[108:111], v18 offset:2048
    v_mfma_f32_16x16x32_bf16 a[20:23], v[36:39], v[92:95], a[20:23]
    ds_read_b128 v[112:115], v18 offset:4096
    v_mfma_f32_16x16x32_bf16 a[24:27], v[36:39], v[96:99], a[24:27]
    ds_read_b128 v[116:119], v18 offset:6144
    v_mfma_f32_16x16x32_bf16 a[28:31], v[36:39], v[100:103], a[28:31]
    buffer_load_dwordx4 v9, s[8:11], s70 offen offset:3072  lds
    v_mfma_f32_16x16x32_bf16 a[32:35], v[40:43], v[88:91], a[32:35]
    ds_read_b64_tr_b16 v[64:65], v20 offset:14368
    v_mfma_f32_16x16x32_bf16 a[36:39], v[40:43], v[92:95], a[36:39]
    ds_read_b64_tr_b16 v[66:67], v20 offset:16160
    v_mfma_f32_16x16x32_bf16 a[40:43], v[40:43], v[96:99], a[40:43]
    ds_read_b64_tr_b16 v[68:69], v19 offset:14400
    v_mfma_f32_16x16x32_bf16 a[44:47], v[40:43], v[100:103], a[44:47]
    ds_read_b64_tr_b16 v[70:71], v19 offset:16192
    s_add_u32 m0, s56, 94208
    v_mfma_f32_16x16x32_bf16 a[48:51], v[44:47], v[88:91], a[48:51]
    buffer_load_dwordx4 v10, s[8:11], s70 offen offset:0  lds
    v_mfma_f32_16x16x32_bf16 a[52:55], v[44:47], v[92:95], a[52:55]
    ds_read_b64_tr_b16 v[72:73], v20 offset:14432
    v_mfma_f32_16x16x32_bf16 a[56:59], v[44:47], v[96:99], a[56:59]
    ds_read_b64_tr_b16 v[74:75], v20 offset:16224
    v_mfma_f32_16x16x32_bf16 a[60:63], v[44:47], v[100:103], a[60:63]
    ds_read_b64_tr_b16 v[76:77], v19 offset:14464
    v_mfma_f32_16x16x32_bf16 a[64:67], v[48:51], v[88:91], a[64:67]
    ds_read_b64_tr_b16 v[78:79], v19 offset:16256
    v_mfma_f32_16x16x32_bf16 a[68:71], v[48:51], v[92:95], a[68:71]
    buffer_load_dwordx4 v11, s[8:11], s70 offen offset:1024  lds
    v_mfma_f32_16x16x32_bf16 a[72:75], v[48:51], v[96:99], a[72:75]
    ds_read_b64_tr_b16 v[80:81], v20 offset:14496
    v_mfma_f32_16x16x32_bf16 a[76:79], v[48:51], v[100:103], a[76:79]
    ds_read_b64_tr_b16 v[82:83], v20 offset:16288
    v_mfma_f32_16x16x32_bf16 a[80:83], v[52:55], v[88:91], a[80:83]
    ds_read_b64_tr_b16 v[84:85], v21 offset:14336
    v_mfma_f32_16x16x32_bf16 a[84:87], v[52:55], v[92:95], a[84:87]
    ds_read_b64_tr_b16 v[86:87], v21 offset:16128
    v_mfma_f32_16x16x32_bf16 a[88:91], v[52:55], v[96:99], a[88:91]
    buffer_load_dwordx4 v12, s[8:11], s70 offen offset:2048  lds
    v_mfma_f32_16x16x32_bf16 a[92:95], v[52:55], v[100:103], a[92:95]
    s_add_u32 s71, s71, 1
    s_and_b32 s71, s71, 15
    v_mfma_f32_16x16x32_bf16 a[96:99], v[56:59], v[88:91], a[96:99]
    s_lshl_b32 s69, s71, 7
    s_mul_i32 s70, s71, 458752
    v_mfma_f32_16x16x32_bf16 a[100:103], v[56:59], v[92:95], a[100:103]
    v_mfma_f32_16x16x32_bf16 a[104:107], v[56:59], v[96:99], a[104:107]
    v_mfma_f32_16x16x32_bf16 a[108:111], v[56:59], v[100:103], a[108:111]
    s_waitcnt vmcnt(15) lgkmcnt(0)
    s_barrier
    v_mfma_f32_16x16x32_bf16 a[0:3], v[60:63], v[104:107], a[0:3]
    buffer_load_dwordx2 v[250:251], v124, s[52:55], 0 offen sc1
    ds_read_b128 v[88:91], v22 offset:0
    v_mfma_f32_16x16x32_bf16 a[4:7], v[60:63], v[108:111], a[4:7]
    ds_read_b64_tr_b16 v[32:33], v24 offset:0
    s_add_u32 m0, s73, 0
    v_mfma_f32_16x16x32_bf16 a[8:11], v[60:63], v[112:115], a[8:11]
    buffer_load_dwordx4 v2, s[4:7], s69 offen offset:0  lds
    v_mfma_f32_16x16x32_bf16 a[12:15], v[60:63], v[116:119], a[12:15]
    ds_read_b64_tr_b16 v[34:35], v24 offset:1792
    v_mfma_f32_16x16x32_bf16 a[16:19], v[64:67], v[104:107], a[16:19]
    ds_read_b128 v[92:95], v22 offset:2048
    v_mfma_f32_16x16x32_bf16 a[20:23], v[64:67], v[108:111], a[20:23]
    ds_read_b128 v[96:99], v22 offset:4096
    v_mfma_f32_16x16x32_bf16 a[24:27], v[64:67], v[112:115], a[24:27]
    ds_read_b128 v[100:103], v22 offset:6144
    v_mfma_f32_16x16x32_bf16 a[28:31], v[64:67], v[116:119], a[28:31]
    buffer_load_dwordx4 v3, s[4:7], s69 offen offset:1024  lds
    v_mfma_f32_16x16x32_bf16 a[32:35], v[68:71], v[104:107], a[32:35]
    ds_read_b64_tr_b16 v[36:37], v25 offset:32
    v_mfma_f32_16x16x32_bf16 a[36:39], v[68:71], v[108:111], a[36:39]
    ds_read_b64_tr_b16 v[38:39], v25 offset:1824
    v_mfma_f32_16x16x32_bf16 a[40:43], v[68:71], v[112:115], a[40:43]
    ds_read_b64_tr_b16 v[40:41], v24 offset:64
    v_mfma_f32_16x16x32_bf16 a[44:47], v[68:71], v[116:119], a[44:47]
    ds_read_b64_tr_b16 v[42:43], v24 offset:1856
    v_mfma_f32_16x16x32_bf16 a[48:51], v[72:75], v[104:107], a[48:51]
    buffer_load_dwordx4 v4, s[4:7], s69 offen offset:2048  lds
    v_mfma_f32_16x16x32_bf16 a[52:55], v[72:75], v[108:111], a[52:55]
    ds_read_b64_tr_b16 v[44:45], v25 offset:96
    v_mfma_f32_16x16x32_bf16 a[56:59], v[72:75], v[112:115], a[56:59]
    ds_read_b64_tr_b16 v[46:47], v25 offset:1888
    v_mfma_f32_16x16x32_bf16 a[60:63], v[72:75], v[116:119], a[60:63]
    ds_read_b64_tr_b16 v[48:49], v24 offset:128
    v_mfma_f32_16x16x32_bf16 a[64:67], v[76:79], v[104:107], a[64:67]
    ds_read_b64_tr_b16 v[50:51], v24 offset:1920
    v_mfma_f32_16x16x32_bf16 a[68:71], v[76:79], v[108:111], a[68:71]
    buffer_load_dwordx4 v5, s[4:7], s69 offen offset:3072  lds
    v_mfma_f32_16x16x32_bf16 a[72:75], v[76:79], v[112:115], a[72:75]
    ds_read_b64_tr_b16 v[52:53], v25 offset:160
    v_mfma_f32_16x16x32_bf16 a[76:79], v[76:79], v[116:119], a[76:79]
    ds_read_b64_tr_b16 v[54:55], v25 offset:1952
    v_mfma_f32_16x16x32_bf16 a[80:83], v[80:83], v[104:107], a[80:83]
    ds_read_b64_tr_b16 v[56:57], v26 offset:0
    v_mfma_f32_16x16x32_bf16 a[84:87], v[80:83], v[108:111], a[84:87]
    ds_read_b64_tr_b16 v[58:59], v26 offset:1792
    s_add_u32 m0, s56, 0
    v_mfma_f32_16x16x32_bf16 a[88:91], v[80:83], v[112:115], a[88:91]
    buffer_load_dwordx4 v6, s[8:11], s70 offen offset:0  lds
    v_mfma_f32_16x16x32_bf16 a[92:95], v[80:83], v[116:119], a[92:95]
    v_mfma_f32_16x16x32_bf16 a[96:99], v[84:87], v[104:107], a[96:99]
    v_mfma_f32_16x16x32_bf16 a[100:103], v[84:87], v[108:111], a[100:103]
    v_mfma_f32_16x16x32_bf16 a[104:107], v[84:87], v[112:115], a[104:107]
    buffer_load_dwordx4 v7, s[8:11], s70 offen offset:1024  lds
    v_mfma_f32_16x16x32_bf16 a[108:111], v[84:87], v[116:119], a[108:111]
    s_waitcnt lgkmcnt(0)
    v_mfma_f32_16x16x32_bf16 a[0:3], v[32:35], v[88:91], a[0:3]
    ds_read_b128 v[104:107], v23 offset:0
    v_mfma_f32_16x16x32_bf16 a[4:7], v[32:35], v[92:95], a[4:7]
    ds_read_b64_tr_b16 v[60:61], v24 offset:14336
    s_add_u32 m0, s56, 0
    v_mfma_f32_16x16x32_bf16 a[8:11], v[32:35], v[96:99], a[8:11]
    buffer_load_dwordx4 v8, s[8:11], s70 offen offset:2048  lds
    v_mfma_f32_16x16x32_bf16 a[12:15], v[32:35], v[100:103], a[12:15]
    ds_read_b64_tr_b16 v[62:63], v24 offset:16128
    v_mfma_f32_16x16x32_bf16 a[16:19], v[36:39], v[88:91], a[16:19]
    ds_read_b128 v[108:111], v23 offset:2048
    v_mfma_f32_16x16x32_bf16 a[20:23], v[36:39], v[92:95], a[20:23]
    ds_read_b128 v[112:115], v23 offset:4096
    v_mfma_f32_16x16x32_bf16 a[24:27], v[36:39], v[96:99], a[24:27]
    ds_read_b128 v[116:119], v23 offset:6144
    v_mfma_f32_16x16x32_bf16 a[28:31], v[36:39], v[100:103], a[28:31]
    buffer_load_dwordx4 v9, s[8:11], s70 offen offset:3072  lds
    v_mfma_f32_16x16x32_bf16 a[32:35], v[40:43], v[88:91], a[32:35]
    ds_read_b64_tr_b16 v[64:65], v25 offset:14368
    v_mfma_f32_16x16x32_bf16 a[36:39], v[40:43], v[92:95], a[36:39]
    ds_read_b64_tr_b16 v[66:67], v25 offset:16160
    v_mfma_f32_16x16x32_bf16 a[40:43], v[40:43], v[96:99], a[40:43]
    ds_read_b64_tr_b16 v[68:69], v24 offset:14400
    v_mfma_f32_16x16x32_bf16 a[44:47], v[40:43], v[100:103], a[44:47]
    ds_read_b64_tr_b16 v[70:71], v24 offset:16192
    s_add_u32 m0, s56, 4096
    v_mfma_f32_16x16x32_bf16 a[48:51], v[44:47], v[88:91], a[48:51]
    buffer_load_dwordx4 v10, s[8:11], s70 offen offset:0  lds
    v_mfma_f32_16x16x32_bf16 a[52:55], v[44:47], v[92:95], a[52:55]
    ds_read_b64_tr_b16 v[72:73], v25 offset:14432
    v_mfma_f32_16x16x32_bf16 a[56:59], v[44:47], v[96:99], a[56:59]
    ds_read_b64_tr_b16 v[74:75], v25 offset:16224
    v_mfma_f32_16x16x32_bf16 a[60:63], v[44:47], v[100:103], a[60:63]
    ds_read_b64_tr_b16 v[76:77], v24 offset:14464
    v_mfma_f32_16x16x32_bf16 a[64:67], v[48:51], v[88:91], a[64:67]
    ds_read_b64_tr_b16 v[78:79], v24 offset:16256
    v_mfma_f32_16x16x32_bf16 a[68:71], v[48:51], v[92:95], a[68:71]
    buffer_load_dwordx4 v11, s[8:11], s70 offen offset:1024  lds
    v_mfma_f32_16x16x32_bf16 a[72:75], v[48:51], v[96:99], a[72:75]
    ds_read_b64_tr_b16 v[80:81], v25 offset:14496
    v_mfma_f32_16x16x32_bf16 a[76:79], v[48:51], v[100:103], a[76:79]
    ds_read_b64_tr_b16 v[82:83], v25 offset:16288
    v_mfma_f32_16x16x32_bf16 a[80:83], v[52:55], v[88:91], a[80:83]
    ds_read_b64_tr_b16 v[84:85], v26 offset:14336
    v_mfma_f32_16x16x32_bf16 a[84:87], v[52:55], v[92:95], a[84:87]
    ds_read_b64_tr_b16 v[86:87], v26 offset:16128
    v_mfma_f32_16x16x32_bf16 a[88:91], v[52:55], v[96:99], a[88:91]
    buffer_load_dwordx4 v12, s[8:11], s70 offen offset:2048  lds
    v_mfma_f32_16x16x32_bf16 a[92:95], v[52:55], v[100:103], a[92:95]
    s_add_u32 s71, s71, 1
    s_and_b32 s71, s71, 15
    v_mfma_f32_16x16x32_bf16 a[96:99], v[56:59], v[88:91], a[96:99]
    s_lshl_b32 s69, s71, 7
    s_mul_i32 s70, s71, 458752
    v_mfma_f32_16x16x32_bf16 a[100:103], v[56:59], v[92:95], a[100:103]
    v_mfma_f32_16x16x32_bf16 a[104:107], v[56:59], v[96:99], a[104:107]
    v_mfma_f32_16x16x32_bf16 a[108:111], v[56:59], v[100:103], a[108:111]
    s_cmp_eq_u32 s74, 4
    s_cbranch_scc0 L_csA4
    v_mfma_f32_16x16x32_bf16 a[112:115], v[32:35], v[120:123], 0
    v_mfma_f32_16x16x32_bf16 a[116:119], v[36:39], v[120:123], 0
    v_mfma_f32_16x16x32_bf16 a[120:123], v[40:43], v[120:123], 0
    v_mfma_f32_16x16x32_bf16 a[124:127], v[44:47], v[120:123], 0
    v_mfma_f32_16x16x32_bf16 a[128:131], v[48:51], v[120:123], 0
    v_mfma_f32_16x16x32_bf16 a[132:135], v[52:55], v[120:123], 0
    v_mfma_f32_16x16x32_bf16 a[136:139], v[56:59], v[120:123], 0
L_csA4:
    s_waitcnt vmcnt(12) lgkmcnt(0)
    s_barrier
    v_mfma_f32_16x16x32_bf16 a[0:3], v[60:63], v[104:107], a[0:3]
    ds_read_b128 v[88:91], v27 offset:0
    v_lshlrev_b32 v144, 16, v128
    v_and_b32 v152, 0xffff0000, v128
    v_mfma_f32_16x16x32_bf16 a[4:7], v[60:63], v[108:111], a[4:7]
    ds_read_b64_tr_b16 v[32:33], v29 offset:0
    s_add_u32 m0, s73, 45056
    v_lshlrev_b32 v145, 16, v129
    v_mfma_f32_16x16x32_bf16 a[8:11], v[60:63], v[112:115], a[8:11]
    buffer_load_dwordx4 v2, s[4:7], s69 offen offset:0  lds
    v_and_b32 v153, 0xffff0000, v129
    v_mfma_f32_16x16x32_bf16 a[12:15], v[60:63], v[116:119], a[12:15]
    ds_read_b64_tr_b16 v[34:35], v29 offset:1792
    v_lshlrev_b32 v146, 16, v130
    v_mfma_f32_16x16x32_bf16 a[16:19], v[64:67], v[104:107], a[16:19]
    ds_read_b128 v[92:95], v27 offset:2048
    v_and_b32 v154, 0xffff0000, v130
    v_mfma_f32_16x16x32_bf16 a[20:23], v[64:67], v[108:111], a[20:23]
    ds_read_b128 v[96:99], v27 offset:4096
    v_lshlrev_b32 v147, 16, v131
    v_mfma_f32_16x16x32_bf16 a[24:27], v[64:67], v[112:115], a[24:27]
    ds_read_b128 v[100:103], v27 offset:6144
    v_and_b32 v155, 0xffff0000, v131
    v_mfma_f32_16x16x32_bf16 a[28:31], v[64:67], v[116:119], a[28:31]
    buffer_load_dwordx4 v3, s[4:7], s69 offen offset:1024  lds
    v_lshlrev_b32 v148, 16, v132
    v_mfma_f32_16x16x32_bf16 a[32:35], v[68:71], v[104:107], a[32:35]
    ds_read_b64_tr_b16 v[36:37], v30 offset:32
    v_and_b32 v156, 0xffff0000, v132
    v_lshlrev_b32 v149, 16, v133
    v_mfma_f32_16x16x32_bf16 a[36:39], v[68:71], v[108:111], a[36:39]
    ds_read_b64_tr_b16 v[38:39], v30 offset:1824
    v_and_b32 v157, 0xffff0000, v133
    v_mfma_f32_16x16x32_bf16 a[40:43], v[68:71], v[112:115], a[40:43]
    ds_read_b64_tr_b16 v[40:41], v29 offset:64
    v_lshlrev_b32 v150, 16, v134
    v_mfma_f32_16x16x32_bf16 a[44:47], v[68:71], v[116:119], a[44:47]
    ds_read_b64_tr_b16 v[42:43], v29 offset:1856
    v_and_b32 v158, 0xffff0000, v134
    v_mfma_f32_16x16x32_bf16 a[48:51], v[72:75], v[104:107], a[48:51]
    buffer_load_dwordx4 v4, s[4:7], s69 offen offset:2048  lds
    v_lshlrev_b32 v151, 16, v135
    v_mfma_f32_16x16x32_bf16 a[52:55], v[72:75], v[108:111], a[52:55]
    ds_read_b64_tr_b16 v[44:45], v30 offset:96
    v_and_b32 v159, 0xffff0000, v135
    v_mfma_f32_16x16x32_bf16 a[56:59], v[72:75], v[112:115], a[56:59]
    ds_read_b64_tr_b16 v[46:47], v30 offset:1888
    v_lshlrev_b32 v160, 16, v136
    v_mfma_f32_16x16x32_bf16 a[60:63], v[72:75], v[116:119], a[60:63]
    ds_read_b64_tr_b16 v[48:49], v29 offset:128
    v_and_b32 v168, 0xffff0000, v136
    v_mfma_f32_16x16x32_bf16 a[64:67], v[76:79], v[104:107], a[64:67]
    ds_read_b64_tr_b16 v[50:51], v29 offset:1920
    v_lshlrev_b32 v161, 16, v137
    v_and_b32 v169, 0xffff0000, v137
    v_mfma_f32_16x16x32_bf16 a[68:71], v[76:79], v[108:111], a[68:71]
    buffer_load_dwordx4 v5, s[4:7], s69 offen offset:3072  lds
    v_lshlrev_b32 v162, 16, v138
    v_mfma_f32_16x16x32_bf16 a[72:75], v[76:79], v[112:115], a[72:75]
    ds_read_b64_tr_b16 v[52:53], v30 offset:160
    v_and_b32 v170, 0xffff0000, v138
    v_mfma_f32_16x16x32_bf16 a[76:79], v[76:79], v[116:119], a[76:79]
    ds_read_b64_tr_b16 v[54:55], v30 offset:1952
    v_lshlrev_b32 v163, 16, v139
    v_mfma_f32_16x16x32_bf16 a[80:83], v[80:83], v[104:107], a[80:83]
    ds_read_b64_tr_b16 v[56:57], v31 offset:0
    v_and_b32 v171, 0xffff0000, v139
    v_mfma_f32_16x16x32_bf16 a[84:87], v[80:83], v[108:111], a[84:87]
    ds_read_b64_tr_b16 v[58:59], v31 offset:1792
    s_add_u32 m0, s56, 45056
    v_lshlrev_b32 v164, 16, v140
    v_mfma_f32_16x16x32_bf16 a[88:91], v[80:83], v[112:115], a[88:91]
    buffer_load_dwordx4 v6, s[8:11], s70 offen offset:0  lds
    v_and_b32 v172, 0xffff0000, v140
    v_mfma_f32_16x16x32_bf16 a[92:95], v[80:83], v[116:119], a[92:95]
    v_lshlrev_b32 v165, 16, v141
    v_mfma_f32_16x16x32_bf16 a[96:99], v[84:87], v[104:107], a[96:99]
    v_and_b32 v173, 0xffff0000, v141
    v_mfma_f32_16x16x32_bf16 a[100:103], v[84:87], v[108:111], a[100:103]
    v_lshlrev_b32 v166, 16, v142
    v_and_b32 v174, 0xffff0000, v142
    v_mfma_f32_16x16x32_bf16 a[104:107], v[84:87], v[112:115], a[104:107]
    buffer_load_dwordx4 v7, s[8:11], s70 offen offset:1024  lds
    v_lshlrev_b32 v167, 16, v143
    v_mfma_f32_16x16x32_bf16 a[108:111], v[84:87], v[116:119], a[108:111]
    v_and_b32 v175, 0xffff0000, v143
    s_cmp_eq_u32 s74, 4
    s_cbranch_scc0 L_csB4
    v_mfma_f32_16x16x32_bf16 a[112:115], v[60:63], v[120:123], a[112:115]
    v_mfma_f32_16x16x32_bf16 a[116:119], v[64:67], v[120:123], a[116:119]
    v_mfma_f32_16x16x32_bf16 a[120:123], v[68:71], v[120:123], a[120:123]
    v_mfma_f32_16x16x32_bf16 a[124:127], v[72:75], v[120:123], a[124:127]
    v_mfma_f32_16x16x32_bf16 a[128:131], v[76:79], v[120:123], a[128:131]
    v_mfma_f32_16x16x32_bf16 a[132:135], v[80:83], v[120:123], a[132:135]
    v_mfma_f32_16x16x32_bf16 a[136:139], v[84:87], v[120:123], a[136:139]
L_csB4:
    s_waitcnt lgkmcnt(0)
L_step5:
    v_mfma_f32_16x16x32_bf16 a[0:3], v[32:35], v[88:91], a[0:3]
    ds_read_b128 v[104:107], v28 offset:0
    v_add_f32 v176, v144, v145
    v_mfma_f32_16x16x32_bf16 a[4:7], v[32:35], v[92:95], a[4:7]
    ds_read_b64_tr_b16 v[60:61], v29 offset:14336
    s_add_u32 m0, s56, 45056
    v_add_f32 v177, v160, v161
    v_mfma_f32_16x16x32_bf16 a[8:11], v[32:35], v[96:99], a[8:11]
    buffer_load_dwordx4 v8, s[8:11], s70 offen offset:2048  lds
    v_add_f32 v176, v176, v146
    v_mfma_f32_16x16x32_bf16 a[12:15], v[32:35], v[100:103], a[12:15]
    ds_read_b64_tr_b16 v[62:63], v29 offset:16128
    v_add_f32 v177, v177, v162
    v_mfma_f32_16x16x32_bf16 a[16:19], v[36:39], v[88:91], a[16:19]
    ds_read_b128 v[108:111], v28 offset:2048
    v_add_f32 v176, v176, v147
    v_mfma_f32_16x16x32_bf16 a[20:23], v[36:39], v[92:95], a[20:23]
    ds_read_b128 v[112:115], v28 offset:4096
    v_add_f32 v177, v177, v163
    v_add_f32 v176, v176, v148
    v_mfma_f32_16x16x32_bf16 a[24:27], v[36:39], v[96:99], a[24:27]
    ds_read_b128 v[116:119], v28 offset:6144
    v_add_f32 v177, v177, v164
    v_mfma_f32_16x16x32_bf16 a[28:31], v[36:39], v[100:103], a[28:31]
    buffer_load_dwordx4 v9, s[8:11], s70 offen offset:3072  lds
    v_add_f32 v176, v176, v149
    v_mfma_f32_16x16x32_bf16 a[32:35], v[40:43], v[88:91], a[32:35]
    ds_read_b64_tr_b16 v[64:65], v30 offset:14368
    v_add_f32 v177, v177, v165
    v_mfma_f32_16x16x32_bf16 a[36:39], v[40:43], v[92:95], a[36:39]
    ds_read_b64_tr_b16 v[66:67], v30 offset:16160
    v_add_f32 v176, v176, v150
    v_mfma_f32_16x16x32_bf16 a[40:43], v[40:43], v[96:99], a[40:43]
    ds_read_b64_tr_b16 v[68:69], v29 offset:14400
    v_add_f32 v177, v177, v166
    v_mfma_f32_16x16x32_bf16 a[44:47], v[40:43], v[100:103], a[44:47]
    ds_read_b64_tr_b16 v[70:71], v29 offset:16192
    s_add_u32 m0, s56, 49152
    v_add_f32 v176, v176, v151
    v_mfma_f32_16x16x32_bf16 a[48:51], v[44:47], v[88:91], a[48:51]
    buffer_load_dwordx4 v10, s[8:11], s70 offen offset:0  lds
    v_add_f32 v177, v177, v167
    v_mfma_f32_16x16x32_bf16 a[52:55], v[44:47], v[92:95], a[52:55]
    ds_read_b64_tr_b16 v[72:73], v30 offset:14432
    v_add_f32 v176, v176, v152
    v_mfma_f32_16x16x32_bf16 a[56:59], v[44:47], v[96:99], a[56:59]
    ds_read_b64_tr_b16 v[74:75], v30 offset:16224
    v_add_f32 v177, v177, v168
    v_add_f32 v176, v176, v153
    v_mfma_f32_16x16x32_bf16 a[60:63], v[44:47], v[100:103], a[60:63]
    ds_read_b64_tr_b16 v[76:77], v29 offset:14464
    v_add_f32 v177, v177, v169
    v_mfma_f32_16x16x32_bf16 a[64:67], v[48:51], v[88:91], a[64:67]
    ds_read_b64_tr_b16 v[78:79], v29 offset:16256
    v_add_f32 v176, v176, v154
    v_mfma_f32_16x16x32_bf16 a[68:71], v[48:51], v[92:95], a[68:71]
    buffer_load_dwordx4 v11, s[8:11], s70 offen offset:1024  lds
    v_add_f32 v177, v177, v170
    v_mfma_f32_16x16x32_bf16 a[72:75], v[48:51], v[96:99], a[72:75]
    ds_read_b64_tr_b16 v[80:81], v30 offset:14496
    v_add_f32 v176, v176, v155
    v_mfma_f32_16x16x32_bf16 a[76:79], v[48:51], v[100:103], a[76:79]
    ds_read_b64_tr_b16 v[82:83], v30 offset:16288
    v_add_f32 v177, v177, v171
    v_mfma_f32_16x16x32_bf16 a[80:83], v[52:55], v[88:91], a[80:83]
    ds_read_b64_tr_b16 v[84:85], v31 offset:14336
    v_add_f32 v176, v176, v156
    v_mfma_f32_16x16x32_bf16 a[84:87], v[52:55], v[92:95], a[84:87]
    ds_read_b64_tr_b16 v[86:87], v31 offset:16128
    v_add_f32 v177, v177, v172
    v_mfma_f32_16x16x32_bf16 a[88:91], v[52:55], v[96:99], a[88:91]
    buffer_load_dwordx4 v12, s[8:11], s70 offen offset:2048  lds
    v_add_f32 v176, v176, v157
    v_add_f32 v177, v177, v173
    v_mfma_f32_16x16x32_bf16 a[92:95], v[52:55], v[100:103], a[92:95]
    s_add_u32 s71, s71, 1
    s_and_b32 s71, s71, 15
    v_add_f32 v176, v176, v158
    v_mfma_f32_16x16x32_bf16 a[96:99], v[56:59], v[88:91], a[96:99]
    s_lshl_b32 s69, s71, 7
    s_mul_i32 s70, s71, 458752
    v_add_f32 v177, v177, v174
    v_mfma_f32_16x16x32_bf16 a[100:103], v[56:59], v[92:95], a[100:103]
    v_add_f32 v176, v176, v159
    v_mfma_f32_16x16x32_bf16 a[104:107], v[56:59], v[96:99], a[104:107]
    v_add_f32 v177, v177, v175
    v_mfma_f32_16x16x32_bf16 a[108:111], v[56:59], v[100:103], a[108:111]
    s_nop 0
    s_waitcnt vmcnt(11) lgkmcnt(0)
    s_barrier
    s_cmp_eq_u32 s74, 4
    s_cbranch_scc0 L_css5
    s_cmp_lt_u32 s66, 2
    s_cbranch_scc0 L_css5
    v_lshrrev_b32 v240, 4, v1
    v_lshlrev_b32 v240, 4, v240
    s_lshl_b32 s76, s65, 4
    s_add_u32 s76, s76, s64
    s_mul_i32 s76, s76, 896
    s_add_u32 s76, s76, 33619968
    s_lshl_b32 s77, s68, 9
    s_add_u32 s77, s77, s76
    s_lshl_b32 s78, s68, 6
    s_add_u32 s78, s78, s76
    s_mov_b32 exec_lo, 0x00010001
    s_mov_b32 exec_hi, 0x00010001
    buffer_store_dwordx4 a[112:115], v240, s[12:15], s77 offen offset:0 sc1
    buffer_store_dwordx4 a[116:119], v240, s[12:15], s77 offen offset:64 sc1
    buffer_store_dwordx4 a[120:123], v240, s[12:15], s77 offen offset:128 sc1
    buffer_store_dwordx4 a[124:127], v240, s[12:15], s77 offen offset:192 sc1
    buffer_store_dwordx4 a[128:131], v240, s[12:15], s77 offen offset:256 sc1
    buffer_store_dwordx4 a[132:135], v240, s[12:15], s77 offen offset:320 sc1
    buffer_store_dwordx4 a[136:139], v240, s[12:15], s78 offen offset:384 sc1
    s_mov_b64 exec, -1
L_css5:
    v_mfma_f32_16x16x32_bf16 a[0:3], v[60:63], v[104:107], a[0:3]
    ds_read_b128 v[88:91], v17 offset:0
    v_add_f32_dpp v176, v176, v176 row_shr:1 row_mask:0xf bank_mask:0xf bound_ctrl:1
    v_mfma_f32_16x16x32_bf16 a[4:7], v[60:63], v[108:111], a[4:7]
    ds_read_b64_tr_b16 v[32:33], v19 offset:0
    s_add_u32 m0, s73, 90112
    v_add_f32_dpp v177, v177, v177 row_shr:1 row_mask:0xf bank_mask:0xf bound_ctrl:1
    v_mfma_f32_16x16x32_bf16 a[8:11], v[60:63], v[112:115], a[8:11]
    buffer_load_dwordx4 v2, s[4:7], s69 offen offset:0  lds
    s_nop 0
    v_add_f32_dpp v176, v176, v176 row_shr:2 row_mask:0xf bank_mask:0xf bound_ctrl:1
    v_mfma_f32_16x16x32_bf16 a[12:15], v[60:63], v[116:119], a[12:15]
    ds_read_b64_tr_b16 v[34:35], v19 offset:1792
    v_add_f32_dpp v177, v177, v177 row_shr:2 row_mask:0xf bank_mask:0xf bound_ctrl:1
    v_mfma_f32_16x16x32_bf16 a[16:19], v[64:67], v[104:107], a[16:19]
    ds_read_b128 v[92:95], v17 offset:2048
    s_nop 0
    v_mfma_f32_16x16x32_bf16 a[20:23], v[64:67], v[108:111], a[20:23]
    ds_read_b128 v[96:99], v17 offset:4096
    v_add_f32_dpp v176, v176, v176 row_shr:4 row_mask:0xf bank_mask:0xf bound_ctrl:1
    v_mfma_f32_16x16x32_bf16 a[24:27], v[64:67], v[112:115], a[24:27]
    ds_read_b128 v[100:103], v17 offset:6144
    v_add_f32_dpp v177, v177, v177 row_shr:4 row_mask:0xf bank_mask:0xf bound_ctrl:1
    v_mfma_f32_16x16x32_bf16 a[28:31], v[64:67], v[116:119], a[28:31]
    buffer_load_dwordx4 v3, s[4:7], s69 offen offset:1024  lds
    s_nop 0
    v_mfma_f32_16x16x32_bf16 a[32:35], v[68:71], v[104:107], a[32:35]
    ds_read_b64_tr_b16 v[36:37], v20 offset:32
    v_add_f32_dpp v176, v176, v176 row_shr:8 row_mask:0xf bank_mask:0xf bound_ctrl:1
    v_mfma_f32_16x16x32_bf16 a[36:39], v[68:71], v[108:111], a[36:39]
    ds_read_b64_tr_b16 v[38:39], v20 offset:1824
    v_add_f32_dpp v177, v177, v177 row_shr:8 row_mask:0xf bank_mask:0xf bound_ctrl:1
    v_mfma_f32_16x16x32_bf16 a[40:43], v[68:71], v[112:115], a[40:43]
    ds_read_b64_tr_b16 v[40:41], v19 offset:64
    s_nop 0
    v_mfma_f32_16x16x32_bf16 a[44:47], v[68:71], v[116:119], a[44:47]
    ds_read_b64_tr_b16 v[42:43], v19 offset:1856
    v_add_f32_dpp v176, v176, v176 row_bcast:15 row_mask:0xa bank_mask:0xf
    v_add_f32_dpp v177, v177, v177 row_bcast:15 row_mask:0xa bank_mask:0xf
    v_mfma_f32_16x16x32_bf16 a[48:51], v[72:75], v[104:107], a[48:51]
    buffer_load_dwordx4 v4, s[4:7], s69 offen offset:2048  lds
    s_nop 0
    v_mfma_f32_16x16x32_bf16 a[52:55], v[72:75], v[108:111], a[52:55]
    ds_read_b64_tr_b16 v[44:45], v20 offset:96
    v_add_f32_dpp v176, v176, v176 row_bcast:31 row_mask:0xc bank_mask:0xf
    v_mfma_f32_16x16x32_bf16 a[56:59], v[72:75], v[112:115], a[56:59]
    ds_read_b64_tr_b16 v[46:47], v20 offset:1888
    v_add_f32_dpp v177, v177, v177 row_bcast:31 row_mask:0xc bank_mask:0xf
    v_mfma_f32_16x16x32_bf16 a[60:63], v[72:75], v[116:119], a[60:63]
    ds_read_b64_tr_b16 v[48:49], v19 offset:128
    s_nop 0
    v_mfma_f32_16x16x32_bf16 a[64:67], v[76:79], v[104:107], a[64:67]
    ds_read_b64_tr_b16 v[50:51], v19 offset:1920
    v_readlane_b32 s82, v176, 63
    v_mfma_f32_16x16x32_bf16 a[68:71], v[76:79], v[108:111], a[68:71]
    buffer_load_dwordx4 v5, s[4:7], s69 offen offset:3072  lds
    v_readlane_b32 s83, v177, 63
    v_mfma_f32_16x16x32_bf16 a[72:75], v[76:79], v[112:115], a[72:75]
    ds_read_b64_tr_b16 v[52:53], v20 offset:160
    v_mov_b32 v182, 0x3a800000
    v_mfma_f32_16x16x32_bf16 a[76:79], v[76:79], v[116:119], a[76:79]
    ds_read_b64_tr_b16 v[54:55], v20 offset:1952
    v_mov_b32 v183, 0x3727c5ac
    v_mul_f32 v184, s82, v182
    v_mfma_f32_16x16x32_bf16 a[80:83], v[80:83], v[104:107], a[80:83]
    ds_read_b64_tr_b16 v[56:57], v21 offset:0
    v_mul_f32 v186, s83, v182
    v_mfma_f32_16x16x32_bf16 a[84:87], v[80:83], v[108:111], a[84:87]
    ds_read_b64_tr_b16 v[58:59], v21 offset:1792
    s_add_u32 m0, s56, 90112
    v_sub_f32 v144, v144, v184
    v_mfma_f32_16x16x32_bf16 a[88:91], v[80:83], v[112:115], a[88:91]
    buffer_load_dwordx4 v6, s[8:11], s70 offen offset:0  lds
    v_sub_f32 v145, v145, v184
    v_mfma_f32_16x16x32_bf16 a[92:95], v[80:83], v[116:119], a[92:95]
    v_sub_f32 v146, v146, v184
    v_mfma_f32_16x16x32_bf16 a[96:99], v[84:87], v[104:107], a[96:99]
    v_sub_f32 v147, v147, v184
    v_mfma_f32_16x16x32_bf16 a[100:103], v[84:87], v[108:111], a[100:103]
    v_sub_f32 v148, v148, v184
    v_mfma_f32_16x16x32_bf16 a[104:107], v[84:87], v[112:115], a[104:107]
    buffer_load_dwordx4 v7, s[8:11], s70 offen offset:1024  lds
    v_sub_f32 v149, v149, v184
    v_mfma_f32_16x16x32_bf16 a[108:111], v[84:87], v[116:119], a[108:111]
    v_sub_f32 v150, v150, v184
    s_waitcnt lgkmcnt(0)
    v_mfma_f32_16x16x32_bf16 a[0:3], v[32:35], v[88:91], a[0:3]
    ds_read_b128 v[104:107], v18 offset:0
    v_sub_f32 v151, v151, v184
    v_sub_f32 v152, v152, v184
    v_mfma_f32_16x16x32_bf16 a[4:7], v[32:35], v[92:95], a[4:7]
    ds_read_b64_tr_b16 v[60:61], v19 offset:14336
    s_add_u32 m0, s56, 90112
    v_sub_f32 v153, v153, v184
    v_mfma_f32_16x16x32_bf16 a[8:11], v[32:35], v[96:99], a[8:11]
    buffer_load_dwordx4 v8, s[8:11], s70 offen offset:2048  lds
    v_sub_f32 v154, v154, v184
    s_lshr_b32 s81, s2, 3
    v_mfma_f32_16x16x32_bf16 a[12:15], v[32:35], v[100:103], a[12:15]
    ds_read_b64_tr_b16 v[62:63], v19 offset:16128
    v_sub_f32 v155, v155, v184
    s_lshl_b32 s81, s81, 2
    v_mfma_f32_16x16x32_bf16 a[16:19], v[36:39], v[88:91], a[16:19]
    ds_read_b128 v[108:111], v18 offset:2048
    v_sub_f32 v156, v156, v184
    v_mfma_f32_16x16x32_bf16 a[20:23], v[36:39], v[92:95], a[20:23]
    ds_read_b128 v[112:115], v18 offset:4096
    v_sub_f32 v157, v157, v184
    s_add_u32 s81, s81, s66
    v_mfma_f32_16x16x32_bf16 a[24:27], v[36:39], v[96:99], a[24:27]
    ds_read_b128 v[116:119], v18 offset:6144
    v_sub_f32 v158, v158, v184
    v_mfma_f32_16x16x32_bf16 a[28:31], v[36:39], v[100:103], a[28:31]
    buffer_load_dwordx4 v9, s[8:11], s70 offen offset:3072  lds
    v_sub_f32 v159, v159, v184
    s_lshl_b32 s81, s81, 8
    v_mfma_f32_16x16x32_bf16 a[32:35], v[40:43], v[88:91], a[32:35]
    ds_read_b64_tr_b16 v[64:65], v20 offset:14368
    v_sub_f32 v160, v160, v186
    v_sub_f32 v161, v161, v186
    v_mfma_f32_16x16x32_bf16 a[36:39], v[40:43], v[92:95], a[36:39]
    ds_read_b64_tr_b16 v[66:67], v20 offset:16160
    v_sub_f32 v162, v162, v186
    v_mfma_f32_16x16x32_bf16 a[40:43], v[40:43], v[96:99], a[40:43]
    ds_read_b64_tr_b16 v[68:69], v19 offset:14400
    v_sub_f32 v163, v163, v186
    s_add_u32 s81, s81, (L_step10-L_pc)
    v_mfma_f32_16x16x32_bf16 a[44:47], v[40:43], v[100:103], a[44:47]
    ds_read_b64_tr_b16 v[70:71], v19 offset:16192
    s_add_u32 m0, s56, 94208
    v_sub_f32 v164, v164, v186
    v_mfma_f32_16x16x32_bf16 a[48:51], v[44:47], v[88:91], a[48:51]
    buffer_load_dwordx4 v10, s[8:11], s70 offen offset:0  lds
    v_sub_f32 v165, v165, v186
    v_and_b32 v236, 1, v1
    v_mfma_f32_16x16x32_bf16 a[52:55], v[44:47], v[92:95], a[52:55]
    ds_read_b64_tr_b16 v[72:73], v20 offset:14432
    v_sub_f32 v166, v166, v186
    v_mfma_f32_16x16x32_bf16 a[56:59], v[44:47], v[96:99], a[56:59]
    ds_read_b64_tr_b16 v[74:75], v20 offset:16224
    v_sub_f32 v167, v167, v186
    v_lshl_add_u32 v236, v236, 7, s81
    v_mfma_f32_16x16x32_bf16 a[60:63], v[44:47], v[100:103], a[60:63]
    ds_read_b64_tr_b16 v[76:77], v19 offset:14464
    v_sub_f32 v168, v168, v186
    v_mfma_f32_16x16x32_bf16 a[64:67], v[48:51], v[88:91], a[64:67]
    ds_read_b64_tr_b16 v[78:79], v19 offset:16256
    v_sub_f32 v169, v169, v186
    v_sub_f32 v170, v170, v186
    v_mfma_f32_16x16x32_bf16 a[68:71], v[48:51], v[92:95], a[68:71]
    buffer_load_dwordx4 v11, s[8:11], s70 offen offset:1024  lds
    v_sub_f32 v171, v171, v186
    v_min_u32 v236, (L_g1end-L_pc), v236
    v_mfma_f32_16x16x32_bf16 a[72:75], v[48:51], v[96:99], a[72:75]
    ds_read_b64_tr_b16 v[80:81], v20 offset:14496
    v_sub_f32 v172, v172, v186
    v_mfma_f32_16x16x32_bf16 a[76:79], v[48:51], v[100:103], a[76:79]
    ds_read_b64_tr_b16 v[82:83], v20 offset:16288
    v_sub_f32 v173, v173, v186
    v_mov_b32 v239, s59
    v_mfma_f32_16x16x32_bf16 a[80:83], v[52:55], v[88:91], a[80:83]
    ds_read_b64_tr_b16 v[84:85], v21 offset:14336
    v_sub_f32 v174, v174, v186
    v_mfma_f32_16x16x32_bf16 a[84:87], v[52:55], v[92:95], a[84:87]
    ds_read_b64_tr_b16 v[86:87], v21 offset:16128
    v_sub_f32 v175, v175, v186
    v_add_co_u32 v238, vcc, s58, v236
    s_nop 1
    v_addc_co_u32 v239, vcc, 0, v239, vcc
    v_mfma_f32_16x16x32_bf16 a[88:91], v[52:55], v[96:99], a[88:91]
    buffer_load_dwordx4 v12, s[8:11], s70 offen offset:2048  lds
    v_mul_f32 v176, v144, v144
    v_mfma_f32_16x16x32_bf16 a[92:95], v[52:55], v[100:103], a[92:95]
    s_add_u32 s71, s71, 1
    s_and_b32 s71, s71, 15
    v_mul_f32 v177, v160, v160
    s_mov_b64 exec, 3
    global_load_dword v127, v[238:239], off
    s_mov_b64 exec, -1
    v_mfma_f32_16x16x32_bf16 a[96:99], v[56:59], v[88:91], a[96:99]
    s_lshl_b32 s69, s71, 7
    s_mul_i32 s70, s71, 458752
    v_fmac_f32 v176, v145, v145
    v_mfma_f32_16x16x32_bf16 a[100:103], v[56:59], v[92:95], a[100:103]
    v_fmac_f32 v177, v161, v161
    v_fmac_f32 v176, v146, v146
    v_mfma_f32_16x16x32_bf16 a[104:107], v[56:59], v[96:99], a[104:107]
    v_fmac_f32 v177, v162, v162
    v_mfma_f32_16x16x32_bf16 a[108:111], v[56:59], v[100:103], a[108:111]
    v_fmac_f32 v176, v147, v147
    s_waitcnt vmcnt(12) lgkmcnt(0)
    s_barrier
    v_mfma_f32_16x16x32_bf16 a[0:3], v[60:63], v[104:107], a[0:3]
    ds_read_b128 v[88:91], v22 offset:0
    v_fmac_f32 v177, v163, v163
    v_mfma_f32_16x16x32_bf16 a[4:7], v[60:63], v[108:111], a[4:7]
    ds_read_b64_tr_b16 v[32:33], v24 offset:0
    s_add_u32 m0, s73, 0
    v_fmac_f32 v176, v148, v148
    v_mfma_f32_16x16x32_bf16 a[8:11], v[60:63], v[112:115], a[8:11]
    buffer_load_dwordx4 v2, s[4:7], s69 offen offset:0  lds
    v_fmac_f32 v177, v164, v164
    v_mfma_f32_16x16x32_bf16 a[12:15], v[60:63], v[116:119], a[12:15]
    ds_read_b64_tr_b16 v[34:35], v24 offset:1792
    v_fmac_f32 v176, v149, v149
    v_mfma_f32_16x16x32_bf16 a[16:19], v[64:67], v[104:107], a[16:19]
    ds_read_b128 v[92:95], v22 offset:2048
    v_fmac_f32 v177, v165, v165
    v_mfma_f32_16x16x32_bf16 a[20:23], v[64:67], v[108:111], a[20:23]
    ds_read_b128 v[96:99], v22 offset:4096
    v_fmac_f32 v176, v150, v150
    v_fmac_f32 v177, v166, v166
    v_mfma_f32_16x16x32_bf16 a[24:27], v[64:67], v[112:115], a[24:27]
    ds_read_b128 v[100:103], v22 offset:6144
    v_fmac_f32 v176, v151, v151
    v_mfma_f32_16x16x32_bf16 a[28:31], v[64:67], v[116:119], a[28:31]
    buffer_load_dwordx4 v3, s[4:7], s69 offen offset:1024  lds
    v_fmac_f32 v177, v167, v167
    v_mfma_f32_16x16x32_bf16 a[32:35], v[68:71], v[104:107], a[32:35]
    ds_read_b64_tr_b16 v[36:37], v25 offset:32
    v_fmac_f32 v176, v152, v152
    v_mfma_f32_16x16x32_bf16 a[36:39], v[68:71], v[108:111], a[36:39]
    ds_read_b64_tr_b16 v[38:39], v25 offset:1824
    v_fmac_f32 v177, v168, v168
    v_mfma_f32_16x16x32_bf16 a[40:43], v[68:71], v[112:115], a[40:43]
    ds_read_b64_tr_b16 v[40:41], v24 offset:64
    v_fmac_f32 v176, v153, v153
    v_mfma_f32_16x16x32_bf16 a[44:47], v[68:71], v[116:119], a[44:47]
    ds_read_b64_tr_b16 v[42:43], v24 offset:1856
    v_fmac_f32 v177, v169, v169
    v_mfma_f32_16x16x32_bf16 a[48:51], v[72:75], v[104:107], a[48:51]
    buffer_load_dwordx4 v4, s[4:7], s69 offen offset:2048  lds
    v_fmac_f32 v176, v154, v154
    v_mfma_f32_16x16x32_bf16 a[52:55], v[72:75], v[108:111], a[52:55]
    ds_read_b64_tr_b16 v[44:45], v25 offset:96
    v_fmac_f32 v177, v170, v170
    v_mfma_f32_16x16x32_bf16 a[56:59], v[72:75], v[112:115], a[56:59]
    ds_read_b64_tr_b16 v[46:47], v25 offset:1888
    v_fmac_f32 v176, v155, v155
    v_fmac_f32 v177, v171, v171
    v_mfma_f32_16x16x32_bf16 a[60:63], v[72:75], v[116:119], a[60:63]
    ds_read_b64_tr_b16 v[48:49], v24 offset:128
    v_fmac_f32 v176, v156, v156
    v_mfma_f32_16x16x32_bf16 a[64:67], v[76:79], v[104:107], a[64:67]
    ds_read_b64_tr_b16 v[50:51], v24 offset:1920
    v_fmac_f32 v177, v172, v172
    v_mfma_f32_16x16x32_bf16 a[68:71], v[76:79], v[108:111], a[68:71]
    buffer_load_dwordx4 v5, s[4:7], s69 offen offset:3072  lds
    v_fmac_f32 v176, v157, v157
    v_mfma_f32_16x16x32_bf16 a[72:75], v[76:79], v[112:115], a[72:75]
    ds_read_b64_tr_b16 v[52:53], v25 offset:160
    v_fmac_f32 v177, v173, v173
    v_mfma_f32_16x16x32_bf16 a[76:79], v[76:79], v[116:119], a[76:79]
    ds_read_b64_tr_b16 v[54:55], v25 offset:1952
    v_fmac_f32 v176, v158, v158
    v_mfma_f32_16x16x32_bf16 a[80:83], v[80:83], v[104:107], a[80:83]
    ds_read_b64_tr_b16 v[56:57], v26 offset:0
    v_fmac_f32 v177, v174, v174
    v_mfma_f32_16x16x32_bf16 a[84:87], v[80:83], v[108:111], a[84:87]
    ds_read_b64_tr_b16 v[58:59], v26 offset:1792
    s_add_u32 m0, s56, 0
    v_fmac_f32 v176, v159, v159
    v_mfma_f32_16x16x32_bf16 a[88:91], v[80:83], v[112:115], a[88:91]
    buffer_load_dwordx4 v6, s[8:11], s70 offen offset:0  lds
    v_fmac_f32 v177, v175, v175
    s_nop 0
    v_mfma_f32_16x16x32_bf16 a[92:95], v[80:83], v[116:119], a[92:95]
    v_add_f32_dpp v176, v176, v176 row_shr:1 row_mask:0xf bank_mask:0xf bound_ctrl:1
    v_mfma_f32_16x16x32_bf16 a[96:99], v[84:87], v[104:107], a[96:99]
    v_add_f32_dpp v177, v177, v177 row_shr:1 row_mask:0xf bank_mask:0xf bound_ctrl:1
    v_mfma_f32_16x16x32_bf16 a[100:103], v[84:87], v[108:111], a[100:103]
    s_nop 0
    v_mfma_f32_16x16x32_bf16 a[104:107], v[84:87], v[112:115], a[104:107]
    buffer_load_dwordx4 v7, s[8:11], s70 offen offset:1024  lds
    v_add_f32_dpp v176, v176, v176 row_shr:2 row_mask:0xf bank_mask:0xf bound_ctrl:1
    v_mfma_f32_16x16x32_bf16 a[108:111], v[84:87], v[116:119], a[108:111]
    v_add_f32_dpp v177, v177, v177 row_shr:2 row_mask:0xf bank_mask:0xf bound_ctrl:1
    s_waitcnt lgkmcnt(0)
    v_mfma_f32_16x16x32_bf16 a[0:3], v[32:35], v[88:91], a[0:3]
    ds_read_b128 v[104:107], v23 offset:0
    s_nop 0
    v_mfma_f32_16x16x32_bf16 a[4:7], v[32:35], v[92:95], a[4:7]
    ds_read_b64_tr_b16 v[60:61], v24 offset:14336
    s_add_u32 m0, s56, 0
    v_add_f32_dpp v176, v176, v176 row_shr:4 row_mask:0xf bank_mask:0xf bound_ctrl:1
    v_mfma_f32_16x16x32_bf16 a[8:11], v[32:35], v[96:99], a[8:11]
    buffer_load_dwordx4 v8, s[8:11], s70 offen offset:2048  lds
    v_add_f32_dpp v177, v177, v177 row_shr:4 row_mask:0xf bank_mask:0xf bound_ctrl:1
    s_nop 0
    v_mfma_f32_16x16x32_bf16 a[12:15], v[32:35], v[100:103], a[12:15]
    ds_read_b64_tr_b16 v[62:63], v24 offset:16128
    v_add_f32_dpp v176, v176, v176 row_shr:8 row_mask:0xf bank_mask:0xf bound_ctrl:1
    v_mfma_f32_16x16x32_bf16 a[16:19], v[36:39], v[88:91], a[16:19]
    ds_read_b128 v[108:111], v23 offset:2048
    v_add_f32_dpp v177, v177, v177 row_shr:8 row_mask:0xf bank_mask:0xf bound_ctrl:1
    v_mfma_f32_16x16x32_bf16 a[20:23], v[36:39], v[92:95], a[20:23]
    ds_read_b128 v[112:115], v23 offset:4096
    s_nop 0
    v_mfma_f32_16x16x32_bf16 a[24:27], v[36:39], v[96:99], a[24:27]
    ds_read_b128 v[116:119], v23 offset:6144
    v_add_f32_dpp v176, v176, v176 row_bcast:15 row_mask:0xa bank_mask:0xf
    v_mfma_f32_16x16x32_bf16 a[28:31], v[36:39], v[100:103], a[28:31]
    buffer_load_dwordx4 v9, s[8:11], s70 offen offset:3072  lds
    v_add_f32_dpp v177, v177, v177 row_bcast:15 row_mask:0xa bank_mask:0xf
    v_mfma_f32_16x16x32_bf16 a[32:35], v[40:43], v[88:91], a[32:35]
    ds_read_b64_tr_b16 v[64:65], v25 offset:14368
    s_nop 0
    v_mfma_f32_16x16x32_bf16 a[36:39], v[40:43], v[92:95], a[36:39]
    ds_read_b64_tr_b16 v[66:67], v25 offset:16160
    v_add_f32_dpp v176, v176, v176 row_bcast:31 row_mask:0xc bank_mask:0xf
    v_mfma_f32_16x16x32_bf16 a[40:43], v[40:43], v[96:99], a[40:43]
    ds_read_b64_tr_b16 v[68:69], v24 offset:14400
    v_add_f32_dpp v177, v177, v177 row_bcast:31 row_mask:0xc bank_mask:0xf
    v_mfma_f32_16x16x32_bf16 a[44:47], v[40:43], v[100:103], a[44:47]
    ds_read_b64_tr_b16 v[70:71], v24 offset:16192
    s_add_u32 m0, s56, 4096
    s_nop 0
    v_readlane_b32 s82, v176, 63
    v_mfma_f32_16x16x32_bf16 a[48:51], v[44:47], v[88:91], a[48:51]
    buffer_load_dwordx4 v10, s[8:11], s70 offen offset:0  lds
    v_readlane_b32 s83, v177, 63
    v_mfma_f32_16x16x32_bf16 a[52:55], v[44:47], v[92:95], a[52:55]
    ds_read_b64_tr_b16 v[72:73], v25 offset:14432
    v_and_b32 v190, 1, v1
    v_mfma_f32_16x16x32_bf16 a[56:59], v[44:47], v[96:99], a[56:59]
    ds_read_b64_tr_b16 v[74:75], v25 offset:16224
    v_cmp_eq_u32 vcc, 1, v190
    v_mov_b32 v191, s82
    v_mov_b32 v190, s83
    v_cndmask_b32 v191, v191, v190, vcc
    v_cndmask_b32 v192, v184, v186, vcc
    v_mfma_f32_16x16x32_bf16 a[60:63], v[44:47], v[100:103], a[60:63]
    ds_read_b64_tr_b16 v[76:77], v24 offset:14464
    v_mul_f32 v191, v191, v182
    v_mfma_f32_16x16x32_bf16 a[64:67], v[48:51], v[88:91], a[64:67]
    ds_read_b64_tr_b16 v[78:79], v24 offset:16256
    v_add_f32 v190, v191, v183
    v_mfma_f32_16x16x32_bf16 a[68:71], v[48:51], v[92:95], a[68:71]
    buffer_load_dwordx4 v11, s[8:11], s70 offen offset:1024  lds
    v_rsq_f32 v193, v190
    v_mfma_f32_16x16x32_bf16 a[72:75], v[48:51], v[96:99], a[72:75]
    ds_read_b64_tr_b16 v[80:81], v25 offset:14496
    s_nop 0
    v_mfma_f32_16x16x32_bf16 a[76:79], v[48:51], v[100:103], a[76:79]
    ds_read_b64_tr_b16 v[82:83], v25 offset:16288
    v_mul_f32 v190, v193, v193
    v_fma_f32 v190, v191, v190, v183
    v_mfma_f32_16x16x32_bf16 a[80:83], v[52:55], v[88:91], a[80:83]
    ds_read_b64_tr_b16 v[84:85], v26 offset:14336
    v_rsq_f32 v190, v190
    v_mfma_f32_16x16x32_bf16 a[84:87], v[52:55], v[92:95], a[84:87]
    ds_read_b64_tr_b16 v[86:87], v26 offset:16128
    s_nop 0
    v_mfma_f32_16x16x32_bf16 a[88:91], v[52:55], v[96:99], a[88:91]
    buffer_load_dwordx4 v12, s[8:11], s70 offen offset:2048  lds
    v_mul_f32 v194, v193, v190
    v_mfma_f32_16x16x32_bf16 a[92:95], v[52:55], v[100:103], a[92:95]
    s_add_u32 s71, s71, 1
    s_and_b32 s71, s71, 15
    v_mul_f32 v195, v194, v192
    v_mfma_f32_16x16x32_bf16 a[96:99], v[56:59], v[88:91], a[96:99]
    s_lshl_b32 s69, s71, 7
    s_mul_i32 s70, s71, 458752
    s_lshl_b32 s82, s87, 4
    v_mfma_f32_16x16x32_bf16 a[100:103], v[56:59], v[92:95], a[100:103]
    s_add_u32 s82, s82, 33554432
    v_mfma_f32_16x16x32_bf16 a[104:107], v[56:59], v[96:99], a[104:107]
    v_lshlrev_b32 v191, 4, v1
    v_mfma_f32_16x16x32_bf16 a[108:111], v[56:59], v[100:103], a[108:111]
    s_mov_b64 exec, 3
    buffer_store_dwordx4 v[192:195], v191, s[12:15], s82 offen sc1
    s_mov_b64 exec, -1
    s_waitcnt vmcnt(13) lgkmcnt(0)
    s_barrier
    v_mfma_f32_16x16x32_bf16 a[0:3], v[60:63], v[104:107], a[0:3]
    ds_read_b128 v[88:91], v27 offset:0
    v_mfma_f32_16x16x32_bf16 a[4:7], v[60:63], v[108:111], a[4:7]
    ds_read_b64_tr_b16 v[32:33], v29 offset:0
    s_add_u32 m0, s73, 45056
    v_mfma_f32_16x16x32_bf16 a[8:11], v[60:63], v[112:115], a[8:11]
    buffer_load_dwordx4 v2, s[4:7], s69 offen offset:0  lds
    v_mfma_f32_16x16x32_bf16 a[12:15], v[60:63], v[116:119], a[12:15]
    ds_read_b64_tr_b16 v[34:35], v29 offset:1792
    v_mfma_f32_16x16x32_bf16 a[16:19], v[64:67], v[104:107], a[16:19]
    ds_read_b128 v[92:95], v27 offset:2048
    v_mfma_f32_16x16x32_bf16 a[20:23], v[64:67], v[108:111], a[20:23]
    ds_read_b128 v[96:99], v27 offset:4096
    v_mfma_f32_16x16x32_bf16 a[24:27], v[64:67], v[112:115], a[24:27]
    ds_read_b128 v[100:103], v27 offset:6144
    v_mfma_f32_16x16x32_bf16 a[28:31], v[64:67], v[116:119], a[28:31]
    buffer_load_dwordx4 v3, s[4:7], s69 offen offset:1024  lds
    v_mfma_f32_16x16x32_bf16 a[32:35], v[68:71], v[104:107], a[32:35]
    ds_read_b64_tr_b16 v[36:37], v30 offset:32
    v_mfma_f32_16x16x32_bf16 a[36:39], v[68:71], v[108:111], a[36:39]
    ds_read_b64_tr_b16 v[38:39], v30 offset:1824
    v_mfma_f32_16x16x32_bf16 a[40:43], v[68:71], v[112:115], a[40:43]
    ds_read_b64_tr_b16 v[40:41], v29 offset:64
    v_mfma_f32_16x16x32_bf16 a[44:47], v[68:71], v[116:119], a[44:47]
    ds_read_b64_tr_b16 v[42:43], v29 offset:1856
    v_mfma_f32_16x16x32_bf16 a[48:51], v[72:75], v[104:107], a[48:51]
    buffer_load_dwordx4 v4, s[4:7], s69 offen offset:2048  lds
    v_mfma_f32_16x16x32_bf16 a[52:55], v[72:75], v[108:111], a[52:55]
    ds_read_b64_tr_b16 v[44:45], v30 offset:96
    v_mfma_f32_16x16x32_bf16 a[56:59], v[72:75], v[112:115], a[56:59]
    ds_read_b64_tr_b16 v[46:47], v30 offset:1888
    v_mfma_f32_16x16x32_bf16 a[60:63], v[72:75], v[116:119], a[60:63]
    ds_read_b64_tr_b16 v[48:49], v29 offset:128
    v_mfma_f32_16x16x32_bf16 a[64:67], v[76:79], v[104:107], a[64:67]
    ds_read_b64_tr_b16 v[50:51], v29 offset:1920
    v_mfma_f32_16x16x32_bf16 a[68:71], v[76:79], v[108:111], a[68:71]
    buffer_load_dwordx4 v5, s[4:7], s69 offen offset:3072  lds
    v_mfma_f32_16x16x32_bf16 a[72:75], v[76:79], v[112:115], a[72:75]
    ds_read_b64_tr_b16 v[52:53], v30 offset:160
    v_mfma_f32_16x16x32_bf16 a[76:79], v[76:79], v[116:119], a[76:79]
    ds_read_b64_tr_b16 v[54:55], v30 offset:1952
    v_mfma_f32_16x16x32_bf16 a[80:83], v[80:83], v[104:107], a[80:83]
    ds_read_b64_tr_b16 v[56:57], v31 offset:0
    v_mfma_f32_16x16x32_bf16 a[84:87], v[80:83], v[108:111], a[84:87]
    ds_read_b64_tr_b16 v[58:59], v31 offset:1792
    s_add_u32 m0, s56, 45056
    v_mfma_f32_16x16x32_bf16 a[88:91], v[80:83], v[112:115], a[88:91]
    buffer_load_dwordx4 v6, s[8:11], s70 offen offset:0  lds
    v_mfma_f32_16x16x32_bf16 a[92:95], v[80:83], v[116:119], a[92:95]
    v_mfma_f32_16x16x32_bf16 a[96:99], v[84:87], v[104:107], a[96:99]
    v_mfma_f32_16x16x32_bf16 a[100:103], v[84:87], v[108:111], a[100:103]
    v_mfma_f32_16x16x32_bf16 a[104:107], v[84:87], v[112:115], a[104:107]
    buffer_load_dwordx4 v7, s[8:11], s70 offen offset:1024  lds
    v_mfma_f32_16x16x32_bf16 a[108:111], v[84:87], v[116:119], a[108:111]
    s_waitcnt lgkmcnt(0)
    v_mfma_f32_16x16x32_bf16 a[0:3], v[32:35], v[88:91], a[0:3]
    ds_read_b128 v[104:107], v28 offset:0
    v_mfma_f32_16x16x32_bf16 a[4:7], v[32:35], v[92:95], a[4:7]
    ds_read_b64_tr_b16 v[60:61], v29 offset:14336
    s_add_u32 m0, s56, 45056
    v_mfma_f32_16x16x32_bf16 a[8:11], v[32:35], v[96:99], a[8:11]
    buffer_load_dwordx4 v8, s[8:11], s70 offen offset:2048  lds
    v_mfma_f32_16x16x32_bf16 a[12:15], v[32:35], v[100:103], a[12:15]
    ds_read_b64_tr_b16 v[62:63], v29 offset:16128
    v_mfma_f32_16x16x32_bf16 a[16:19], v[36:39], v[88:91], a[16:19]
    ds_read_b128 v[108:111], v28 offset:2048
    v_mfma_f32_16x16x32_bf16 a[20:23], v[36:39], v[92:95], a[20:23]
    ds_read_b128 v[112:115], v28 offset:4096
    v_mfma_f32_16x16x32_bf16 a[24:27], v[36:39], v[96:99], a[24:27]
    ds_read_b128 v[116:119], v28 offset:6144
    v_mfma_f32_16x16x32_bf16 a[28:31], v[36:39], v[100:103], a[28:31]
    buffer_load_dwordx4 v9, s[8:11], s70 offen offset:3072  lds
    v_mfma_f32_16x16x32_bf16 a[32:35], v[40:43], v[88:91], a[32:35]
    ds_read_b64_tr_b16 v[64:65], v30 offset:14368
    v_mfma_f32_16x16x32_bf16 a[36:39], v[40:43], v[92:95], a[36:39]
    ds_read_b64_tr_b16 v[66:67], v30 offset:16160
    v_mfma_f32_16x16x32_bf16 a[40:43], v[40:43], v[96:99], a[40:43]
    ds_read_b64_tr_b16 v[68:69], v29 offset:14400
    v_mfma_f32_16x16x32_bf16 a[44:47], v[40:43], v[100:103], a[44:47]
    ds_read_b64_tr_b16 v[70:71], v29 offset:16192
    s_add_u32 m0, s56, 49152
    v_mfma_f32_16x16x32_bf16 a[48:51], v[44:47], v[88:91], a[48:51]
    buffer_load_dwordx4 v10, s[8:11], s70 offen offset:0  lds
    v_mfma_f32_16x16x32_bf16 a[52:55], v[44:47], v[92:95], a[52:55]
    ds_read_b64_tr_b16 v[72:73], v30 offset:14432
    v_mfma_f32_16x16x32_bf16 a[56:59], v[44:47], v[96:99], a[56:59]
    ds_read_b64_tr_b16 v[74:75], v30 offset:16224
    v_mfma_f32_16x16x32_bf16 a[60:63], v[44:47], v[100:103], a[60:63]
    ds_read_b64_tr_b16 v[76:77], v29 offset:14464
    v_mfma_f32_16x16x32_bf16 a[64:67], v[48:51], v[88:91], a[64:67]
    ds_read_b64_tr_b16 v[78:79], v29 offset:16256
    v_mfma_f32_16x16x32_bf16 a[68:71], v[48:51], v[92:95], a[68:71]
    buffer_load_dwordx4 v11, s[8:11], s70 offen offset:1024  lds
    v_mfma_f32_16x16x32_bf16 a[72:75], v[48:51], v[96:99], a[72:75]
    ds_read_b64_tr_b16 v[80:81], v30 offset:14496
    v_mfma_f32_16x16x32_bf16 a[76:79], v[48:51], v[100:103], a[76:79]
    ds_read_b64_tr_b16 v[82:83], v30 offset:16288
    v_mfma_f32_16x16x32_bf16 a[80:83], v[52:55], v[88:91], a[80:83]
    ds_read_b64_tr_b16 v[84:85], v31 offset:14336
    v_mfma_f32_16x16x32_bf16 a[84:87], v[52:55], v[92:95], a[84:87]
    ds_read_b64_tr_b16 v[86:87], v31 offset:16128
    v_mfma_f32_16x16x32_bf16 a[88:91], v[52:55], v[96:99], a[88:91]
    buffer_load_dwordx4 v12, s[8:11], s70 offen offset:2048  lds
    v_mfma_f32_16x16x32_bf16 a[92:95], v[52:55], v[100:103], a[92:95]
    s_add_u32 s71, s71, 1
    s_and_b32 s71, s71, 15
    v_mfma_f32_16x16x32_bf16 a[96:99], v[56:59], v[88:91], a[96:99]
    s_lshl_b32 s69, s71, 7
    s_mul_i32 s70, s71, 458752
    v_mfma_f32_16x16x32_bf16 a[100:103], v[56:59], v[92:95], a[100:103]
    v_mfma_f32_16x16x32_bf16 a[104:107], v[56:59], v[96:99], a[104:107]
    v_mfma_f32_16x16x32_bf16 a[108:111], v[56:59], v[100:103], a[108:111]
    s_waitcnt vmcnt(11) lgkmcnt(0)
    s_barrier
    v_readfirstlane_b32 s88, v250
    v_readfirstlane_b32 s89, v251
    s_mov_b32 s80, 0
    s_nop 2
    s_cmp_lg_u32 s88, 0
    s_cbranch_scc1 L_have_nonce
L_nonce_spin:
    buffer_load_dwordx2 v[250:251], v124, s[52:55], 0 offen sc1
    s_waitcnt vmcnt(0)
    v_readfirstlane_b32 s88, v250
    v_readfirstlane_b32 s89, v251
    s_add_u32 s80, s80, 1
    s_cmp_gt_u32 s80, 0x20000
    s_cbranch_scc1 L_have_nonce
    s_cmp_eq_u32 s88, 0
    s_cbranch_scc1 L_nonce_spin
L_have_nonce:
    s_cmp_lg_u32 s66, 0
    s_cbranch_scc1 L_pubSC
    s_lshl_b32 s76, s64, 7
    s_lshl_b32 s77, s65, 3
    s_add_u32 s76, s76, s77
    s_add_u32 s76, s76, 34603008
    s_lshl_b32 s77, s65, 7
    s_lshl_b32 s78, s64, 3
    s_add_u32 s77, s77, s78
    s_add_u32 s77, s77, 34607104
    v_mov_b32 v240, s76
    v_mov_b32 v241, s77
    v_cmp_eq_u32 vcc, 0, v1
    s_nop 1
    v_cndmask_b32 v240, v241, v240, vcc
    v_mov_b32 v242, s88
    v_mov_b32 v243, s89
    s_mov_b64 exec, 0x3
    buffer_store_dwordx2 v[242:243], v240, s[12:15], 0 offen sc1
    s_mov_b64 exec, -1
L_pubSC:
    v_mfma_f32_16x16x32_bf16 a[0:3], v[60:63], v[104:107], a[0:3]
    ds_read_b128 v[88:91], v17 offset:0
    v_mfma_f32_16x16x32_bf16 a[4:7], v[60:63], v[108:111], a[4:7]
    ds_read_b64_tr_b16 v[32:33], v19 offset:0
    s_add_u32 m0, s73, 90112
    v_mfma_f32_16x16x32_bf16 a[8:11], v[60:63], v[112:115], a[8:11]
    buffer_load_dwordx4 v2, s[4:7], s69 offen offset:0  lds
    v_mfma_f32_16x16x32_bf16 a[12:15], v[60:63], v[116:119], a[12:15]
    ds_read_b64_tr_b16 v[34:35], v19 offset:1792
    v_mfma_f32_16x16x32_bf16 a[16:19], v[64:67], v[104:107], a[16:19]
    ds_read_b128 v[92:95], v17 offset:2048
    v_mfma_f32_16x16x32_bf16 a[20:23], v[64:67], v[108:111], a[20:23]
    ds_read_b128 v[96:99], v17 offset:4096
    v_mfma_f32_16x16x32_bf16 a[24:27], v[64:67], v[112:115], a[24:27]
    ds_read_b128 v[100:103], v17 offset:6144
    v_mfma_f32_16x16x32_bf16 a[28:31], v[64:67], v[116:119], a[28:31]
    buffer_load_dwordx4 v3, s[4:7], s69 offen offset:1024  lds
    v_mfma_f32_16x16x32_bf16 a[32:35], v[68:71], v[104:107], a[32:35]
    ds_read_b64_tr_b16 v[36:37], v20 offset:32
    v_mfma_f32_16x16x32_bf16 a[36:39], v[68:71], v[108:111], a[36:39]
    ds_read_b64_tr_b16 v[38:39], v20 offset:1824
    v_mfma_f32_16x16x32_bf16 a[40:43], v[68:71], v[112:115], a[40:43]
    ds_read_b64_tr_b16 v[40:41], v19 offset:64
    v_mfma_f32_16x16x32_bf16 a[44:47], v[68:71], v[116:119], a[44:47]
    ds_read_b64_tr_b16 v[42:43], v19 offset:1856
    v_mfma_f32_16x16x32_bf16 a[48:51], v[72:75], v[104:107], a[48:51]
    buffer_load_dwordx4 v4, s[4:7], s69 offen offset:2048  lds
    v_mfma_f32_16x16x32_bf16 a[52:55], v[72:75], v[108:111], a[52:55]
    ds_read_b64_tr_b16 v[44:45], v20 offset:96
    v_mfma_f32_16x16x32_bf16 a[56:59], v[72:75], v[112:115], a[56:59]
    ds_read_b64_tr_b16 v[46:47], v20 offset:1888
    v_mfma_f32_16x16x32_bf16 a[60:63], v[72:75], v[116:119], a[60:63]
    ds_read_b64_tr_b16 v[48:49], v19 offset:128
    v_mfma_f32_16x16x32_bf16 a[64:67], v[76:79], v[104:107], a[64:67]
    ds_read_b64_tr_b16 v[50:51], v19 offset:1920
    v_mfma_f32_16x16x32_bf16 a[68:71], v[76:79], v[108:111], a[68:71]
    buffer_load_dwordx4 v5, s[4:7], s69 offen offset:3072  lds
    v_mfma_f32_16x16x32_bf16 a[72:75], v[76:79], v[112:115], a[72:75]
    ds_read_b64_tr_b16 v[52:53], v20 offset:160
    v_mfma_f32_16x16x32_bf16 a[76:79], v[76:79], v[116:119], a[76:79]
    ds_read_b64_tr_b16 v[54:55], v20 offset:1952
    v_mfma_f32_16x16x32_bf16 a[80:83], v[80:83], v[104:107], a[80:83]
    ds_read_b64_tr_b16 v[56:57], v21 offset:0
    v_mfma_f32_16x16x32_bf16 a[84:87], v[80:83], v[108:111], a[84:87]
    ds_read_b64_tr_b16 v[58:59], v21 offset:1792
    s_add_u32 m0, s56, 90112
    v_mfma_f32_16x16x32_bf16 a[88:91], v[80:83], v[112:115], a[88:91]
    buffer_load_dwordx4 v6, s[8:11], s70 offen offset:0  lds
    v_mfma_f32_16x16x32_bf16 a[92:95], v[80:83], v[116:119], a[92:95]
    v_mfma_f32_16x16x32_bf16 a[96:99], v[84:87], v[104:107], a[96:99]
    v_mfma_f32_16x16x32_bf16 a[100:103], v[84:87], v[108:111], a[100:103]
    v_mfma_f32_16x16x32_bf16 a[104:107], v[84:87], v[112:115], a[104:107]
    buffer_load_dwordx4 v7, s[8:11], s70 offen offset:1024  lds
    v_mfma_f32_16x16x32_bf16 a[108:111], v[84:87], v[116:119], a[108:111]
    s_waitcnt lgkmcnt(0)
    v_mfma_f32_16x16x32_bf16 a[0:3], v[32:35], v[88:91], a[0:3]
    ds_read_b128 v[104:107], v18 offset:0
    v_mfma_f32_16x16x32_bf16 a[4:7], v[32:35], v[92:95], a[4:7]
    ds_read_b64_tr_b16 v[60:61], v19 offset:14336
    s_add_u32 m0, s56, 90112
    v_mfma_f32_16x16x32_bf16 a[8:11], v[32:35], v[96:99], a[8:11]
    buffer_load_dwordx4 v8, s[8:11], s70 offen offset:2048  lds
    v_mfma_f32_16x16x32_bf16 a[12:15], v[32:35], v[100:103], a[12:15]
    ds_read_b64_tr_b16 v[62:63], v19 offset:16128
    v_mfma_f32_16x16x32_bf16 a[16:19], v[36:39], v[88:91], a[16:19]
    ds_read_b128 v[108:111], v18 offset:2048
    v_mfma_f32_16x16x32_bf16 a[20:23], v[36:39], v[92:95], a[20:23]
    ds_read_b128 v[112:115], v18 offset:4096
    v_mfma_f32_16x16x32_bf16 a[24:27], v[36:39], v[96:99], a[24:27]
    ds_read_b128 v[116:119], v18 offset:6144
    v_mfma_f32_16x16x32_bf16 a[28:31], v[36:39], v[100:103], a[28:31]
    buffer_load_dwordx4 v9, s[8:11], s70 offen offset:3072  lds
    v_mfma_f32_16x16x32_bf16 a[32:35], v[40:43], v[88:91], a[32:35]
    ds_read_b64_tr_b16 v[64:65], v20 offset:14368
    v_mfma_f32_16x16x32_bf16 a[36:39], v[40:43], v[92:95], a[36:39]
    ds_read_b64_tr_b16 v[66:67], v20 offset:16160
    v_mfma_f32_16x16x32_bf16 a[40:43], v[40:43], v[96:99], a[40:43]
    ds_read_b64_tr_b16 v[68:69], v19 offset:14400
    v_mfma_f32_16x16x32_bf16 a[44:47], v[40:43], v[100:103], a[44:47]
    ds_read_b64_tr_b16 v[70:71], v19 offset:16192
    s_add_u32 m0, s56, 94208
    v_mfma_f32_16x16x32_bf16 a[48:51], v[44:47], v[88:91], a[48:51]
    buffer_load_dwordx4 v10, s[8:11], s70 offen offset:0  lds
    v_mfma_f32_16x16x32_bf16 a[52:55], v[44:47], v[92:95], a[52:55]
    ds_read_b64_tr_b16 v[72:73], v20 offset:14432
    v_mfma_f32_16x16x32_bf16 a[56:59], v[44:47], v[96:99], a[56:59]
    ds_read_b64_tr_b16 v[74:75], v20 offset:16224
    v_mfma_f32_16x16x32_bf16 a[60:63], v[44:47], v[100:103], a[60:63]
    ds_read_b64_tr_b16 v[76:77], v19 offset:14464
    v_mfma_f32_16x16x32_bf16 a[64:67], v[48:51], v[88:91], a[64:67]
    ds_read_b64_tr_b16 v[78:79], v19 offset:16256
    v_mfma_f32_16x16x32_bf16 a[68:71], v[48:51], v[92:95], a[68:71]
    buffer_load_dwordx4 v11, s[8:11], s70 offen offset:1024  lds
    v_mfma_f32_16x16x32_bf16 a[72:75], v[48:51], v[96:99], a[72:75]
    ds_read_b64_tr_b16 v[80:81], v20 offset:14496
    v_mfma_f32_16x16x32_bf16 a[76:79], v[48:51], v[100:103], a[76:79]
    ds_read_b64_tr_b16 v[82:83], v20 offset:16288
    v_mfma_f32_16x16x32_bf16 a[80:83], v[52:55], v[88:91], a[80:83]
    ds_read_b64_tr_b16 v[84:85], v21 offset:14336
    v_mfma_f32_16x16x32_bf16 a[84:87], v[52:55], v[92:95], a[84:87]
    ds_read_b64_tr_b16 v[86:87], v21 offset:16128
    v_mfma_f32_16x16x32_bf16 a[88:91], v[52:55], v[96:99], a[88:91]
    buffer_load_dwordx4 v12, s[8:11], s70 offen offset:2048  lds
    v_mfma_f32_16x16x32_bf16 a[92:95], v[52:55], v[100:103], a[92:95]
    s_add_u32 s71, s71, 1
    s_and_b32 s71, s71, 15
    v_mfma_f32_16x16x32_bf16 a[96:99], v[56:59], v[88:91], a[96:99]
    s_lshl_b32 s69, s71, 7
    s_mul_i32 s70, s71, 458752
    v_mfma_f32_16x16x32_bf16 a[100:103], v[56:59], v[92:95], a[100:103]
    v_mfma_f32_16x16x32_bf16 a[104:107], v[56:59], v[96:99], a[104:107]
    v_mfma_f32_16x16x32_bf16 a[108:111], v[56:59], v[100:103], a[108:111]
    s_waitcnt vmcnt(11) lgkmcnt(0)
    s_barrier
    v_mfma_f32_16x16x32_bf16 a[0:3], v[60:63], v[104:107], a[0:3]
    ds_read_b128 v[88:91], v22 offset:0
    v_mfma_f32_16x16x32_bf16 a[4:7], v[60:63], v[108:111], a[4:7]
    ds_read_b64_tr_b16 v[32:33], v24 offset:0
    s_add_u32 m0, s73, 0
    v_mfma_f32_16x16x32_bf16 a[8:11], v[60:63], v[112:115], a[8:11]
    buffer_load_dwordx4 v2, s[4:7], s69 offen offset:0  lds
    v_mfma_f32_16x16x32_bf16 a[12:15], v[60:63], v[116:119], a[12:15]
    ds_read_b64_tr_b16 v[34:35], v24 offset:1792
    v_mfma_f32_16x16x32_bf16 a[16:19], v[64:67], v[104:107], a[16:19]
    ds_read_b128 v[92:95], v22 offset:2048
    v_mfma_f32_16x16x32_bf16 a[20:23], v[64:67], v[108:111], a[20:23]
    ds_read_b128 v[96:99], v22 offset:4096
    v_mfma_f32_16x16x32_bf16 a[24:27], v[64:67], v[112:115], a[24:27]
    ds_read_b128 v[100:103], v22 offset:6144
    v_mfma_f32_16x16x32_bf16 a[28:31], v[64:67], v[116:119], a[28:31]
    buffer_load_dwordx4 v3, s[4:7], s69 offen offset:1024  lds
    v_mfma_f32_16x16x32_bf16 a[32:35], v[68:71], v[104:107], a[32:35]
    ds_read_b64_tr_b16 v[36:37], v25 offset:32
    v_mfma_f32_16x16x32_bf16 a[36:39], v[68:71], v[108:111], a[36:39]
    ds_read_b64_tr_b16 v[38:39], v25 offset:1824
    v_mfma_f32_16x16x32_bf16 a[40:43], v[68:71], v[112:115], a[40:43]
    ds_read_b64_tr_b16 v[40:41], v24 offset:64
    v_mfma_f32_16x16x32_bf16 a[44:47], v[68:71], v[116:119], a[44:47]
    ds_read_b64_tr_b16 v[42:43], v24 offset:1856
    v_mfma_f32_16x16x32_bf16 a[48:51], v[72:75], v[104:107], a[48:51]
    buffer_load_dwordx4 v4, s[4:7], s69 offen offset:2048  lds
    v_mfma_f32_16x16x32_bf16 a[52:55], v[72:75], v[108:111], a[52:55]
    ds_read_b64_tr_b16 v[44:45], v25 offset:96
    v_mfma_f32_16x16x32_bf16 a[56:59], v[72:75], v[112:115], a[56:59]
    ds_read_b64_tr_b16 v[46:47], v25 offset:1888
    v_mfma_f32_16x16x32_bf16 a[60:63], v[72:75], v[116:119], a[60:63]
    ds_read_b64_tr_b16 v[48:49], v24 offset:128
    v_mfma_f32_16x16x32_bf16 a[64:67], v[76:79], v[104:107], a[64:67]
    ds_read_b64_tr_b16 v[50:51], v24 offset:1920
    v_mfma_f32_16x16x32_bf16 a[68:71], v[76:79], v[108:111], a[68:71]
    buffer_load_dwordx4 v5, s[4:7], s69 offen offset:3072  lds
    v_mfma_f32_16x16x32_bf16 a[72:75], v[76:79], v[112:115], a[72:75]
    ds_read_b64_tr_b16 v[52:53], v25 offset:160
    v_mfma_f32_16x16x32_bf16 a[76:79], v[76:79], v[116:119], a[76:79]
    ds_read_b64_tr_b16 v[54:55], v25 offset:1952
    v_mfma_f32_16x16x32_bf16 a[80:83], v[80:83], v[104:107], a[80:83]
    ds_read_b64_tr_b16 v[56:57], v26 offset:0
    v_mfma_f32_16x16x32_bf16 a[84:87], v[80:83], v[108:111], a[84:87]
    ds_read_b64_tr_b16 v[58:59], v26 offset:1792
    s_add_u32 m0, s56, 0
    v_mfma_f32_16x16x32_bf16 a[88:91], v[80:83], v[112:115], a[88:91]
    buffer_load_dwordx4 v6, s[8:11], s70 offen offset:0  lds
    v_mfma_f32_16x16x32_bf16 a[92:95], v[80:83], v[116:119], a[92:95]
    v_mfma_f32_16x16x32_bf16 a[96:99], v[84:87], v[104:107], a[96:99]
    v_mfma_f32_16x16x32_bf16 a[100:103], v[84:87], v[108:111], a[100:103]
    v_mfma_f32_16x16x32_bf16 a[104:107], v[84:87], v[112:115], a[104:107]
    buffer_load_dwordx4 v7, s[8:11], s70 offen offset:1024  lds
    v_mfma_f32_16x16x32_bf16 a[108:111], v[84:87], v[116:119], a[108:111]
    s_waitcnt lgkmcnt(0)
L_step10:
    v_mfma_f32_16x16x32_bf16 a[0:3], v[32:35], v[88:91], a[0:3]
    ds_read_b128 v[104:107], v23 offset:0
    v_mfma_f32_16x16x32_bf16 a[4:7], v[32:35], v[92:95], a[4:7]
    ds_read_b64_tr_b16 v[60:61], v24 offset:14336
    s_add_u32 m0, s56, 0
    v_mfma_f32_16x16x32_bf16 a[8:11], v[32:35], v[96:99], a[8:11]
    buffer_load_dwordx4 v8, s[8:11], s70 offen offset:2048  lds
    v_mfma_f32_16x16x32_bf16 a[12:15], v[32:35], v[100:103], a[12:15]
    ds_read_b64_tr_b16 v[62:63], v24 offset:16128
    v_mfma_f32_16x16x32_bf16 a[16:19], v[36:39], v[88:91], a[16:19]
    ds_read_b128 v[108:111], v23 offset:2048
    v_mfma_f32_16x16x32_bf16 a[20:23], v[36:39], v[92:95], a[20:23]
    ds_read_b128 v[112:115], v23 offset:4096
    v_mfma_f32_16x16x32_bf16 a[24:27], v[36:39], v[96:99], a[24:27]
    ds_read_b128 v[116:119], v23 offset:6144
    v_mfma_f32_16x16x32_bf16 a[28:31], v[36:39], v[100:103], a[28:31]
    buffer_load_dwordx4 v9, s[8:11], s70 offen offset:3072  lds
    v_mfma_f32_16x16x32_bf16 a[32:35], v[40:43], v[88:91], a[32:35]
    ds_read_b64_tr_b16 v[64:65], v25 offset:14368
    v_mfma_f32_16x16x32_bf16 a[36:39], v[40:43], v[92:95], a[36:39]
    ds_read_b64_tr_b16 v[66:67], v25 offset:16160
    v_mfma_f32_16x16x32_bf16 a[40:43], v[40:43], v[96:99], a[40:43]
    ds_read_b64_tr_b16 v[68:69], v24 offset:14400
    v_mfma_f32_16x16x32_bf16 a[44:47], v[40:43], v[100:103], a[44:47]
    ds_read_b64_tr_b16 v[70:71], v24 offset:16192
    s_add_u32 m0, s56, 4096
    v_mfma_f32_16x16x32_bf16 a[48:51], v[44:47], v[88:91], a[48:51]
    buffer_load_dwordx4 v10, s[8:11], s70 offen offset:0  lds
    v_mfma_f32_16x16x32_bf16 a[52:55], v[44:47], v[92:95], a[52:55]
    ds_read_b64_tr_b16 v[72:73], v25 offset:14432
    v_mfma_f32_16x16x32_bf16 a[56:59], v[44:47], v[96:99], a[56:59]
    ds_read_b64_tr_b16 v[74:75], v25 offset:16224
    v_mfma_f32_16x16x32_bf16 a[60:63], v[44:47], v[100:103], a[60:63]
    ds_read_b64_tr_b16 v[76:77], v24 offset:14464
    v_mfma_f32_16x16x32_bf16 a[64:67], v[48:51], v[88:91], a[64:67]
    ds_read_b64_tr_b16 v[78:79], v24 offset:16256
    v_mfma_f32_16x16x32_bf16 a[68:71], v[48:51], v[92:95], a[68:71]
    buffer_load_dwordx4 v11, s[8:11], s70 offen offset:1024  lds
    v_mfma_f32_16x16x32_bf16 a[72:75], v[48:51], v[96:99], a[72:75]
    ds_read_b64_tr_b16 v[80:81], v25 offset:14496
    v_mfma_f32_16x16x32_bf16 a[76:79], v[48:51], v[100:103], a[76:79]
    ds_read_b64_tr_b16 v[82:83], v25 offset:16288
    v_mfma_f32_16x16x32_bf16 a[80:83], v[52:55], v[88:91], a[80:83]
    ds_read_b64_tr_b16 v[84:85], v26 offset:14336
    v_mfma_f32_16x16x32_bf16 a[84:87], v[52:55], v[92:95], a[84:87]
    ds_read_b64_tr_b16 v[86:87], v26 offset:16128
    v_mfma_f32_16x16x32_bf16 a[88:91], v[52:55], v[96:99], a[88:91]
    buffer_load_dwordx4 v12, s[8:11], s70 offen offset:2048  lds
    v_mfma_f32_16x16x32_bf16 a[92:95], v[52:55], v[100:103], a[92:95]
    s_add_u32 s71, s71, 1
    s_and_b32 s71, s71, 15
    v_mfma_f32_16x16x32_bf16 a[96:99], v[56:59], v[88:91], a[96:99]
    s_lshl_b32 s69, s71, 7
    s_mul_i32 s70, s71, 458752
    v_mfma_f32_16x16x32_bf16 a[100:103], v[56:59], v[92:95], a[100:103]
    v_mfma_f32_16x16x32_bf16 a[104:107], v[56:59], v[96:99], a[104:107]
    v_mfma_f32_16x16x32_bf16 a[108:111], v[56:59], v[100:103], a[108:111]
    s_waitcnt vmcnt(11) lgkmcnt(0)
    s_barrier
    v_mfma_f32_16x16x32_bf16 a[0:3], v[60:63], v[104:107], a[0:3]
    ds_read_b128 v[88:91], v27 offset:0
    v_mfma_f32_16x16x32_bf16 a[4:7], v[60:63], v[108:111], a[4:7]
    ds_read_b64_tr_b16 v[32:33], v29 offset:0
    s_add_u32 m0, s73, 45056
    v_mfma_f32_16x16x32_bf16 a[8:11], v[60:63], v[112:115], a[8:11]
    buffer_load_dwordx4 v2, s[4:7], s69 offen offset:0  lds
    v_mfma_f32_16x16x32_bf16 a[12:15], v[60:63], v[116:119], a[12:15]
    ds_read_b64_tr_b16 v[34:35], v29 offset:1792
    v_mfma_f32_16x16x32_bf16 a[16:19], v[64:67], v[104:107], a[16:19]
    ds_read_b128 v[92:95], v27 offset:2048
    v_mfma_f32_16x16x32_bf16 a[20:23], v[64:67], v[108:111], a[20:23]
    ds_read_b128 v[96:99], v27 offset:4096
    v_mfma_f32_16x16x32_bf16 a[24:27], v[64:67], v[112:115], a[24:27]
    ds_read_b128 v[100:103], v27 offset:6144
    v_mfma_f32_16x16x32_bf16 a[28:31], v[64:67], v[116:119], a[28:31]
    buffer_load_dwordx4 v3, s[4:7], s69 offen offset:1024  lds
    v_mfma_f32_16x16x32_bf16 a[32:35], v[68:71], v[104:107], a[32:35]
    ds_read_b64_tr_b16 v[36:37], v30 offset:32
    v_and_b32 v244, 15, v1
    v_mfma_f32_16x16x32_bf16 a[36:39], v[68:71], v[108:111], a[36:39]
    ds_read_b64_tr_b16 v[38:39], v30 offset:1824
    v_lshlrev_b32 v244, 3, v244
    v_mfma_f32_16x16x32_bf16 a[40:43], v[68:71], v[112:115], a[40:43]
    ds_read_b64_tr_b16 v[40:41], v29 offset:64
    v_mfma_f32_16x16x32_bf16 a[44:47], v[68:71], v[116:119], a[44:47]
    ds_read_b64_tr_b16 v[42:43], v29 offset:1856
    s_lshl_b32 s82, s64, 7
    v_mfma_f32_16x16x32_bf16 a[48:51], v[72:75], v[104:107], a[48:51]
    buffer_load_dwordx4 v4, s[4:7], s69 offen offset:2048  lds
    v_mfma_f32_16x16x32_bf16 a[52:55], v[72:75], v[108:111], a[52:55]
    ds_read_b64_tr_b16 v[44:45], v30 offset:96
    s_add_u32 s82, s82, 34603008
    v_mfma_f32_16x16x32_bf16 a[56:59], v[72:75], v[112:115], a[56:59]
    ds_read_b64_tr_b16 v[46:47], v30 offset:1888
    s_lshl_b32 s83, s65, 7
    v_mfma_f32_16x16x32_bf16 a[60:63], v[72:75], v[116:119], a[60:63]
    ds_read_b64_tr_b16 v[48:49], v29 offset:128
    v_mfma_f32_16x16x32_bf16 a[64:67], v[76:79], v[104:107], a[64:67]
    ds_read_b64_tr_b16 v[50:51], v29 offset:1920
    s_add_u32 s83, s83, 34607104
    v_mfma_f32_16x16x32_bf16 a[68:71], v[76:79], v[108:111], a[68:71]
    buffer_load_dwordx4 v5, s[4:7], s69 offen offset:3072  lds
    v_mfma_f32_16x16x32_bf16 a[72:75], v[76:79], v[112:115], a[72:75]
    ds_read_b64_tr_b16 v[52:53], v30 offset:160
    v_mov_b32 v245, s82
    v_mfma_f32_16x16x32_bf16 a[76:79], v[76:79], v[116:119], a[76:79]
    ds_read_b64_tr_b16 v[54:55], v30 offset:1952
    v_mfma_f32_16x16x32_bf16 a[80:83], v[80:83], v[104:107], a[80:83]
    ds_read_b64_tr_b16 v[56:57], v31 offset:0
    v_mov_b32 v246, s83
    v_mfma_f32_16x16x32_bf16 a[84:87], v[80:83], v[108:111], a[84:87]
    ds_read_b64_tr_b16 v[58:59], v31 offset:1792
    s_add_u32 m0, s56, 45056
    v_mfma_f32_16x16x32_bf16 a[88:91], v[80:83], v[112:115], a[88:91]
    buffer_load_dwordx4 v6, s[8:11], s70 offen offset:0  lds
    v_cmp_gt_u32 vcc, 16, v1
    s_nop 1
    v_cndmask_b32 v245, v246, v245, vcc
    v_mfma_f32_16x16x32_bf16 a[92:95], v[80:83], v[116:119], a[92:95]
    v_mfma_f32_16x16x32_bf16 a[96:99], v[84:87], v[104:107], a[96:99]
    v_add_u32 v252, v244, v245
    v_mfma_f32_16x16x32_bf16 a[100:103], v[84:87], v[108:111], a[100:103]
    v_mfma_f32_16x16x32_bf16 a[104:107], v[84:87], v[112:115], a[104:107]
    buffer_load_dwordx4 v7, s[8:11], s70 offen offset:1024  lds
    buffer_load_dwordx2 v[250:251], v252, s[12:15], 0 offen sc1
    v_mfma_f32_16x16x32_bf16 a[108:111], v[84:87], v[116:119], a[108:111]
    s_waitcnt lgkmcnt(0)
    v_mfma_f32_16x16x32_bf16 a[0:3], v[32:35], v[88:91], a[0:3]
    ds_read_b128 v[104:107], v28 offset:0
    v_mfma_f32_16x16x32_bf16 a[4:7], v[32:35], v[92:95], a[4:7]
    ds_read_b64_tr_b16 v[60:61], v29 offset:14336
    s_add_u32 m0, s56, 45056
    v_mfma_f32_16x16x32_bf16 a[8:11], v[32:35], v[96:99], a[8:11]
    buffer_load_dwordx4 v8, s[8:11], s70 offen offset:2048  lds
    v_mfma_f32_16x16x32_bf16 a[12:15], v[32:35], v[100:103], a[12:15]
    ds_read_b64_tr_b16 v[62:63], v29 offset:16128
    v_mfma_f32_16x16x32_bf16 a[16:19], v[36:39], v[88:91], a[16:19]
    ds_read_b128 v[108:111], v28 offset:2048
    v_mfma_f32_16x16x32_bf16 a[20:23], v[36:39], v[92:95], a[20:23]
    ds_read_b128 v[112:115], v28 offset:4096
    v_mfma_f32_16x16x32_bf16 a[24:27], v[36:39], v[96:99], a[24:27]
    ds_read_b128 v[116:119], v28 offset:6144
    v_mfma_f32_16x16x32_bf16 a[28:31], v[36:39], v[100:103], a[28:31]
    buffer_load_dwordx4 v9, s[8:11], s70 offen offset:3072  lds
    v_mfma_f32_16x16x32_bf16 a[32:35], v[40:43], v[88:91], a[32:35]
    ds_read_b64_tr_b16 v[64:65], v30 offset:14368
    v_mfma_f32_16x16x32_bf16 a[36:39], v[40:43], v[92:95], a[36:39]
    ds_read_b64_tr_b16 v[66:67], v30 offset:16160
    v_mfma_f32_16x16x32_bf16 a[40:43], v[40:43], v[96:99], a[40:43]
    ds_read_b64_tr_b16 v[68:69], v29 offset:14400
    v_mfma_f32_16x16x32_bf16 a[44:47], v[40:43], v[100:103], a[44:47]
    ds_read_b64_tr_b16 v[70:71], v29 offset:16192
    s_add_u32 m0, s56, 49152
    v_mfma_f32_16x16x32_bf16 a[48:51], v[44:47], v[88:91], a[48:51]
    buffer_load_dwordx4 v10, s[8:11], s70 offen offset:0  lds
    v_mfma_f32_16x16x32_bf16 a[52:55], v[44:47], v[92:95], a[52:55]
    ds_read_b64_tr_b16 v[72:73], v30 offset:14432
    v_mfma_f32_16x16x32_bf16 a[56:59], v[44:47], v[96:99], a[56:59]
    ds_read_b64_tr_b16 v[74:75], v30 offset:16224
    v_mfma_f32_16x16x32_bf16 a[60:63], v[44:47], v[100:103], a[60:63]
    ds_read_b64_tr_b16 v[76:77], v29 offset:14464
    v_mfma_f32_16x16x32_bf16 a[64:67], v[48:51], v[88:91], a[64:67]
    ds_read_b64_tr_b16 v[78:79], v29 offset:16256
    v_mfma_f32_16x16x32_bf16 a[68:71], v[48:51], v[92:95], a[68:71]
    buffer_load_dwordx4 v11, s[8:11], s70 offen offset:1024  lds
    v_mfma_f32_16x16x32_bf16 a[72:75], v[48:51], v[96:99], a[72:75]
    ds_read_b64_tr_b16 v[80:81], v30 offset:14496
    v_mfma_f32_16x16x32_bf16 a[76:79], v[48:51], v[100:103], a[76:79]
    ds_read_b64_tr_b16 v[82:83], v30 offset:16288
    v_mfma_f32_16x16x32_bf16 a[80:83], v[52:55], v[88:91], a[80:83]
    ds_read_b64_tr_b16 v[84:85], v31 offset:14336
    v_mfma_f32_16x16x32_bf16 a[84:87], v[52:55], v[92:95], a[84:87]
    ds_read_b64_tr_b16 v[86:87], v31 offset:16128
    v_mfma_f32_16x16x32_bf16 a[88:91], v[52:55], v[96:99], a[88:91]
    buffer_load_dwordx4 v12, s[8:11], s70 offen offset:2048  lds
    v_mfma_f32_16x16x32_bf16 a[92:95], v[52:55], v[100:103], a[92:95]
    s_add_u32 s71, s71, 1
    s_and_b32 s71, s71, 15
    v_mfma_f32_16x16x32_bf16 a[96:99], v[56:59], v[88:91], a[96:99]
    s_lshl_b32 s69, s71, 7
    s_mul_i32 s70, s71, 458752
    v_mfma_f32_16x16x32_bf16 a[100:103], v[56:59], v[92:95], a[100:103]
    v_mfma_f32_16x16x32_bf16 a[104:107], v[56:59], v[96:99], a[104:107]
    v_mfma_f32_16x16x32_bf16 a[108:111], v[56:59], v[100:103], a[108:111]
    s_waitcnt vmcnt(12) lgkmcnt(0)
    s_barrier
    v_mfma_f32_16x16x32_bf16 a[0:3], v[60:63], v[104:107], a[0:3]
    ds_read_b128 v[88:91], v17 offset:0
    v_mfma_f32_16x16x32_bf16 a[4:7], v[60:63], v[108:111], a[4:7]
    ds_read_b64_tr_b16 v[32:33], v19 offset:0
    s_add_u32 m0, s73, 90112
    v_mfma_f32_16x16x32_bf16 a[8:11], v[60:63], v[112:115], a[8:11]
    buffer_load_dwordx4 v2, s[4:7], s69 offen offset:0  lds
    v_mfma_f32_16x16x32_bf16 a[12:15], v[60:63], v[116:119], a[12:15]
    ds_read_b64_tr_b16 v[34:35], v19 offset:1792
    v_mfma_f32_16x16x32_bf16 a[16:19], v[64:67], v[104:107], a[16:19]
    ds_read_b128 v[92:95], v17 offset:2048
    v_mfma_f32_16x16x32_bf16 a[20:23], v[64:67], v[108:111], a[20:23]
    ds_read_b128 v[96:99], v17 offset:4096
    v_mfma_f32_16x16x32_bf16 a[24:27], v[64:67], v[112:115], a[24:27]
    ds_read_b128 v[100:103], v17 offset:6144
    v_mfma_f32_16x16x32_bf16 a[28:31], v[64:67], v[116:119], a[28:31]
    buffer_load_dwordx4 v3, s[4:7], s69 offen offset:1024  lds
    v_mfma_f32_16x16x32_bf16 a[32:35], v[68:71], v[104:107], a[32:35]
    ds_read_b64_tr_b16 v[36:37], v20 offset:32
    v_mfma_f32_16x16x32_bf16 a[36:39], v[68:71], v[108:111], a[36:39]
    ds_read_b64_tr_b16 v[38:39], v20 offset:1824
    v_mfma_f32_16x16x32_bf16 a[40:43], v[68:71], v[112:115], a[40:43]
    ds_read_b64_tr_b16 v[40:41], v19 offset:64
    v_mfma_f32_16x16x32_bf16 a[44:47], v[68:71], v[116:119], a[44:47]
    ds_read_b64_tr_b16 v[42:43], v19 offset:1856
    v_mfma_f32_16x16x32_bf16 a[48:51], v[72:75], v[104:107], a[48:51]
    buffer_load_dwordx4 v4, s[4:7], s69 offen offset:2048  lds
    v_mfma_f32_16x16x32_bf16 a[52:55], v[72:75], v[108:111], a[52:55]
    ds_read_b64_tr_b16 v[44:45], v20 offset:96
    v_mfma_f32_16x16x32_bf16 a[56:59], v[72:75], v[112:115], a[56:59]
    ds_read_b64_tr_b16 v[46:47], v20 offset:1888
    v_mfma_f32_16x16x32_bf16 a[60:63], v[72:75], v[116:119], a[60:63]
    ds_read_b64_tr_b16 v[48:49], v19 offset:128
    v_mfma_f32_16x16x32_bf16 a[64:67], v[76:79], v[104:107], a[64:67]
    ds_read_b64_tr_b16 v[50:51], v19 offset:1920
    v_mfma_f32_16x16x32_bf16 a[68:71], v[76:79], v[108:111], a[68:71]
    buffer_load_dwordx4 v5, s[4:7], s69 offen offset:3072  lds
    v_mfma_f32_16x16x32_bf16 a[72:75], v[76:79], v[112:115], a[72:75]
    ds_read_b64_tr_b16 v[52:53], v20 offset:160
    v_mfma_f32_16x16x32_bf16 a[76:79], v[76:79], v[116:119], a[76:79]
    ds_read_b64_tr_b16 v[54:55], v20 offset:1952
    v_mfma_f32_16x16x32_bf16 a[80:83], v[80:83], v[104:107], a[80:83]
    ds_read_b64_tr_b16 v[56:57], v21 offset:0
    v_mfma_f32_16x16x32_bf16 a[84:87], v[80:83], v[108:111], a[84:87]
    ds_read_b64_tr_b16 v[58:59], v21 offset:1792
    s_add_u32 m0, s56, 90112
    v_mfma_f32_16x16x32_bf16 a[88:91], v[80:83], v[112:115], a[88:91]
    buffer_load_dwordx4 v6, s[8:11], s70 offen offset:0  lds
    v_mfma_f32_16x16x32_bf16 a[92:95], v[80:83], v[116:119], a[92:95]
    v_mfma_f32_16x16x32_bf16 a[96:99], v[84:87], v[104:107], a[96:99]
    v_mfma_f32_16x16x32_bf16 a[100:103], v[84:87], v[108:111], a[100:103]
    v_mfma_f32_16x16x32_bf16 a[104:107], v[84:87], v[112:115], a[104:107]
    buffer_load_dwordx4 v7, s[8:11], s70 offen offset:1024  lds
    v_mfma_f32_16x16x32_bf16 a[108:111], v[84:87], v[116:119], a[108:111]
    s_waitcnt lgkmcnt(0)
    v_mfma_f32_16x16x32_bf16 a[0:3], v[32:35], v[88:91], a[0:3]
    ds_read_b128 v[104:107], v18 offset:0
    v_mfma_f32_16x16x32_bf16 a[4:7], v[32:35], v[92:95], a[4:7]
    ds_read_b64_tr_b16 v[60:61], v19 offset:14336
    s_add_u32 m0, s56, 90112
    v_mfma_f32_16x16x32_bf16 a[8:11], v[32:35], v[96:99], a[8:11]
    buffer_load_dwordx4 v8, s[8:11], s70 offen offset:2048  lds
    s_lshr_b32 s82, s2, 3
    v_mfma_f32_16x16x32_bf16 a[12:15], v[32:35], v[100:103], a[12:15]
    ds_read_b64_tr_b16 v[62:63], v19 offset:16128
    s_lshl_b32 s82, s82, 2
    v_mfma_f32_16x16x32_bf16 a[16:19], v[36:39], v[88:91], a[16:19]
    ds_read_b128 v[108:111], v18 offset:2048
    v_mfma_f32_16x16x32_bf16 a[20:23], v[36:39], v[92:95], a[20:23]
    ds_read_b128 v[112:115], v18 offset:4096
    s_add_u32 s82, s82, s66
    v_mfma_f32_16x16x32_bf16 a[24:27], v[36:39], v[96:99], a[24:27]
    ds_read_b128 v[116:119], v18 offset:6144
    v_mfma_f32_16x16x32_bf16 a[28:31], v[36:39], v[100:103], a[28:31]
    buffer_load_dwordx4 v9, s[8:11], s70 offen offset:3072  lds
    s_lshl_b32 s82, s82, 8
    v_mfma_f32_16x16x32_bf16 a[32:35], v[40:43], v[88:91], a[32:35]
    ds_read_b64_tr_b16 v[64:65], v20 offset:14368
    v_mfma_f32_16x16x32_bf16 a[36:39], v[40:43], v[92:95], a[36:39]
    ds_read_b64_tr_b16 v[66:67], v20 offset:16160
    s_add_u32 s82, s82, (L_g1end-L_pc)
    v_mfma_f32_16x16x32_bf16 a[40:43], v[40:43], v[96:99], a[40:43]
    ds_read_b64_tr_b16 v[68:69], v19 offset:14400
    v_mfma_f32_16x16x32_bf16 a[44:47], v[40:43], v[100:103], a[44:47]
    ds_read_b64_tr_b16 v[70:71], v19 offset:16192
    s_add_u32 m0, s56, 94208
    v_mfma_f32_16x16x32_bf16 a[48:51], v[44:47], v[88:91], a[48:51]
    buffer_load_dwordx4 v10, s[8:11], s70 offen offset:0  lds
    v_and_b32 v244, 1, v1
    v_mfma_f32_16x16x32_bf16 a[52:55], v[44:47], v[92:95], a[52:55]
    ds_read_b64_tr_b16 v[72:73], v20 offset:14432
    v_lshl_add_u32 v244, v244, 7, s82
    v_mfma_f32_16x16x32_bf16 a[56:59], v[44:47], v[96:99], a[56:59]
    ds_read_b64_tr_b16 v[74:75], v20 offset:16224
    v_mfma_f32_16x16x32_bf16 a[60:63], v[44:47], v[100:103], a[60:63]
    ds_read_b64_tr_b16 v[76:77], v19 offset:14464
    v_min_u32 v244, (L_convend-L_pc), v244
    v_mfma_f32_16x16x32_bf16 a[64:67], v[48:51], v[88:91], a[64:67]
    ds_read_b64_tr_b16 v[78:79], v19 offset:16256
    v_mfma_f32_16x16x32_bf16 a[68:71], v[48:51], v[92:95], a[68:71]
    buffer_load_dwordx4 v11, s[8:11], s70 offen offset:1024  lds
    v_mov_b32 v247, s59
    v_mfma_f32_16x16x32_bf16 a[72:75], v[48:51], v[96:99], a[72:75]
    ds_read_b64_tr_b16 v[80:81], v20 offset:14496
    v_mfma_f32_16x16x32_bf16 a[76:79], v[48:51], v[100:103], a[76:79]
    ds_read_b64_tr_b16 v[82:83], v20 offset:16288
    v_add_co_u32 v246, vcc, s58, v244
    s_nop 1
    v_addc_co_u32 v247, vcc, 0, v247, vcc
    v_mfma_f32_16x16x32_bf16 a[80:83], v[52:55], v[88:91], a[80:83]
    ds_read_b64_tr_b16 v[84:85], v21 offset:14336
    v_mfma_f32_16x16x32_bf16 a[84:87], v[52:55], v[92:95], a[84:87]
    ds_read_b64_tr_b16 v[86:87], v21 offset:16128
    s_mov_b64 exec, 3
    global_load_dword v127, v[246:247], off
    s_mov_b64 exec, -1
    v_mfma_f32_16x16x32_bf16 a[88:91], v[52:55], v[96:99], a[88:91]
    buffer_load_dwordx4 v12, s[8:11], s70 offen offset:2048  lds
    v_mfma_f32_16x16x32_bf16 a[92:95], v[52:55], v[100:103], a[92:95]
    s_add_u32 s71, s71, 1
    s_and_b32 s71, s71, 15
    v_mfma_f32_16x16x32_bf16 a[96:99], v[56:59], v[88:91], a[96:99]
    s_lshl_b32 s69, s71, 7
    s_mul_i32 s70, s71, 458752
    v_mfma_f32_16x16x32_bf16 a[100:103], v[56:59], v[92:95], a[100:103]
    v_mfma_f32_16x16x32_bf16 a[104:107], v[56:59], v[96:99], a[104:107]
    v_mfma_f32_16x16x32_bf16 a[108:111], v[56:59], v[100:103], a[108:111]
    s_waitcnt vmcnt(12) lgkmcnt(0)
    s_mov_b32 s80, 0
    s_mov_b32 s78, 0xffffffff
    s_mov_b32 s79, 0x0
    s_branch L_poll1_chk
L_poll1:
    buffer_load_dwordx2 v[250:251], v252, s[12:15], 0 offen sc1
    s_waitcnt vmcnt(0)
L_poll1_chk:
    v_cmp_ne_u32 vcc, s88, v250
    v_cmp_ne_u32 s[76:77], s89, v251
    s_add_u32 s80, s80, 1
    s_nop 0
    s_or_b64 vcc, vcc, s[76:77]
    s_and_b64 vcc, vcc, s[78:79]
    s_cmp_gt_u32 s80, 0x20000
    s_cbranch_scc1 L_poll1_done
    s_cbranch_vccnz L_poll1
L_poll1_done:
    s_barrier
    v_mfma_f32_16x16x32_bf16 a[0:3], v[60:63], v[104:107], a[0:3]
    ds_read_b128 v[88:91], v22 offset:0
    v_and_b32 v244, 15, v1
    s_lshl_b32 s82, s64, 7
    v_mfma_f32_16x16x32_bf16 a[4:7], v[60:63], v[108:111], a[4:7]
    ds_read_b64_tr_b16 v[32:33], v24 offset:0
    s_add_u32 m0, s73, 0
    s_lshl_b32 s83, s67, 6
    v_mfma_f32_16x16x32_bf16 a[8:11], v[60:63], v[112:115], a[8:11]
    buffer_load_dwordx4 v2, s[4:7], s69 offen offset:0  lds
    s_add_u32 s82, s82, s83
    v_mfma_f32_16x16x32_bf16 a[12:15], v[60:63], v[116:119], a[12:15]
    ds_read_b64_tr_b16 v[34:35], v24 offset:1792
    v_add_u32 v244, s82, v244
    v_lshlrev_b32 v244, 4, v244
    v_mfma_f32_16x16x32_bf16 a[16:19], v[64:67], v[104:107], a[16:19]
    ds_read_b128 v[92:95], v22 offset:2048
    buffer_load_dwordx4 v3, s[4:7], s69 offen offset:1024  lds
    s_mov_b32 s82, 33554440
    v_mfma_f32_16x16x32_bf16 a[20:23], v[64:67], v[108:111], a[20:23]
    ds_read_b128 v[96:99], v22 offset:4096
    buffer_load_dwordx2 v[128:129], v244, s[12:15], s82 offen offset:0 sc1
    v_mfma_f32_16x16x32_bf16 a[24:27], v[64:67], v[112:115], a[24:27]
    ds_read_b128 v[100:103], v22 offset:6144
    buffer_load_dwordx2 v[130:131], v244, s[12:15], s82 offen offset:256 sc1
    buffer_load_dwordx2 v[132:133], v244, s[12:15], s82 offen offset:512 sc1
    v_mfma_f32_16x16x32_bf16 a[28:31], v[64:67], v[116:119], a[28:31]
    buffer_load_dwordx4 v4, s[4:7], s69 offen offset:2048  lds
    buffer_load_dwordx2 v[134:135], v244, s[12:15], s82 offen offset:768 sc1
    v_mfma_f32_16x16x32_bf16 a[32:35], v[68:71], v[104:107], a[32:35]
    ds_read_b64_tr_b16 v[36:37], v25 offset:32
    v_lshlrev_b32 v245, 2, v0
    v_mfma_f32_16x16x32_bf16 a[36:39], v[68:71], v[108:111], a[36:39]
    ds_read_b64_tr_b16 v[38:39], v25 offset:1824
    buffer_load_dwordx4 v5, s[4:7], s69 offen offset:3072  lds
    s_mul_i32 s82, s65, 14336
    s_add_u32 s82, s82, 33619968
    v_mfma_f32_16x16x32_bf16 a[40:43], v[68:71], v[112:115], a[40:43]
    ds_read_b64_tr_b16 v[40:41], v24 offset:64
    buffer_load_dword v136, v245, s[12:15], s82 offen offset:0 sc1
    v_mfma_f32_16x16x32_bf16 a[44:47], v[68:71], v[116:119], a[44:47]
    ds_read_b64_tr_b16 v[42:43], v24 offset:1856
    s_add_u32 m0, s56, 0
    buffer_load_dword v137, v245, s[12:15], s82 offen offset:896 sc1
    v_mfma_f32_16x16x32_bf16 a[48:51], v[72:75], v[104:107], a[48:51]
    buffer_load_dwordx4 v6, s[8:11], s70 offen offset:0  lds
    buffer_load_dword v138, v245, s[12:15], s82 offen offset:1792 sc1
    buffer_load_dword v139, v245, s[12:15], s82 offen offset:2688 sc1
    v_mfma_f32_16x16x32_bf16 a[52:55], v[72:75], v[108:111], a[52:55]
    ds_read_b64_tr_b16 v[44:45], v25 offset:96
    s_add_u32 s82, s82, 3584
    v_mfma_f32_16x16x32_bf16 a[56:59], v[72:75], v[112:115], a[56:59]
    ds_read_b64_tr_b16 v[46:47], v25 offset:1888
    buffer_load_dwordx4 v7, s[8:11], s70 offen offset:1024  lds
    buffer_load_dword v140, v245, s[12:15], s82 offen offset:0 sc1
    v_mfma_f32_16x16x32_bf16 a[60:63], v[72:75], v[116:119], a[60:63]
    ds_read_b64_tr_b16 v[48:49], v24 offset:128
    buffer_load_dword v141, v245, s[12:15], s82 offen offset:896 sc1
    buffer_load_dword v142, v245, s[12:15], s82 offen offset:1792 sc1
    v_mfma_f32_16x16x32_bf16 a[64:67], v[76:79], v[104:107], a[64:67]
    ds_read_b64_tr_b16 v[50:51], v24 offset:1920
    buffer_load_dword v143, v245, s[12:15], s82 offen offset:2688 sc1
    v_mfma_f32_16x16x32_bf16 a[68:71], v[76:79], v[108:111], a[68:71]
    buffer_load_dwordx4 v8, s[8:11], s70 offen offset:2048  lds
    s_add_u32 s82, s82, 3584
    v_mfma_f32_16x16x32_bf16 a[72:75], v[76:79], v[112:115], a[72:75]
    ds_read_b64_tr_b16 v[52:53], v25 offset:160
    buffer_load_dword v144, v245, s[12:15], s82 offen offset:0 sc1
    buffer_load_dword v145, v245, s[12:15], s82 offen offset:896 sc1
    v_mfma_f32_16x16x32_bf16 a[76:79], v[76:79], v[116:119], a[76:79]
    ds_read_b64_tr_b16 v[54:55], v25 offset:1952
    buffer_load_dwordx4 v9, s[8:11], s70 offen offset:3072  lds
    buffer_load_dword v146, v245, s[12:15], s82 offen offset:1792 sc1
    v_mfma_f32_16x16x32_bf16 a[80:83], v[80:83], v[104:107], a[80:83]
    ds_read_b64_tr_b16 v[56:57], v26 offset:0
    s_add_u32 m0, s56, 4096
    buffer_load_dword v147, v245, s[12:15], s82 offen offset:2688 sc1
    v_mfma_f32_16x16x32_bf16 a[84:87], v[80:83], v[108:111], a[84:87]
    ds_read_b64_tr_b16 v[58:59], v26 offset:1792
    buffer_load_dwordx4 v10, s[8:11], s70 offen offset:0  lds
    s_add_u32 s82, s82, 3584
    buffer_load_dword v148, v245, s[12:15], s82 offen offset:0 sc1
    v_mfma_f32_16x16x32_bf16 a[88:91], v[80:83], v[112:115], a[88:91]
    buffer_load_dword v149, v245, s[12:15], s82 offen offset:896 sc1
    v_mfma_f32_16x16x32_bf16 a[92:95], v[80:83], v[116:119], a[92:95]
    buffer_load_dwordx4 v11, s[8:11], s70 offen offset:1024  lds
    buffer_load_dword v150, v245, s[12:15], s82 offen offset:1792 sc1
    v_mfma_f32_16x16x32_bf16 a[96:99], v[84:87], v[104:107], a[96:99]
    buffer_load_dword v151, v245, s[12:15], s82 offen offset:2688 sc1
    s_add_u32 s82, s82, 3584
    v_mfma_f32_16x16x32_bf16 a[100:103], v[84:87], v[108:111], a[100:103]
    buffer_load_dwordx4 v12, s[8:11], s70 offen offset:2048  lds
    v_lshlrev_b32 v246, 1, v0
    v_mfma_f32_16x16x32_bf16 a[104:107], v[84:87], v[112:115], a[104:107]
    s_mul_i32 s82, s65, 448
    v_mfma_f32_16x16x32_bf16 a[108:111], v[84:87], v[116:119], a[108:111]
    buffer_load_ushort v152, v246, s[36:39], s82 offen
    s_waitcnt lgkmcnt(0)
    v_mfma_f32_16x16x32_bf16 a[0:3], v[32:35], v[88:91], a[0:3]
    ds_read_b128 v[104:107], v23 offset:0
    v_and_b32 v244, 31, v1
    v_lshrrev_b32 v245, 5, v1
    v_mfma_f32_16x16x32_bf16 a[4:7], v[32:35], v[92:95], a[4:7]
    ds_read_b64_tr_b16 v[60:61], v24 offset:14336
    s_lshl_b32 s92, s65, 5
    v_mfma_f32_16x16x32_bf16 a[8:11], v[32:35], v[96:99], a[8:11]
    v_add_u32 v246, s92, v244
    v_mfma_f32_16x16x32_bf16 a[12:15], v[32:35], v[100:103], a[12:15]
    ds_read_b64_tr_b16 v[62:63], v24 offset:16128
    v_lshlrev_b32 v247, 4, v246
    v_mfma_f32_16x16x32_bf16 a[16:19], v[36:39], v[88:91], a[16:19]
    ds_read_b128 v[108:111], v23 offset:2048
    buffer_load_dwordx4 v[196:199], v247, s[24:27], 0 offen nt
    v_mfma_f32_16x16x32_bf16 a[20:23], v[36:39], v[92:95], a[20:23]
    ds_read_b128 v[112:115], v23 offset:4096
    s_lshl_b32 s92, s64, 7
    v_mfma_f32_16x16x32_bf16 a[24:27], v[36:39], v[96:99], a[24:27]
    ds_read_b128 v[116:119], v23 offset:6144
    s_lshl_b32 s93, s66, 5
    v_mfma_f32_16x16x32_bf16 a[28:31], v[36:39], v[100:103], a[28:31]
    s_add_u32 s92, s92, s93
    v_mfma_f32_16x16x32_bf16 a[32:35], v[40:43], v[88:91], a[32:35]
    ds_read_b64_tr_b16 v[64:65], v25 offset:14368
    v_lshl_add_u32 v245, v245, 4, s92
    v_mfma_f32_16x16x32_bf16 a[36:39], v[40:43], v[92:95], a[36:39]
    ds_read_b64_tr_b16 v[66:67], v25 offset:16160
    v_lshlrev_b32 v247, 11, v245
    v_mfma_f32_16x16x32_bf16 a[40:43], v[40:43], v[96:99], a[40:43]
    ds_read_b64_tr_b16 v[68:69], v24 offset:14400
    v_lshl_add_u32 v247, v246, 2, v247
    v_mfma_f32_16x16x32_bf16 a[44:47], v[40:43], v[100:103], a[44:47]
    ds_read_b64_tr_b16 v[70:71], v24 offset:16192
    v_subrev_u32 v248, 6144, v247
    v_mfma_f32_16x16x32_bf16 a[48:51], v[44:47], v[88:91], a[48:51]
    v_mov_b32 v249, 0x80000000
    v_mfma_f32_16x16x32_bf16 a[52:55], v[44:47], v[92:95], a[52:55]
    ds_read_b64_tr_b16 v[72:73], v25 offset:14432
    v_cmp_eq_u32 vcc, 0, v245
    s_mov_b32 s92, 4096
    s_nop 0
    v_cndmask_b32 v248, v248, v249, vcc
    v_mfma_f32_16x16x32_bf16 a[56:59], v[44:47], v[96:99], a[56:59]
    ds_read_b64_tr_b16 v[74:75], v25 offset:16224
    buffer_load_dword v200, v248, s[16:19], 0 offen nt
    v_mfma_f32_16x16x32_bf16 a[60:63], v[44:47], v[100:103], a[60:63]
    ds_read_b64_tr_b16 v[76:77], v24 offset:14464
    buffer_load_dword v201, v248, s[16:19], 0 offen offset:2048 nt
    v_mfma_f32_16x16x32_bf16 a[64:67], v[48:51], v[88:91], a[64:67]
    ds_read_b64_tr_b16 v[78:79], v24 offset:16256
    buffer_load_dword v202, v248, s[16:19], s92 offen nt
    v_mfma_f32_16x16x32_bf16 a[68:71], v[48:51], v[92:95], a[68:71]
    s_mov_b32 s92, 0
    v_mfma_f32_16x16x32_bf16 a[72:75], v[48:51], v[96:99], a[72:75]
    ds_read_b64_tr_b16 v[80:81], v25 offset:14496
    buffer_load_dword v203, v247, s[16:19], s92 offen nt
    v_mfma_f32_16x16x32_bf16 a[76:79], v[48:51], v[100:103], a[76:79]
    ds_read_b64_tr_b16 v[82:83], v25 offset:16288
    buffer_load_dword v204, v247, s[16:19], s92 offen offset:2048 nt
    v_mfma_f32_16x16x32_bf16 a[80:83], v[52:55], v[88:91], a[80:83]
    ds_read_b64_tr_b16 v[84:85], v26 offset:14336
    buffer_load_dword v220, v247, s[20:23], s92 offen nt
    v_mfma_f32_16x16x32_bf16 a[84:87], v[52:55], v[92:95], a[84:87]
    ds_read_b64_tr_b16 v[86:87], v26 offset:16128
    buffer_load_dword v221, v247, s[20:23], s92 offen offset:2048 nt
    v_mfma_f32_16x16x32_bf16 a[88:91], v[52:55], v[96:99], a[88:91]
    s_mov_b32 s92, 4096
    v_mfma_f32_16x16x32_bf16 a[92:95], v[52:55], v[100:103], a[92:95]
    buffer_load_dword v205, v247, s[16:19], s92 offen nt
    v_mfma_f32_16x16x32_bf16 a[96:99], v[56:59], v[88:91], a[96:99]
    buffer_load_dword v206, v247, s[16:19], s92 offen offset:2048 nt
    v_mfma_f32_16x16x32_bf16 a[100:103], v[56:59], v[92:95], a[100:103]
    buffer_load_dword v222, v247, s[20:23], s92 offen nt
    v_mfma_f32_16x16x32_bf16 a[104:107], v[56:59], v[96:99], a[104:107]
    buffer_load_dword v223, v247, s[20:23], s92 offen offset:2048 nt
    v_mfma_f32_16x16x32_bf16 a[108:111], v[56:59], v[100:103], a[108:111]
    s_mov_b32 s92, 8192
    s_waitcnt vmcnt(44) lgkmcnt(0)
    s_barrier
    v_mfma_f32_16x16x32_bf16 a[0:3], v[60:63], v[104:107], a[0:3]
    ds_read_b128 v[88:91], v27 offset:0
    buffer_load_dword v207, v247, s[16:19], s92 offen nt
    buffer_load_dword v208, v247, s[16:19], s92 offen offset:2048 nt
    v_mfma_f32_16x16x32_bf16 a[4:7], v[60:63], v[108:111], a[4:7]
    ds_read_b64_tr_b16 v[32:33], v29 offset:0
    buffer_load_dword v224, v247, s[20:23], s92 offen nt
    v_mfma_f32_16x16x32_bf16 a[8:11], v[60:63], v[112:115], a[8:11]
    buffer_load_dword v225, v247, s[20:23], s92 offen offset:2048 nt
    v_mfma_f32_16x16x32_bf16 a[12:15], v[60:63], v[116:119], a[12:15]
    ds_read_b64_tr_b16 v[34:35], v29 offset:1792
    s_mov_b32 s92, 12288
    v_mfma_f32_16x16x32_bf16 a[16:19], v[64:67], v[104:107], a[16:19]
    ds_read_b128 v[92:95], v27 offset:2048
    buffer_load_dword v209, v247, s[16:19], s92 offen nt
    v_mfma_f32_16x16x32_bf16 a[20:23], v[64:67], v[108:111], a[20:23]
    ds_read_b128 v[96:99], v27 offset:4096
    buffer_load_dword v210, v247, s[16:19], s92 offen offset:2048 nt
    v_mfma_f32_16x16x32_bf16 a[24:27], v[64:67], v[112:115], a[24:27]
    ds_read_b128 v[100:103], v27 offset:6144
    buffer_load_dword v226, v247, s[20:23], s92 offen nt
    v_mfma_f32_16x16x32_bf16 a[28:31], v[64:67], v[116:119], a[28:31]
    buffer_load_dword v227, v247, s[20:23], s92 offen offset:2048 nt
    v_mfma_f32_16x16x32_bf16 a[32:35], v[68:71], v[104:107], a[32:35]
    ds_read_b64_tr_b16 v[36:37], v30 offset:32
    s_mov_b32 s92, 16384
    v_mfma_f32_16x16x32_bf16 a[36:39], v[68:71], v[108:111], a[36:39]
    ds_read_b64_tr_b16 v[38:39], v30 offset:1824
    buffer_load_dword v211, v247, s[16:19], s92 offen nt
    v_mfma_f32_16x16x32_bf16 a[40:43], v[68:71], v[112:115], a[40:43]
    ds_read_b64_tr_b16 v[40:41], v29 offset:64
    buffer_load_dword v212, v247, s[16:19], s92 offen offset:2048 nt
    v_mfma_f32_16x16x32_bf16 a[44:47], v[68:71], v[116:119], a[44:47]
    ds_read_b64_tr_b16 v[42:43], v29 offset:1856
    buffer_load_dword v228, v247, s[20:23], s92 offen nt
    v_mfma_f32_16x16x32_bf16 a[48:51], v[72:75], v[104:107], a[48:51]
    buffer_load_dword v229, v247, s[20:23], s92 offen offset:2048 nt
    v_mfma_f32_16x16x32_bf16 a[52:55], v[72:75], v[108:111], a[52:55]
    ds_read_b64_tr_b16 v[44:45], v30 offset:96
    s_mov_b32 s92, 20480
    v_mfma_f32_16x16x32_bf16 a[56:59], v[72:75], v[112:115], a[56:59]
    ds_read_b64_tr_b16 v[46:47], v30 offset:1888
    buffer_load_dword v213, v247, s[16:19], s92 offen nt
    v_mfma_f32_16x16x32_bf16 a[60:63], v[72:75], v[116:119], a[60:63]
    ds_read_b64_tr_b16 v[48:49], v29 offset:128
    buffer_load_dword v214, v247, s[16:19], s92 offen offset:2048 nt
    v_mfma_f32_16x16x32_bf16 a[64:67], v[76:79], v[104:107], a[64:67]
    ds_read_b64_tr_b16 v[50:51], v29 offset:1920
    buffer_load_dword v230, v247, s[20:23], s92 offen nt
    v_mfma_f32_16x16x32_bf16 a[68:71], v[76:79], v[108:111], a[68:71]
    buffer_load_dword v231, v247, s[20:23], s92 offen offset:2048 nt
    v_mfma_f32_16x16x32_bf16 a[72:75], v[76:79], v[112:115], a[72:75]
    ds_read_b64_tr_b16 v[52:53], v30 offset:160
    s_mov_b32 s92, 24576
    v_mfma_f32_16x16x32_bf16 a[76:79], v[76:79], v[116:119], a[76:79]
    ds_read_b64_tr_b16 v[54:55], v30 offset:1952
    buffer_load_dword v215, v247, s[16:19], s92 offen nt
    v_mfma_f32_16x16x32_bf16 a[80:83], v[80:83], v[104:107], a[80:83]
    ds_read_b64_tr_b16 v[56:57], v31 offset:0
    buffer_load_dword v216, v247, s[16:19], s92 offen offset:2048 nt
    v_mfma_f32_16x16x32_bf16 a[84:87], v[80:83], v[108:111], a[84:87]
    ds_read_b64_tr_b16 v[58:59], v31 offset:1792
    buffer_load_dword v232, v247, s[20:23], s92 offen nt
    v_mfma_f32_16x16x32_bf16 a[88:91], v[80:83], v[112:115], a[88:91]
    buffer_load_dword v233, v247, s[20:23], s92 offen offset:2048 nt
    v_mfma_f32_16x16x32_bf16 a[92:95], v[80:83], v[116:119], a[92:95]
    s_mov_b32 s92, 28672
    v_mfma_f32_16x16x32_bf16 a[96:99], v[84:87], v[104:107], a[96:99]
    buffer_load_dword v217, v247, s[16:19], s92 offen nt
    v_mfma_f32_16x16x32_bf16 a[100:103], v[84:87], v[108:111], a[100:103]
    buffer_load_dword v218, v247, s[16:19], s92 offen offset:2048 nt
    v_mfma_f32_16x16x32_bf16 a[104:107], v[84:87], v[112:115], a[104:107]
    buffer_load_dword v234, v247, s[20:23], s92 offen nt
    v_mfma_f32_16x16x32_bf16 a[108:111], v[84:87], v[116:119], a[108:111]
    buffer_load_dword v235, v247, s[20:23], s92 offen offset:2048 nt
    s_waitcnt lgkmcnt(0)
    v_mfma_f32_16x16x32_bf16 a[0:3], v[32:35], v[88:91], a[0:3]
    ds_read_b128 v[104:107], v28 offset:0
    s_and_b32 s82, s64, 7
    v_mfma_f32_16x16x32_bf16 a[4:7], v[32:35], v[92:95], a[4:7]
    ds_read_b64_tr_b16 v[60:61], v29 offset:14336
    s_mul_i32 s82, s82, 28
    v_mfma_f32_16x16x32_bf16 a[8:11], v[32:35], v[96:99], a[8:11]
    v_mfma_f32_16x16x32_bf16 a[12:15], v[32:35], v[100:103], a[12:15]
    ds_read_b64_tr_b16 v[62:63], v29 offset:16128
    s_mul_i32 s83, s65, 224
    v_mfma_f32_16x16x32_bf16 a[16:19], v[36:39], v[88:91], a[16:19]
    ds_read_b128 v[108:111], v28 offset:2048
    s_add_u32 s82, s82, s83
    v_mfma_f32_16x16x32_bf16 a[20:23], v[36:39], v[92:95], a[20:23]
    ds_read_b128 v[112:115], v28 offset:4096
    v_mfma_f32_16x16x32_bf16 a[24:27], v[36:39], v[96:99], a[24:27]
    ds_read_b128 v[116:119], v28 offset:6144
    s_lshl_b32 s82, s82, 11
    v_mfma_f32_16x16x32_bf16 a[28:31], v[36:39], v[100:103], a[28:31]
    s_lshl_b32 s83, s101, 8
    v_mfma_f32_16x16x32_bf16 a[32:35], v[40:43], v[88:91], a[32:35]
    ds_read_b64_tr_b16 v[64:65], v30 offset:14368
    v_mfma_f32_16x16x32_bf16 a[36:39], v[40:43], v[92:95], a[36:39]
    ds_read_b64_tr_b16 v[66:67], v30 offset:16160
    s_add_u32 s82, s82, s83
    v_mfma_f32_16x16x32_bf16 a[40:43], v[40:43], v[96:99], a[40:43]
    ds_read_b64_tr_b16 v[68:69], v29 offset:14400
    v_mfma_f32_16x16x32_bf16 a[44:47], v[40:43], v[100:103], a[44:47]
    ds_read_b64_tr_b16 v[70:71], v29 offset:16192
    s_mul_i32 s83, s66, 7
    v_mfma_f32_16x16x32_bf16 a[48:51], v[44:47], v[88:91], a[48:51]
    v_lshrrev_b32 v244, 1, v1
    v_mfma_f32_16x16x32_bf16 a[52:55], v[44:47], v[92:95], a[52:55]
    ds_read_b64_tr_b16 v[72:73], v30 offset:14432
    v_mfma_f32_16x16x32_bf16 a[56:59], v[44:47], v[96:99], a[56:59]
    ds_read_b64_tr_b16 v[74:75], v30 offset:16224
    v_add_u32 v244, s83, v244
    v_mfma_f32_16x16x32_bf16 a[60:63], v[44:47], v[100:103], a[60:63]
    ds_read_b64_tr_b16 v[76:77], v29 offset:14464
    v_lshlrev_b32 v244, 11, v244
    v_mfma_f32_16x16x32_bf16 a[64:67], v[48:51], v[88:91], a[64:67]
    ds_read_b64_tr_b16 v[78:79], v29 offset:16256
    v_mfma_f32_16x16x32_bf16 a[68:71], v[48:51], v[92:95], a[68:71]
    v_and_b32 v245, 1, v1
    v_mfma_f32_16x16x32_bf16 a[72:75], v[48:51], v[96:99], a[72:75]
    ds_read_b64_tr_b16 v[80:81], v30 offset:14496
    v_lshl_add_u32 v244, v245, 7, v244
    v_mfma_f32_16x16x32_bf16 a[76:79], v[48:51], v[100:103], a[76:79]
    ds_read_b64_tr_b16 v[82:83], v30 offset:16288
    v_mfma_f32_16x16x32_bf16 a[80:83], v[52:55], v[88:91], a[80:83]
    ds_read_b64_tr_b16 v[84:85], v31 offset:14336
    s_mov_b32 exec_lo, 0x3fff
    s_mov_b32 exec_hi, 0
    buffer_load_dword v127, v244, s[40:43], s82 offen
    s_mov_b64 exec, -1
    v_mfma_f32_16x16x32_bf16 a[84:87], v[52:55], v[92:95], a[84:87]
    ds_read_b64_tr_b16 v[86:87], v31 offset:16128
    v_mfma_f32_16x16x32_bf16 a[88:91], v[52:55], v[96:99], a[88:91]
    v_mfma_f32_16x16x32_bf16 a[92:95], v[52:55], v[100:103], a[92:95]
    v_mfma_f32_16x16x32_bf16 a[96:99], v[56:59], v[88:91], a[96:99]
    v_mfma_f32_16x16x32_bf16 a[100:103], v[56:59], v[92:95], a[100:103]
    v_mfma_f32_16x16x32_bf16 a[104:107], v[56:59], v[96:99], a[104:107]
    v_mfma_f32_16x16x32_bf16 a[108:111], v[56:59], v[100:103], a[108:111]
    s_waitcnt vmcnt(38) lgkmcnt(0)
    s_barrier
    v_mfma_f32_16x16x32_bf16 a[0:3], v[60:63], v[104:107], a[0:3]
    ds_read_b128 v[88:91], v17 offset:0
    s_lshr_b32 s100, s65, 3
    v_mfma_f32_16x16x32_bf16 a[4:7], v[60:63], v[108:111], a[4:7]
    ds_read_b64_tr_b16 v[32:33], v19 offset:0
    s_and_b32 s101, s65, 7
    v_mfma_f32_16x16x32_bf16 a[8:11], v[60:63], v[112:115], a[8:11]
    s_xor_b32 s101, s101, 0
    v_mfma_f32_16x16x32_bf16 a[12:15], v[60:63], v[116:119], a[12:15]
    ds_read_b64_tr_b16 v[34:35], v19 offset:1792
    s_mov_b32 s16, s12
    v_mfma_f32_16x16x32_bf16 a[16:19], v[64:67], v[104:107], a[16:19]
    ds_read_b128 v[92:95], v17 offset:2048
    s_mov_b32 s17, s13
    v_mfma_f32_16x16x32_bf16 a[20:23], v[64:67], v[108:111], a[20:23]
    ds_read_b128 v[96:99], v17 offset:4096
    s_mov_b32 s18, 0x10000000
    v_mfma_f32_16x16x32_bf16 a[24:27], v[64:67], v[112:115], a[24:27]
    ds_read_b128 v[100:103], v17 offset:6144
    s_mov_b32 s19, 0x20000
    v_mfma_f32_16x16x32_bf16 a[28:31], v[64:67], v[116:119], a[28:31]
    s_lshl_b32 s73, s66, 11
    v_mfma_f32_16x16x32_bf16 a[32:35], v[68:71], v[104:107], a[32:35]
    ds_read_b64_tr_b16 v[36:37], v20 offset:32
    v_lshlrev_b32 v250, 4, v1
    v_mfma_f32_16x16x32_bf16 a[36:39], v[68:71], v[108:111], a[36:39]
    ds_read_b64_tr_b16 v[38:39], v20 offset:1824
    v_add_u32 v16, s73, v250
    v_mfma_f32_16x16x32_bf16 a[40:43], v[68:71], v[112:115], a[40:43]
    ds_read_b64_tr_b16 v[40:41], v19 offset:64
    s_lshl_b32 s76, s67, 2
    v_mfma_f32_16x16x32_bf16 a[44:47], v[68:71], v[116:119], a[44:47]
    ds_read_b64_tr_b16 v[42:43], v19 offset:1856
    s_lshl_b32 s77, s100, 1
    v_mfma_f32_16x16x32_bf16 a[48:51], v[72:75], v[104:107], a[48:51]
    s_add_u32 s78, s76, s77
    v_mfma_f32_16x16x32_bf16 a[52:55], v[72:75], v[108:111], a[52:55]
    ds_read_b64_tr_b16 v[44:45], v20 offset:96
    s_lshl_b32 s78, s78, 10
    v_mfma_f32_16x16x32_bf16 a[56:59], v[72:75], v[112:115], a[56:59]
    ds_read_b64_tr_b16 v[46:47], v20 offset:1888
    s_add_u32 s79, s76, 2
    v_mfma_f32_16x16x32_bf16 a[60:63], v[72:75], v[116:119], a[60:63]
    ds_read_b64_tr_b16 v[48:49], v19 offset:128
    s_sub_u32 s79, s79, s77
    v_mfma_f32_16x16x32_bf16 a[64:67], v[76:79], v[104:107], a[64:67]
    ds_read_b64_tr_b16 v[50:51], v19 offset:1920
    s_lshl_b32 s79, s79, 10
    v_mfma_f32_16x16x32_bf16 a[68:71], v[76:79], v[108:111], a[68:71]
    v_add_u32 v2, s78, v250
    v_mfma_f32_16x16x32_bf16 a[72:75], v[76:79], v[112:115], a[72:75]
    ds_read_b64_tr_b16 v[52:53], v20 offset:160
    v_add_u32 v3, 0x10000, v2
    v_mfma_f32_16x16x32_bf16 a[76:79], v[76:79], v[116:119], a[76:79]
    ds_read_b64_tr_b16 v[54:55], v20 offset:1952
    v_add_u32 v4, s79, v250
    v_mfma_f32_16x16x32_bf16 a[80:83], v[80:83], v[104:107], a[80:83]
    ds_read_b64_tr_b16 v[56:57], v21 offset:0
    v_add_u32 v5, 0x10000, v4
    v_mfma_f32_16x16x32_bf16 a[84:87], v[80:83], v[108:111], a[84:87]
    ds_read_b64_tr_b16 v[58:59], v21 offset:1792
    v_lshlrev_b32 v250, 3, v1
    v_mfma_f32_16x16x32_bf16 a[88:91], v[80:83], v[112:115], a[88:91]
    v_add_u32 v6, s78, v250
    v_mfma_f32_16x16x32_bf16 a[92:95], v[80:83], v[116:119], a[92:95]
    v_add_u32 v7, s79, v250
    v_mfma_f32_16x16x32_bf16 a[96:99], v[84:87], v[104:107], a[96:99]
    v_lshrrev_b32 v250, 4, v1
    v_mfma_f32_16x16x32_bf16 a[100:103], v[84:87], v[108:111], a[100:103]
    v_lshrrev_b32 v251, 2, v1
    v_mfma_f32_16x16x32_bf16 a[104:107], v[84:87], v[112:115], a[104:107]
    v_and_b32 v251, 3, v251
    v_mfma_f32_16x16x32_bf16 a[108:111], v[84:87], v[116:119], a[108:111]
    v_lshl_add_u32 v252, v250, 2, v251
    s_waitcnt lgkmcnt(0)
    v_mfma_f32_16x16x32_bf16 a[0:3], v[32:35], v[88:91], a[0:3]
    ds_read_b128 v[104:107], v18 offset:0
    v_and_b32 v253, 7, v252
    v_mfma_f32_16x16x32_bf16 a[4:7], v[32:35], v[92:95], a[4:7]
    ds_read_b64_tr_b16 v[60:61], v19 offset:14336
    v_lshlrev_b32 v252, 8, v252
    v_mfma_f32_16x16x32_bf16 a[8:11], v[32:35], v[96:99], a[8:11]
    v_and_b32 v254, 3, v1
    v_mfma_f32_16x16x32_bf16 a[12:15], v[32:35], v[100:103], a[12:15]
    ds_read_b64_tr_b16 v[62:63], v19 offset:16128
    v_lshl_add_u32 v252, v254, 3, v252
    v_mfma_f32_16x16x32_bf16 a[16:19], v[36:39], v[88:91], a[16:19]
    ds_read_b128 v[108:111], v18 offset:2048
    v_add_u32 v252, 8192, v252
    v_mfma_f32_16x16x32_bf16 a[20:23], v[36:39], v[92:95], a[20:23]
    ds_read_b128 v[112:115], v18 offset:4096
    s_lshl_b32 s76, s68, 2
    v_mfma_f32_16x16x32_bf16 a[24:27], v[36:39], v[96:99], a[24:27]
    ds_read_b128 v[116:119], v18 offset:6144
    s_add_u32 s77, s76, 0
    v_mfma_f32_16x16x32_bf16 a[28:31], v[36:39], v[100:103], a[28:31]
    v_xor_b32 v254, s77, v253
    v_mfma_f32_16x16x32_bf16 a[32:35], v[40:43], v[88:91], a[32:35]
    ds_read_b64_tr_b16 v[64:65], v20 offset:14368
    v_lshl_add_u32 v8, v254, 5, v252
    v_mfma_f32_16x16x32_bf16 a[36:39], v[40:43], v[92:95], a[36:39]
    ds_read_b64_tr_b16 v[66:67], v20 offset:16160
    v_add_u32 v12, 0x10000, v8
    v_mfma_f32_16x16x32_bf16 a[40:43], v[40:43], v[96:99], a[40:43]
    ds_read_b64_tr_b16 v[68:69], v19 offset:14400
    s_add_u32 s77, s76, 1
    v_mfma_f32_16x16x32_bf16 a[44:47], v[40:43], v[100:103], a[44:47]
    ds_read_b64_tr_b16 v[70:71], v19 offset:16192
    v_xor_b32 v254, s77, v253
    v_mfma_f32_16x16x32_bf16 a[48:51], v[44:47], v[88:91], a[48:51]
    v_lshl_add_u32 v9, v254, 5, v252
    v_mfma_f32_16x16x32_bf16 a[52:55], v[44:47], v[92:95], a[52:55]
    ds_read_b64_tr_b16 v[72:73], v20 offset:14432
    v_add_u32 v13, 0x10000, v9
    v_mfma_f32_16x16x32_bf16 a[56:59], v[44:47], v[96:99], a[56:59]
    ds_read_b64_tr_b16 v[74:75], v20 offset:16224
    s_add_u32 s77, s76, 2
    v_mfma_f32_16x16x32_bf16 a[60:63], v[44:47], v[100:103], a[60:63]
    ds_read_b64_tr_b16 v[76:77], v19 offset:14464
    v_xor_b32 v254, s77, v253
    v_mfma_f32_16x16x32_bf16 a[64:67], v[48:51], v[88:91], a[64:67]
    ds_read_b64_tr_b16 v[78:79], v19 offset:16256
    v_lshl_add_u32 v10, v254, 5, v252
    v_mfma_f32_16x16x32_bf16 a[68:71], v[48:51], v[92:95], a[68:71]
    v_add_u32 v14, 0x10000, v10
    v_mfma_f32_16x16x32_bf16 a[72:75], v[48:51], v[96:99], a[72:75]
    ds_read_b64_tr_b16 v[80:81], v20 offset:14496
    s_add_u32 s77, s76, 3
    v_mfma_f32_16x16x32_bf16 a[76:79], v[48:51], v[100:103], a[76:79]
    ds_read_b64_tr_b16 v[82:83], v20 offset:16288
    v_xor_b32 v254, s77, v253
    v_mfma_f32_16x16x32_bf16 a[80:83], v[52:55], v[88:91], a[80:83]
    ds_read_b64_tr_b16 v[84:85], v21 offset:14336
    v_lshl_add_u32 v11, v254, 5, v252
    v_mfma_f32_16x16x32_bf16 a[84:87], v[52:55], v[92:95], a[84:87]
    ds_read_b64_tr_b16 v[86:87], v21 offset:16128
    v_add_u32 v15, 0x10000, v11
    v_mfma_f32_16x16x32_bf16 a[88:91], v[52:55], v[96:99], a[88:91]
    v_lshrrev_b32 v250, 4, v1
    v_mfma_f32_16x16x32_bf16 a[92:95], v[52:55], v[100:103], a[92:95]
    v_and_b32 v251, 15, v1
    v_mfma_f32_16x16x32_bf16 a[96:99], v[56:59], v[88:91], a[96:99]
    s_lshl_b32 s76, s66, 3
    v_mfma_f32_16x16x32_bf16 a[100:103], v[56:59], v[92:95], a[100:103]
    s_lshl_b32 s77, s101, 8
    v_mfma_f32_16x16x32_bf16 a[104:107], v[56:59], v[96:99], a[104:107]
    v_add_u32 v252, 0, v250
    v_mfma_f32_16x16x32_bf16 a[108:111], v[56:59], v[100:103], a[108:111]
    v_lshlrev_b32 v253, 1, v252
    s_waitcnt lgkmcnt(0)
    v_mfma_f32_16x16x32_bf16 a[0:3], v[60:63], v[104:107], a[0:3]
    v_xor_b32 v253, v253, v251
    v_mfma_f32_16x16x32_bf16 a[4:7], v[60:63], v[108:111], a[4:7]
    v_add_u32 v252, s76, v252
    v_mfma_f32_16x16x32_bf16 a[8:11], v[60:63], v[112:115], a[8:11]
    v_lshlrev_b32 v252, 11, v252
    v_mfma_f32_16x16x32_bf16 a[12:15], v[60:63], v[116:119], a[12:15]
    v_lshl_add_u32 v252, v253, 4, v252
    v_mfma_f32_16x16x32_bf16 a[16:19], v[64:67], v[104:107], a[16:19]
    v_add_u32 v252, s77, v252
    v_mfma_f32_16x16x32_bf16 a[20:23], v[64:67], v[108:111], a[20:23]
    v_subrev_u32 v122, 0, v252
    v_mfma_f32_16x16x32_bf16 a[24:27], v[64:67], v[112:115], a[24:27]
    v_add_u32 v252, 4, v250
    v_mfma_f32_16x16x32_bf16 a[28:31], v[64:67], v[116:119], a[28:31]
    v_lshlrev_b32 v253, 1, v252
    v_mfma_f32_16x16x32_bf16 a[32:35], v[68:71], v[104:107], a[32:35]
    v_xor_b32 v253, v253, v251
    v_mfma_f32_16x16x32_bf16 a[36:39], v[68:71], v[108:111], a[36:39]
    v_add_u32 v252, s76, v252
    v_mfma_f32_16x16x32_bf16 a[40:43], v[68:71], v[112:115], a[40:43]
    v_lshlrev_b32 v252, 11, v252
    v_mfma_f32_16x16x32_bf16 a[44:47], v[68:71], v[116:119], a[44:47]
    v_lshl_add_u32 v252, v253, 4, v252
    v_mfma_f32_16x16x32_bf16 a[48:51], v[72:75], v[104:107], a[48:51]
    v_add_u32 v252, s77, v252
    v_mfma_f32_16x16x32_bf16 a[52:55], v[72:75], v[108:111], a[52:55]
    v_subrev_u32 v123, 1024, v252
    v_mfma_f32_16x16x32_bf16 a[56:59], v[72:75], v[112:115], a[56:59]
    s_lshl_b32 s76, s64, 4
    v_mfma_f32_16x16x32_bf16 a[60:63], v[72:75], v[116:119], a[60:63]
    s_add_u32 s76, s76, s65
    v_mfma_f32_16x16x32_bf16 a[64:67], v[76:79], v[104:107], a[64:67]
    s_mul_i32 s70, s65, 458752
    v_mfma_f32_16x16x32_bf16 a[68:71], v[76:79], v[108:111], a[68:71]
    s_mov_b32 s71, 0
    v_mfma_f32_16x16x32_bf16 a[72:75], v[76:79], v[112:115], a[72:75]
    s_mov_b32 s72, 0
    v_mfma_f32_16x16x32_bf16 a[76:79], v[76:79], v[116:119], a[76:79]
    s_and_b32 s74, s65, 7
    v_mfma_f32_16x16x32_bf16 a[80:83], v[80:83], v[104:107], a[80:83]
    s_cmp_ge_u32 s72, s74
    s_addc_u32 s78, s72, 0
    v_mfma_f32_16x16x32_bf16 a[84:87], v[80:83], v[108:111], a[84:87]
    s_lshl_b32 s79, s100, 3
    v_mfma_f32_16x16x32_bf16 a[88:91], v[80:83], v[112:115], a[88:91]
    s_add_u32 s78, s78, s79
    v_mfma_f32_16x16x32_bf16 a[92:95], v[80:83], v[116:119], a[92:95]
    s_add_u32 s72, s72, 1
    v_mfma_f32_16x16x32_bf16 a[96:99], v[84:87], v[104:107], a[96:99]
    s_lshl_b32 s79, s64, 4
    v_mfma_f32_16x16x32_bf16 a[100:103], v[84:87], v[108:111], a[100:103]
    s_add_u32 s78, s78, s79
    v_mfma_f32_16x16x32_bf16 a[104:107], v[84:87], v[112:115], a[104:107]
    s_mul_i32 s69, s78, 57344
    v_mfma_f32_16x16x32_bf16 a[108:111], v[84:87], v[116:119], a[108:111]
    s_add_u32 s69, s69, 0
    s_waitcnt vmcnt(1)
L_g1end:
    v_lshlrev_b32 v154, 16, v196
    v_lshlrev_b32 v155, 16, v198
    v_and_b32 v156, 0xffff0000, v196
    v_and_b32 v157, 0xffff0000, v198
    v_lshlrev_b32 v158, 16, v197
    v_lshlrev_b32 v159, 16, v199
    v_and_b32 v160, 0xffff0000, v197
    v_and_b32 v161, 0xffff0000, v199
    v_lshlrev_b32 v162, 16, v200
    v_and_b32 v163, 0xffff0000, v200
    v_lshlrev_b32 v164, 16, v201
    v_and_b32 v165, 0xffff0000, v201
    v_lshlrev_b32 v166, 16, v202
    v_and_b32 v167, 0xffff0000, v202
    v_lshlrev_b32 v168, 16, v203
    v_and_b32 v169, 0xffff0000, v203
    v_lshlrev_b32 v170, 16, v220
    v_and_b32 v171, 0xffff0000, v220
    v_pk_mul_f32 v[174:175], v[162:163], v[160:161]
    v_pk_fma_f32 v[174:175], v[164:165], v[158:159], v[174:175]
    v_pk_fma_f32 v[174:175], v[166:167], v[156:157], v[174:175]
    v_pk_fma_f32 v[174:175], v[168:169], v[154:155], v[174:175]
    v_pk_mul_f32 v[174:175], v[174:175], v[170:171]
    v_lshlrev_b32 v162, 16, v204
    v_and_b32 v163, 0xffff0000, v204
    v_lshlrev_b32 v172, 16, v221
    v_and_b32 v173, 0xffff0000, v221
    v_pk_mul_f32 v[176:177], v[164:165], v[160:161]
    v_pk_fma_f32 v[176:177], v[166:167], v[158:159], v[176:177]
    v_pk_fma_f32 v[176:177], v[168:169], v[156:157], v[176:177]
    v_pk_fma_f32 v[176:177], v[162:163], v[154:155], v[176:177]
    v_pk_mul_f32 v[176:177], v[176:177], v[172:173]
    v_lshlrev_b32 v164, 16, v205
    v_and_b32 v165, 0xffff0000, v205
    v_lshlrev_b32 v170, 16, v222
    v_and_b32 v171, 0xffff0000, v222
    v_pk_mul_f32 v[178:179], v[166:167], v[160:161]
    v_pk_fma_f32 v[178:179], v[168:169], v[158:159], v[178:179]
    v_pk_fma_f32 v[178:179], v[162:163], v[156:157], v[178:179]
    v_pk_fma_f32 v[178:179], v[164:165], v[154:155], v[178:179]
    v_pk_mul_f32 v[178:179], v[178:179], v[170:171]
    v_lshlrev_b32 v166, 16, v206
    v_and_b32 v167, 0xffff0000, v206
    v_lshlrev_b32 v172, 16, v223
    v_and_b32 v173, 0xffff0000, v223
    v_pk_mul_f32 v[180:181], v[168:169], v[160:161]
    v_pk_fma_f32 v[180:181], v[162:163], v[158:159], v[180:181]
    v_pk_fma_f32 v[180:181], v[164:165], v[156:157], v[180:181]
    v_pk_fma_f32 v[180:181], v[166:167], v[154:155], v[180:181]
    v_pk_mul_f32 v[180:181], v[180:181], v[172:173]
    v_lshlrev_b32 v168, 16, v207
    v_and_b32 v169, 0xffff0000, v207
    v_lshlrev_b32 v170, 16, v224
    v_and_b32 v171, 0xffff0000, v224
    v_pk_mul_f32 v[182:183], v[162:163], v[160:161]
    v_pk_fma_f32 v[182:183], v[164:165], v[158:159], v[182:183]
    v_pk_fma_f32 v[182:183], v[166:167], v[156:157], v[182:183]
    v_pk_fma_f32 v[182:183], v[168:169], v[154:155], v[182:183]
    v_pk_mul_f32 v[182:183], v[182:183], v[170:171]
    v_cvt_pk_bf16_f32 v32, v174, v182
    v_cvt_pk_bf16_f32 v40, v175, v183
    v_lshlrev_b32 v162, 16, v208
    v_and_b32 v163, 0xffff0000, v208
    v_lshlrev_b32 v172, 16, v225
    v_and_b32 v173, 0xffff0000, v225
    v_pk_mul_f32 v[184:185], v[164:165], v[160:161]
    v_pk_fma_f32 v[184:185], v[166:167], v[158:159], v[184:185]
    v_pk_fma_f32 v[184:185], v[168:169], v[156:157], v[184:185]
    v_pk_fma_f32 v[184:185], v[162:163], v[154:155], v[184:185]
    v_pk_mul_f32 v[184:185], v[184:185], v[172:173]
    v_cvt_pk_bf16_f32 v34, v176, v184
    v_cvt_pk_bf16_f32 v42, v177, v185
    v_lshlrev_b32 v164, 16, v209
    v_and_b32 v165, 0xffff0000, v209
    v_lshlrev_b32 v170, 16, v226
    v_and_b32 v171, 0xffff0000, v226
    v_pk_mul_f32 v[186:187], v[166:167], v[160:161]
    v_pk_fma_f32 v[186:187], v[168:169], v[158:159], v[186:187]
    v_pk_fma_f32 v[186:187], v[162:163], v[156:157], v[186:187]
    v_pk_fma_f32 v[186:187], v[164:165], v[154:155], v[186:187]
    v_pk_mul_f32 v[186:187], v[186:187], v[170:171]
    v_cvt_pk_bf16_f32 v36, v178, v186
    v_cvt_pk_bf16_f32 v44, v179, v187
    v_lshlrev_b32 v166, 16, v210
    v_and_b32 v167, 0xffff0000, v210
    v_lshlrev_b32 v172, 16, v227
    v_and_b32 v173, 0xffff0000, v227
    v_pk_mul_f32 v[188:189], v[168:169], v[160:161]
    v_pk_fma_f32 v[188:189], v[162:163], v[158:159], v[188:189]
    v_pk_fma_f32 v[188:189], v[164:165], v[156:157], v[188:189]
    v_pk_fma_f32 v[188:189], v[166:167], v[154:155], v[188:189]
    v_pk_mul_f32 v[188:189], v[188:189], v[172:173]
    v_cvt_pk_bf16_f32 v38, v180, v188
    v_cvt_pk_bf16_f32 v46, v181, v189
    v_lshlrev_b32 v168, 16, v211
    v_and_b32 v169, 0xffff0000, v211
    v_lshlrev_b32 v170, 16, v228
    v_and_b32 v171, 0xffff0000, v228
    v_pk_mul_f32 v[174:175], v[162:163], v[160:161]
    v_pk_fma_f32 v[174:175], v[164:165], v[158:159], v[174:175]
    v_pk_fma_f32 v[174:175], v[166:167], v[156:157], v[174:175]
    v_pk_fma_f32 v[174:175], v[168:169], v[154:155], v[174:175]
    v_pk_mul_f32 v[174:175], v[174:175], v[170:171]
    v_lshlrev_b32 v162, 16, v212
    v_and_b32 v163, 0xffff0000, v212
    v_lshlrev_b32 v172, 16, v229
    v_and_b32 v173, 0xffff0000, v229
    v_pk_mul_f32 v[176:177], v[164:165], v[160:161]
    v_pk_fma_f32 v[176:177], v[166:167], v[158:159], v[176:177]
    v_pk_fma_f32 v[176:177], v[168:169], v[156:157], v[176:177]
    v_pk_fma_f32 v[176:177], v[162:163], v[154:155], v[176:177]
    v_pk_mul_f32 v[176:177], v[176:177], v[172:173]
    v_lshlrev_b32 v164, 16, v213
    v_and_b32 v165, 0xffff0000, v213
    v_lshlrev_b32 v170, 16, v230
    v_and_b32 v171, 0xffff0000, v230
    v_pk_mul_f32 v[178:179], v[166:167], v[160:161]
    v_pk_fma_f32 v[178:179], v[168:169], v[158:159], v[178:179]
    v_pk_fma_f32 v[178:179], v[162:163], v[156:157], v[178:179]
    v_pk_fma_f32 v[178:179], v[164:165], v[154:155], v[178:179]
    v_pk_mul_f32 v[178:179], v[178:179], v[170:171]
    v_lshlrev_b32 v166, 16, v214
    v_and_b32 v167, 0xffff0000, v214
    v_lshlrev_b32 v172, 16, v231
    v_and_b32 v173, 0xffff0000, v231
    v_pk_mul_f32 v[180:181], v[168:169], v[160:161]
    v_pk_fma_f32 v[180:181], v[162:163], v[158:159], v[180:181]
    v_pk_fma_f32 v[180:181], v[164:165], v[156:157], v[180:181]
    v_pk_fma_f32 v[180:181], v[166:167], v[154:155], v[180:181]
    v_pk_mul_f32 v[180:181], v[180:181], v[172:173]
    v_lshlrev_b32 v168, 16, v215
    v_and_b32 v169, 0xffff0000, v215
    v_lshlrev_b32 v170, 16, v232
    v_and_b32 v171, 0xffff0000, v232
    v_pk_mul_f32 v[182:183], v[162:163], v[160:161]
    v_pk_fma_f32 v[182:183], v[164:165], v[158:159], v[182:183]
    v_pk_fma_f32 v[182:183], v[166:167], v[156:157], v[182:183]
    v_pk_fma_f32 v[182:183], v[168:169], v[154:155], v[182:183]
    v_pk_mul_f32 v[182:183], v[182:183], v[170:171]
    v_cvt_pk_bf16_f32 v33, v174, v182
    v_cvt_pk_bf16_f32 v41, v175, v183
    v_lshlrev_b32 v162, 16, v216
    v_and_b32 v163, 0xffff0000, v216
    v_lshlrev_b32 v172, 16, v233
    v_and_b32 v173, 0xffff0000, v233
    v_pk_mul_f32 v[184:185], v[164:165], v[160:161]
    v_pk_fma_f32 v[184:185], v[166:167], v[158:159], v[184:185]
    v_pk_fma_f32 v[184:185], v[168:169], v[156:157], v[184:185]
    v_pk_fma_f32 v[184:185], v[162:163], v[154:155], v[184:185]
    v_pk_mul_f32 v[184:185], v[184:185], v[172:173]
    v_cvt_pk_bf16_f32 v35, v176, v184
    v_cvt_pk_bf16_f32 v43, v177, v185
    v_lshlrev_b32 v164, 16, v217
    v_and_b32 v165, 0xffff0000, v217
    v_lshlrev_b32 v170, 16, v234
    v_and_b32 v171, 0xffff0000, v234
    v_pk_mul_f32 v[186:187], v[166:167], v[160:161]
    v_pk_fma_f32 v[186:187], v[168:169], v[158:159], v[186:187]
    v_pk_fma_f32 v[186:187], v[162:163], v[156:157], v[186:187]
    v_pk_fma_f32 v[186:187], v[164:165], v[154:155], v[186:187]
    v_pk_mul_f32 v[186:187], v[186:187], v[170:171]
    v_cvt_pk_bf16_f32 v37, v178, v186
    v_cvt_pk_bf16_f32 v45, v179, v187
    v_lshlrev_b32 v166, 16, v218
    v_and_b32 v167, 0xffff0000, v218
    v_lshlrev_b32 v172, 16, v235
    v_and_b32 v173, 0xffff0000, v235
    v_pk_mul_f32 v[188:189], v[168:169], v[160:161]
    v_pk_fma_f32 v[188:189], v[162:163], v[158:159], v[188:189]
    v_pk_fma_f32 v[188:189], v[164:165], v[156:157], v[188:189]
    v_pk_fma_f32 v[188:189], v[166:167], v[154:155], v[188:189]
    v_pk_mul_f32 v[188:189], v[188:189], v[172:173]
    v_cvt_pk_bf16_f32 v39, v180, v188
    v_cvt_pk_bf16_f32 v47, v181, v189
    v_and_b32 v244, 31, v1
    v_lshrrev_b32 v245, 5, v1
    v_and_b32 v246, 15, v1
    v_lshlrev_b32 v247, 9, v244
    v_lshl_add_u32 v247, v245, 3, v247
    v_add_u32 v247, 114688, v247
    s_add_u32 s82, s66, 0
    v_xor_b32 v248, s82, v246
    v_lshl_add_u32 v248, v248, 4, v247
    ds_write_b64 v248, v[32:33]
    ds_write_b64 v248, v[40:41] offset:256
    s_add_u32 s82, s66, 4
    v_xor_b32 v248, s82, v246
    v_lshl_add_u32 v248, v248, 4, v247
    ds_write_b64 v248, v[34:35]
    ds_write_b64 v248, v[42:43] offset:256
    s_add_u32 s82, s66, 8
    v_xor_b32 v248, s82, v246
    v_lshl_add_u32 v248, v248, 4, v247
    ds_write_b64 v248, v[36:37]
    ds_write_b64 v248, v[44:45] offset:256
    s_add_u32 s82, s66, 12
    v_xor_b32 v248, s82, v246
    v_lshl_add_u32 v248, v248, 4, v247
    ds_write_b64 v248, v[38:39]
    ds_write_b64 v248, v[46:47] offset:256
    v_add_f32 v136, v136, v137
    v_add_f32 v136, v136, v138
    v_add_f32 v136, v136, v139
    v_add_f32 v136, v136, v140
    v_add_f32 v136, v136, v141
    v_add_f32 v136, v136, v142
    v_add_f32 v136, v136, v143
    v_add_f32 v136, v136, v144
    v_add_f32 v136, v136, v145
    v_add_f32 v136, v136, v146
    v_add_f32 v136, v136, v147
    v_add_f32 v136, v136, v148
    v_add_f32 v136, v136, v149
    v_add_f32 v136, v136, v150
    v_add_f32 v136, v136, v151
    v_lshlrev_b32 v244, 2, v0
    v_add_u32 v244, 152832, v244
    v_lshlrev_b32 v152, 16, v152
    v_cmp_gt_u32 vcc, 224, v0
    s_and_saveexec_b64 s[90:91], vcc
    ds_write_b32 v244, v136
    ds_write_b32 v244, v152 offset:896
    s_mov_b64 exec, s[90:91]
    s_waitcnt lgkmcnt(0)
    s_barrier
    v_lshrrev_b32 v244, 4, v1
    s_lshl_b32 s82, s66, 4
    v_add_u32 v244, s82, v244
    v_and_b32 v245, 15, v1
    v_add_u32 v246, 0, v244
    v_lshrrev_b32 v247, 1, v246
    v_and_b32 v247, 15, v247
    v_xor_b32 v247, v247, v245
    v_lshlrev_b32 v247, 4, v247
    v_lshl_add_u32 v247, v246, 8, v247
    v_add_u32 v247, 114688, v247
    ds_read_b128 v[196:199], v247
    v_lshlrev_b32 v246, 12, v246
    v_lshl_add_u32 v220, v245, 4, v246
    v_add_u32 v246, 4, v244
    v_lshrrev_b32 v247, 1, v246
    v_and_b32 v247, 15, v247
    v_xor_b32 v247, v247, v245
    v_lshlrev_b32 v247, 4, v247
    v_lshl_add_u32 v247, v246, 8, v247
    v_add_u32 v247, 114688, v247
    ds_read_b128 v[200:203], v247
    v_lshlrev_b32 v246, 12, v246
    v_lshl_add_u32 v221, v245, 4, v246
    v_add_u32 v246, 8, v244
    v_lshrrev_b32 v247, 1, v246
    v_and_b32 v247, 15, v247
    v_xor_b32 v247, v247, v245
    v_lshlrev_b32 v247, 4, v247
    v_lshl_add_u32 v247, v246, 8, v247
    v_add_u32 v247, 114688, v247
    ds_read_b128 v[204:207], v247
    v_lshlrev_b32 v246, 12, v246
    v_lshl_add_u32 v222, v245, 4, v246
    v_add_u32 v246, 12, v244
    v_lshrrev_b32 v247, 1, v246
    v_and_b32 v247, 15, v247
    v_xor_b32 v247, v247, v245
    v_lshlrev_b32 v247, 4, v247
    v_lshl_add_u32 v247, v246, 8, v247
    v_add_u32 v247, 114688, v247
    ds_read_b128 v[208:211], v247
    v_lshlrev_b32 v246, 12, v246
    v_lshl_add_u32 v223, v245, 4, v246
    s_lshl_b32 s82, s65, 18
    s_lshl_b32 s83, s64, 8
    s_add_u32 s82, s82, s83
    s_add_u32 s82, s82, 16777216
    s_waitcnt lgkmcnt(0)
    buffer_store_dwordx4 v[196:199], v220, s[12:15], s82 offen sc1
    buffer_store_dwordx4 v[200:203], v221, s[12:15], s82 offen sc1
    buffer_store_dwordx4 v[204:207], v222, s[12:15], s82 offen sc1
    buffer_store_dwordx4 v[208:211], v223, s[12:15], s82 offen sc1
    v_lshrrev_b32 v240, 4, v1
    v_lshlrev_b32 v240, 4, v240
    s_lshl_b32 s76, s68, 9
    s_add_u32 s76, s76, 152832
    v_add_u32 v241, s76, v240
    s_lshl_b32 s76, s68, 6
    s_add_u32 s76, s76, 153216
    v_add_u32 v242, s76, v240
    ds_read_b128 v[32:35], v241 offset:0
    ds_read_b128 v[60:63], v241 offset:896
    ds_read_b128 v[36:39], v241 offset:64
    ds_read_b128 v[64:67], v241 offset:960
    ds_read_b128 v[40:43], v241 offset:128
    ds_read_b128 v[68:71], v241 offset:1024
    ds_read_b128 v[44:47], v241 offset:192
    ds_read_b128 v[72:75], v241 offset:1088
    ds_read_b128 v[48:51], v241 offset:256
    ds_read_b128 v[76:79], v241 offset:1152
    ds_read_b128 v[52:55], v241 offset:320
    ds_read_b128 v[80:83], v241 offset:1216
    ds_read_b128 v[56:59], v242
    ds_read_b128 v[84:87], v242 offset:896
    s_mov_b32 s92, 0xbdd2d3e8
    s_mov_b32 s93, 0xbdd2d3e8
    s_mov_b32 s94, 1.0
    s_mov_b32 s95, 1.0
    v_mov_b32 v88, 0xc0135761
    v_mov_b32 v89, 0xc0135761
    v_lshlrev_b32 v90, 4, v1
    s_lshl_b32 s76, s67, 12
    v_add_u32 v90, s76, v90
    v_lshlrev_b32 v91, 3, v1
    s_lshl_b32 s77, s68, 9
    s_add_u32 s76, s76, s77
    v_add_u32 v91, s76, v91
    s_lshl_b32 s76, s68, 16
    v_add_u32 v92, s76, v90
    s_lshl_b32 s76, s64, 4
    s_add_u32 s76, s76, s65
    s_mul_i32 s76, s76, 57344
    s_add_u32 s76, s76, 0
    s_add_u32 s85, s76, 24576
    s_lshl_b32 s77, s68, 15
    s_add_u32 s82, s76, s77
    s_add_u32 s83, s82, 8192
    s_add_u32 s84, s82, 16384
    s_waitcnt lgkmcnt(0)
    v_accvgpr_read_b32 v154, a0
    v_accvgpr_read_b32 v155, a1
    v_pk_fma_f32 v[162:163], v[32:33], v[128:129], v[60:61] op_sel:[0,1,0] op_sel_hi:[1,1,1] neg_lo:[0,1,0] neg_hi:[0,1,0]
    v_accvgpr_read_b32 v156, a2
    v_accvgpr_read_b32 v157, a3
    v_pk_fma_f32 v[164:165], v[34:35], v[128:129], v[62:63] op_sel:[0,1,0] op_sel_hi:[1,1,1] neg_lo:[0,1,0] neg_hi:[0,1,0]
    v_accvgpr_read_b32 v158, a16
    v_accvgpr_read_b32 v159, a17
    v_pk_fma_f32 v[166:167], v[36:37], v[128:129], v[64:65] op_sel:[0,1,0] op_sel_hi:[1,1,1] neg_lo:[0,1,0] neg_hi:[0,1,0]
    v_accvgpr_read_b32 v160, a18
    v_accvgpr_read_b32 v161, a19
    v_pk_fma_f32 v[168:169], v[38:39], v[128:129], v[66:67] op_sel:[0,1,0] op_sel_hi:[1,1,1] neg_lo:[0,1,0] neg_hi:[0,1,0]
    v_pk_fma_f32 v[154:155], v[154:155], v[128:129], v[162:163] op_sel_hi:[1,0,1]
    v_pk_fma_f32 v[156:157], v[156:157], v[128:129], v[164:165] op_sel_hi:[1,0,1]
    v_pk_fma_f32 v[158:159], v[158:159], v[128:129], v[166:167] op_sel_hi:[1,0,1]
    v_pk_fma_f32 v[160:161], v[160:161], v[128:129], v[168:169] op_sel_hi:[1,0,1]
    v_pk_mul_f32 v[162:163], v[154:155], v[154:155]
    v_pk_mul_f32 v[164:165], v[156:157], v[156:157]
    v_pk_mul_f32 v[166:167], v[158:159], v[158:159]
    v_pk_mul_f32 v[168:169], v[160:161], v[160:161]
    v_pk_fma_f32 v[162:163], v[162:163], s[92:93], v[88:89]
    v_pk_fma_f32 v[164:165], v[164:165], s[92:93], v[88:89]
    v_pk_fma_f32 v[166:167], v[166:167], s[92:93], v[88:89]
    v_pk_fma_f32 v[168:169], v[168:169], s[92:93], v[88:89]
    v_pk_mul_f32 v[162:163], v[154:155], v[162:163]
    v_pk_mul_f32 v[164:165], v[156:157], v[164:165]
    v_pk_mul_f32 v[166:167], v[158:159], v[166:167]
    v_pk_mul_f32 v[168:169], v[160:161], v[168:169]
    v_exp_f32 v162, v162
    v_exp_f32 v163, v163
    v_exp_f32 v164, v164
    v_exp_f32 v165, v165
    v_exp_f32 v166, v166
    v_exp_f32 v167, v167
    v_exp_f32 v168, v168
    v_exp_f32 v169, v169
    v_pk_add_f32 v[162:163], v[162:163], s[94:95]
    v_pk_add_f32 v[164:165], v[164:165], s[94:95]
    v_pk_add_f32 v[166:167], v[166:167], s[94:95]
    v_pk_add_f32 v[168:169], v[168:169], s[94:95]
    v_rcp_f32 v162, v162
    v_rcp_f32 v163, v163
    v_rcp_f32 v164, v164
    v_rcp_f32 v165, v165
    v_rcp_f32 v166, v166
    v_rcp_f32 v167, v167
    v_rcp_f32 v168, v168
    v_rcp_f32 v169, v169
    v_pk_mul_f32 v[154:155], v[154:155], v[162:163]
    v_pk_mul_f32 v[156:157], v[156:157], v[164:165]
    v_pk_mul_f32 v[158:159], v[158:159], v[166:167]
    v_pk_mul_f32 v[160:161], v[160:161], v[168:169]
    v_cvt_pk_bf16_f32 v170, v154, v155
    v_cvt_pk_bf16_f32 v171, v156, v157
    v_cvt_pk_bf16_f32 v172, v158, v159
    v_cvt_pk_bf16_f32 v173, v160, v161
    buffer_store_dwordx4 v[170:173], v90, s[12:15], s82 offen offset:0 sc1
    ds_write_b128 v92, v[170:173] offset:0
    s_add_u32 m0, s73, 8192
    s_nop 0
    buffer_load_dwordx4 v122, s[40:43], s70 offen lds
    v_accvgpr_read_b32 v154, a4
    v_accvgpr_read_b32 v155, a5
    v_pk_fma_f32 v[162:163], v[32:33], v[130:131], v[60:61] op_sel:[0,1,0] op_sel_hi:[1,1,1] neg_lo:[0,1,0] neg_hi:[0,1,0]
    v_accvgpr_read_b32 v156, a6
    v_accvgpr_read_b32 v157, a7
    v_pk_fma_f32 v[164:165], v[34:35], v[130:131], v[62:63] op_sel:[0,1,0] op_sel_hi:[1,1,1] neg_lo:[0,1,0] neg_hi:[0,1,0]
    v_accvgpr_read_b32 v158, a20
    v_accvgpr_read_b32 v159, a21
    v_pk_fma_f32 v[166:167], v[36:37], v[130:131], v[64:65] op_sel:[0,1,0] op_sel_hi:[1,1,1] neg_lo:[0,1,0] neg_hi:[0,1,0]
    v_accvgpr_read_b32 v160, a22
    v_accvgpr_read_b32 v161, a23
    v_pk_fma_f32 v[168:169], v[38:39], v[130:131], v[66:67] op_sel:[0,1,0] op_sel_hi:[1,1,1] neg_lo:[0,1,0] neg_hi:[0,1,0]
    v_pk_fma_f32 v[154:155], v[154:155], v[130:131], v[162:163] op_sel_hi:[1,0,1]
    v_pk_fma_f32 v[156:157], v[156:157], v[130:131], v[164:165] op_sel_hi:[1,0,1]
    v_pk_fma_f32 v[158:159], v[158:159], v[130:131], v[166:167] op_sel_hi:[1,0,1]
    v_pk_fma_f32 v[160:161], v[160:161], v[130:131], v[168:169] op_sel_hi:[1,0,1]
    v_pk_mul_f32 v[162:163], v[154:155], v[154:155]
    v_pk_mul_f32 v[164:165], v[156:157], v[156:157]
    v_pk_mul_f32 v[166:167], v[158:159], v[158:159]
    v_pk_mul_f32 v[168:169], v[160:161], v[160:161]
    v_pk_fma_f32 v[162:163], v[162:163], s[92:93], v[88:89]
    v_pk_fma_f32 v[164:165], v[164:165], s[92:93], v[88:89]
    v_pk_fma_f32 v[166:167], v[166:167], s[92:93], v[88:89]
    v_pk_fma_f32 v[168:169], v[168:169], s[92:93], v[88:89]
    v_pk_mul_f32 v[162:163], v[154:155], v[162:163]
    v_pk_mul_f32 v[164:165], v[156:157], v[164:165]
    v_pk_mul_f32 v[166:167], v[158:159], v[166:167]
    v_pk_mul_f32 v[168:169], v[160:161], v[168:169]
    v_exp_f32 v162, v162
    v_exp_f32 v163, v163
    v_exp_f32 v164, v164
    v_exp_f32 v165, v165
    v_exp_f32 v166, v166
    v_exp_f32 v167, v167
    v_exp_f32 v168, v168
    v_exp_f32 v169, v169
    v_pk_add_f32 v[162:163], v[162:163], s[94:95]
    v_pk_add_f32 v[164:165], v[164:165], s[94:95]
    v_pk_add_f32 v[166:167], v[166:167], s[94:95]
    v_pk_add_f32 v[168:169], v[168:169], s[94:95]
    v_rcp_f32 v162, v162
    v_rcp_f32 v163, v163
    v_rcp_f32 v164, v164
    v_rcp_f32 v165, v165
    v_rcp_f32 v166, v166
    v_rcp_f32 v167, v167
    v_rcp_f32 v168, v168
    v_rcp_f32 v169, v169
    v_pk_mul_f32 v[154:155], v[154:155], v[162:163]
    v_pk_mul_f32 v[156:157], v[156:157], v[164:165]
    v_pk_mul_f32 v[158:159], v[158:159], v[166:167]
    v_pk_mul_f32 v[160:161], v[160:161], v[168:169]
    v_cvt_pk_bf16_f32 v174, v154, v155
    v_cvt_pk_bf16_f32 v175, v156, v157
    v_cvt_pk_bf16_f32 v176, v158, v159
    v_cvt_pk_bf16_f32 v177, v160, v161
    buffer_store_dwordx4 v[174:177], v90, s[12:15], s82 offen offset:1024 sc1
    ds_write_b128 v92, v[174:177] offset:1024
    buffer_load_dwordx4 v123, s[40:43], s70 offen offset:1024 lds
    s_add_u32 s70, s70, 65536
    v_accvgpr_read_b32 v154, a8
    v_accvgpr_read_b32 v155, a9
    v_pk_fma_f32 v[162:163], v[32:33], v[132:133], v[60:61] op_sel:[0,1,0] op_sel_hi:[1,1,1] neg_lo:[0,1,0] neg_hi:[0,1,0]
    v_accvgpr_read_b32 v156, a10
    v_accvgpr_read_b32 v157, a11
    v_pk_fma_f32 v[164:165], v[34:35], v[132:133], v[62:63] op_sel:[0,1,0] op_sel_hi:[1,1,1] neg_lo:[0,1,0] neg_hi:[0,1,0]
    v_accvgpr_read_b32 v158, a24
    v_accvgpr_read_b32 v159, a25
    v_pk_fma_f32 v[166:167], v[36:37], v[132:133], v[64:65] op_sel:[0,1,0] op_sel_hi:[1,1,1] neg_lo:[0,1,0] neg_hi:[0,1,0]
    v_accvgpr_read_b32 v160, a26
    v_accvgpr_read_b32 v161, a27
    v_pk_fma_f32 v[168:169], v[38:39], v[132:133], v[66:67] op_sel:[0,1,0] op_sel_hi:[1,1,1] neg_lo:[0,1,0] neg_hi:[0,1,0]
    v_pk_fma_f32 v[154:155], v[154:155], v[132:133], v[162:163] op_sel_hi:[1,0,1]
    v_pk_fma_f32 v[156:157], v[156:157], v[132:133], v[164:165] op_sel_hi:[1,0,1]
    v_pk_fma_f32 v[158:159], v[158:159], v[132:133], v[166:167] op_sel_hi:[1,0,1]
    v_pk_fma_f32 v[160:161], v[160:161], v[132:133], v[168:169] op_sel_hi:[1,0,1]
    v_pk_mul_f32 v[162:163], v[154:155], v[154:155]
    v_pk_mul_f32 v[164:165], v[156:157], v[156:157]
    v_pk_mul_f32 v[166:167], v[158:159], v[158:159]
    v_pk_mul_f32 v[168:169], v[160:161], v[160:161]
    v_pk_fma_f32 v[162:163], v[162:163], s[92:93], v[88:89]
    v_pk_fma_f32 v[164:165], v[164:165], s[92:93], v[88:89]
    v_pk_fma_f32 v[166:167], v[166:167], s[92:93], v[88:89]
    v_pk_fma_f32 v[168:169], v[168:169], s[92:93], v[88:89]
    v_pk_mul_f32 v[162:163], v[154:155], v[162:163]
    v_pk_mul_f32 v[164:165], v[156:157], v[164:165]
    v_pk_mul_f32 v[166:167], v[158:159], v[166:167]
    v_pk_mul_f32 v[168:169], v[160:161], v[168:169]
    v_exp_f32 v162, v162
    v_exp_f32 v163, v163
    v_exp_f32 v164, v164
    v_exp_f32 v165, v165
    v_exp_f32 v166, v166
    v_exp_f32 v167, v167
    v_exp_f32 v168, v168
    v_exp_f32 v169, v169
    v_pk_add_f32 v[162:163], v[162:163], s[94:95]
    v_pk_add_f32 v[164:165], v[164:165], s[94:95]
    v_pk_add_f32 v[166:167], v[166:167], s[94:95]
    v_pk_add_f32 v[168:169], v[168:169], s[94:95]
    v_rcp_f32 v162, v162
    v_rcp_f32 v163, v163
    v_rcp_f32 v164, v164
    v_rcp_f32 v165, v165
    v_rcp_f32 v166, v166
    v_rcp_f32 v167, v167
    v_rcp_f32 v168, v168
    v_rcp_f32 v169, v169
    v_pk_mul_f32 v[154:155], v[154:155], v[162:163]
    v_pk_mul_f32 v[156:157], v[156:157], v[164:165]
    v_pk_mul_f32 v[158:159], v[158:159], v[166:167]
    v_pk_mul_f32 v[160:161], v[160:161], v[168:169]
    v_cvt_pk_bf16_f32 v170, v154, v155
    v_cvt_pk_bf16_f32 v171, v156, v157
    v_cvt_pk_bf16_f32 v172, v158, v159
    v_cvt_pk_bf16_f32 v173, v160, v161
    buffer_store_dwordx4 v[170:173], v90, s[12:15], s82 offen offset:2048 sc1
    ds_write_b128 v92, v[170:173] offset:2048
    s_add_u32 m0, s73, 24576
    s_nop 0
    buffer_load_dwordx4 v122, s[40:43], s70 offen lds
    v_accvgpr_read_b32 v154, a12
    v_accvgpr_read_b32 v155, a13
    v_pk_fma_f32 v[162:163], v[32:33], v[134:135], v[60:61] op_sel:[0,1,0] op_sel_hi:[1,1,1] neg_lo:[0,1,0] neg_hi:[0,1,0]
    v_accvgpr_read_b32 v156, a14
    v_accvgpr_read_b32 v157, a15
    v_pk_fma_f32 v[164:165], v[34:35], v[134:135], v[62:63] op_sel:[0,1,0] op_sel_hi:[1,1,1] neg_lo:[0,1,0] neg_hi:[0,1,0]
    v_accvgpr_read_b32 v158, a28
    v_accvgpr_read_b32 v159, a29
    v_pk_fma_f32 v[166:167], v[36:37], v[134:135], v[64:65] op_sel:[0,1,0] op_sel_hi:[1,1,1] neg_lo:[0,1,0] neg_hi:[0,1,0]
    v_accvgpr_read_b32 v160, a30
    v_accvgpr_read_b32 v161, a31
    v_pk_fma_f32 v[168:169], v[38:39], v[134:135], v[66:67] op_sel:[0,1,0] op_sel_hi:[1,1,1] neg_lo:[0,1,0] neg_hi:[0,1,0]
    v_pk_fma_f32 v[154:155], v[154:155], v[134:135], v[162:163] op_sel_hi:[1,0,1]
    v_pk_fma_f32 v[156:157], v[156:157], v[134:135], v[164:165] op_sel_hi:[1,0,1]
    v_pk_fma_f32 v[158:159], v[158:159], v[134:135], v[166:167] op_sel_hi:[1,0,1]
    v_pk_fma_f32 v[160:161], v[160:161], v[134:135], v[168:169] op_sel_hi:[1,0,1]
    v_pk_mul_f32 v[162:163], v[154:155], v[154:155]
    v_pk_mul_f32 v[164:165], v[156:157], v[156:157]
    v_pk_mul_f32 v[166:167], v[158:159], v[158:159]
    v_pk_mul_f32 v[168:169], v[160:161], v[160:161]
    v_pk_fma_f32 v[162:163], v[162:163], s[92:93], v[88:89]
    v_pk_fma_f32 v[164:165], v[164:165], s[92:93], v[88:89]
    v_pk_fma_f32 v[166:167], v[166:167], s[92:93], v[88:89]
    v_pk_fma_f32 v[168:169], v[168:169], s[92:93], v[88:89]
    v_pk_mul_f32 v[162:163], v[154:155], v[162:163]
    v_pk_mul_f32 v[164:165], v[156:157], v[164:165]
    v_pk_mul_f32 v[166:167], v[158:159], v[166:167]
    v_pk_mul_f32 v[168:169], v[160:161], v[168:169]
    v_exp_f32 v162, v162
    v_exp_f32 v163, v163
    v_exp_f32 v164, v164
    v_exp_f32 v165, v165
    v_exp_f32 v166, v166
    v_exp_f32 v167, v167
    v_exp_f32 v168, v168
    v_exp_f32 v169, v169
    v_pk_add_f32 v[162:163], v[162:163], s[94:95]
    v_pk_add_f32 v[164:165], v[164:165], s[94:95]
    v_pk_add_f32 v[166:167], v[166:167], s[94:95]
    v_pk_add_f32 v[168:169], v[168:169], s[94:95]
    v_rcp_f32 v162, v162
    v_rcp_f32 v163, v163
    v_rcp_f32 v164, v164
    v_rcp_f32 v165, v165
    v_rcp_f32 v166, v166
    v_rcp_f32 v167, v167
    v_rcp_f32 v168, v168
    v_rcp_f32 v169, v169
    v_pk_mul_f32 v[154:155], v[154:155], v[162:163]
    v_pk_mul_f32 v[156:157], v[156:157], v[164:165]
    v_pk_mul_f32 v[158:159], v[158:159], v[166:167]
    v_pk_mul_f32 v[160:161], v[160:161], v[168:169]
    v_cvt_pk_bf16_f32 v174, v154, v155
    v_cvt_pk_bf16_f32 v175, v156, v157
    v_cvt_pk_bf16_f32 v176, v158, v159
    v_cvt_pk_bf16_f32 v177, v160, v161
    buffer_store_dwordx4 v[174:177], v90, s[12:15], s82 offen offset:3072 sc1
    ds_write_b128 v92, v[174:177] offset:3072
    buffer_load_dwordx4 v123, s[40:43], s70 offen offset:1024 lds
    s_add_u32 s70, s70, 65536
    v_accvgpr_read_b32 v154, a32
    v_accvgpr_read_b32 v155, a33
    v_pk_fma_f32 v[162:163], v[40:41], v[128:129], v[68:69] op_sel:[0,1,0] op_sel_hi:[1,1,1] neg_lo:[0,1,0] neg_hi:[0,1,0]
    v_accvgpr_read_b32 v156, a34
    v_accvgpr_read_b32 v157, a35
    v_pk_fma_f32 v[164:165], v[42:43], v[128:129], v[70:71] op_sel:[0,1,0] op_sel_hi:[1,1,1] neg_lo:[0,1,0] neg_hi:[0,1,0]
    v_accvgpr_read_b32 v158, a48
    v_accvgpr_read_b32 v159, a49
    v_pk_fma_f32 v[166:167], v[44:45], v[128:129], v[72:73] op_sel:[0,1,0] op_sel_hi:[1,1,1] neg_lo:[0,1,0] neg_hi:[0,1,0]
    v_accvgpr_read_b32 v160, a50
    v_accvgpr_read_b32 v161, a51
    v_pk_fma_f32 v[168:169], v[46:47], v[128:129], v[74:75] op_sel:[0,1,0] op_sel_hi:[1,1,1] neg_lo:[0,1,0] neg_hi:[0,1,0]
    v_pk_fma_f32 v[154:155], v[154:155], v[128:129], v[162:163] op_sel_hi:[1,0,1]
    v_pk_fma_f32 v[156:157], v[156:157], v[128:129], v[164:165] op_sel_hi:[1,0,1]
    v_pk_fma_f32 v[158:159], v[158:159], v[128:129], v[166:167] op_sel_hi:[1,0,1]
    v_pk_fma_f32 v[160:161], v[160:161], v[128:129], v[168:169] op_sel_hi:[1,0,1]
    v_pk_mul_f32 v[162:163], v[154:155], v[154:155]
    v_pk_mul_f32 v[164:165], v[156:157], v[156:157]
    v_pk_mul_f32 v[166:167], v[158:159], v[158:159]
    v_pk_mul_f32 v[168:169], v[160:161], v[160:161]
    v_pk_fma_f32 v[162:163], v[162:163], s[92:93], v[88:89]
    v_pk_fma_f32 v[164:165], v[164:165], s[92:93], v[88:89]
    v_pk_fma_f32 v[166:167], v[166:167], s[92:93], v[88:89]
    v_pk_fma_f32 v[168:169], v[168:169], s[92:93], v[88:89]
    v_pk_mul_f32 v[162:163], v[154:155], v[162:163]
    v_pk_mul_f32 v[164:165], v[156:157], v[164:165]
    v_pk_mul_f32 v[166:167], v[158:159], v[166:167]
    v_pk_mul_f32 v[168:169], v[160:161], v[168:169]
    v_exp_f32 v162, v162
    v_exp_f32 v163, v163
    v_exp_f32 v164, v164
    v_exp_f32 v165, v165
    v_exp_f32 v166, v166
    v_exp_f32 v167, v167
    v_exp_f32 v168, v168
    v_exp_f32 v169, v169
    v_pk_add_f32 v[162:163], v[162:163], s[94:95]
    v_pk_add_f32 v[164:165], v[164:165], s[94:95]
    v_pk_add_f32 v[166:167], v[166:167], s[94:95]
    v_pk_add_f32 v[168:169], v[168:169], s[94:95]
    v_rcp_f32 v162, v162
    v_rcp_f32 v163, v163
    v_rcp_f32 v164, v164
    v_rcp_f32 v165, v165
    v_rcp_f32 v166, v166
    v_rcp_f32 v167, v167
    v_rcp_f32 v168, v168
    v_rcp_f32 v169, v169
    v_pk_mul_f32 v[154:155], v[154:155], v[162:163]
    v_pk_mul_f32 v[156:157], v[156:157], v[164:165]
    v_pk_mul_f32 v[158:159], v[158:159], v[166:167]
    v_pk_mul_f32 v[160:161], v[160:161], v[168:169]
    v_cvt_pk_bf16_f32 v170, v154, v155
    v_cvt_pk_bf16_f32 v171, v156, v157
    v_cvt_pk_bf16_f32 v172, v158, v159
    v_cvt_pk_bf16_f32 v173, v160, v161
    buffer_store_dwordx4 v[170:173], v90, s[12:15], s83 offen offset:0 sc1
    ds_write_b128 v92, v[170:173] offset:16384
    s_add_u32 m0, s73, 40960
    s_nop 0
    buffer_load_dwordx4 v122, s[40:43], s70 offen lds
    v_accvgpr_read_b32 v154, a36
    v_accvgpr_read_b32 v155, a37
    v_pk_fma_f32 v[162:163], v[40:41], v[130:131], v[68:69] op_sel:[0,1,0] op_sel_hi:[1,1,1] neg_lo:[0,1,0] neg_hi:[0,1,0]
    v_accvgpr_read_b32 v156, a38
    v_accvgpr_read_b32 v157, a39
    v_pk_fma_f32 v[164:165], v[42:43], v[130:131], v[70:71] op_sel:[0,1,0] op_sel_hi:[1,1,1] neg_lo:[0,1,0] neg_hi:[0,1,0]
    v_accvgpr_read_b32 v158, a52
    v_accvgpr_read_b32 v159, a53
    v_pk_fma_f32 v[166:167], v[44:45], v[130:131], v[72:73] op_sel:[0,1,0] op_sel_hi:[1,1,1] neg_lo:[0,1,0] neg_hi:[0,1,0]
    v_accvgpr_read_b32 v160, a54
    v_accvgpr_read_b32 v161, a55
    v_pk_fma_f32 v[168:169], v[46:47], v[130:131], v[74:75] op_sel:[0,1,0] op_sel_hi:[1,1,1] neg_lo:[0,1,0] neg_hi:[0,1,0]
    v_pk_fma_f32 v[154:155], v[154:155], v[130:131], v[162:163] op_sel_hi:[1,0,1]
    v_pk_fma_f32 v[156:157], v[156:157], v[130:131], v[164:165] op_sel_hi:[1,0,1]
    v_pk_fma_f32 v[158:159], v[158:159], v[130:131], v[166:167] op_sel_hi:[1,0,1]
    v_pk_fma_f32 v[160:161], v[160:161], v[130:131], v[168:169] op_sel_hi:[1,0,1]
    v_pk_mul_f32 v[162:163], v[154:155], v[154:155]
    v_pk_mul_f32 v[164:165], v[156:157], v[156:157]
    v_pk_mul_f32 v[166:167], v[158:159], v[158:159]
    v_pk_mul_f32 v[168:169], v[160:161], v[160:161]
    v_pk_fma_f32 v[162:163], v[162:163], s[92:93], v[88:89]
    v_pk_fma_f32 v[164:165], v[164:165], s[92:93], v[88:89]
    v_pk_fma_f32 v[166:167], v[166:167], s[92:93], v[88:89]
    v_pk_fma_f32 v[168:169], v[168:169], s[92:93], v[88:89]
    v_pk_mul_f32 v[162:163], v[154:155], v[162:163]
    v_pk_mul_f32 v[164:165], v[156:157], v[164:165]
    v_pk_mul_f32 v[166:167], v[158:159], v[166:167]
    v_pk_mul_f32 v[168:169], v[160:161], v[168:169]
    v_exp_f32 v162, v162
    v_exp_f32 v163, v163
    v_exp_f32 v164, v164
    v_exp_f32 v165, v165
    v_exp_f32 v166, v166
    v_exp_f32 v167, v167
    v_exp_f32 v168, v168
    v_exp_f32 v169, v169
    v_pk_add_f32 v[162:163], v[162:163], s[94:95]
    v_pk_add_f32 v[164:165], v[164:165], s[94:95]
    v_pk_add_f32 v[166:167], v[166:167], s[94:95]
    v_pk_add_f32 v[168:169], v[168:169], s[94:95]
    v_rcp_f32 v162, v162
    v_rcp_f32 v163, v163
    v_rcp_f32 v164, v164
    v_rcp_f32 v165, v165
    v_rcp_f32 v166, v166
    v_rcp_f32 v167, v167
    v_rcp_f32 v168, v168
    v_rcp_f32 v169, v169
    v_pk_mul_f32 v[154:155], v[154:155], v[162:163]
    v_pk_mul_f32 v[156:157], v[156:157], v[164:165]
    v_pk_mul_f32 v[158:159], v[158:159], v[166:167]
    v_pk_mul_f32 v[160:161], v[160:161], v[168:169]
    v_cvt_pk_bf16_f32 v174, v154, v155
    v_cvt_pk_bf16_f32 v175, v156, v157
    v_cvt_pk_bf16_f32 v176, v158, v159
    v_cvt_pk_bf16_f32 v177, v160, v161
    buffer_store_dwordx4 v[174:177], v90, s[12:15], s83 offen offset:1024 sc1
    ds_write_b128 v92, v[174:177] offset:17408
    buffer_load_dwordx4 v123, s[40:43], s70 offen offset:1024 lds
    s_add_u32 s70, s70, 65536
    v_accvgpr_read_b32 v154, a40
    v_accvgpr_read_b32 v155, a41
    v_pk_fma_f32 v[162:163], v[40:41], v[132:133], v[68:69] op_sel:[0,1,0] op_sel_hi:[1,1,1] neg_lo:[0,1,0] neg_hi:[0,1,0]
    v_accvgpr_read_b32 v156, a42
    v_accvgpr_read_b32 v157, a43
    v_pk_fma_f32 v[164:165], v[42:43], v[132:133], v[70:71] op_sel:[0,1,0] op_sel_hi:[1,1,1] neg_lo:[0,1,0] neg_hi:[0,1,0]
    v_accvgpr_read_b32 v158, a56
    v_accvgpr_read_b32 v159, a57
    v_pk_fma_f32 v[166:167], v[44:45], v[132:133], v[72:73] op_sel:[0,1,0] op_sel_hi:[1,1,1] neg_lo:[0,1,0] neg_hi:[0,1,0]
    v_accvgpr_read_b32 v160, a58
    v_accvgpr_read_b32 v161, a59
    v_pk_fma_f32 v[168:169], v[46:47], v[132:133], v[74:75] op_sel:[0,1,0] op_sel_hi:[1,1,1] neg_lo:[0,1,0] neg_hi:[0,1,0]
    v_pk_fma_f32 v[154:155], v[154:155], v[132:133], v[162:163] op_sel_hi:[1,0,1]
    v_pk_fma_f32 v[156:157], v[156:157], v[132:133], v[164:165] op_sel_hi:[1,0,1]
    v_pk_fma_f32 v[158:159], v[158:159], v[132:133], v[166:167] op_sel_hi:[1,0,1]
    v_pk_fma_f32 v[160:161], v[160:161], v[132:133], v[168:169] op_sel_hi:[1,0,1]
    v_pk_mul_f32 v[162:163], v[154:155], v[154:155]
    v_pk_mul_f32 v[164:165], v[156:157], v[156:157]
    v_pk_mul_f32 v[166:167], v[158:159], v[158:159]
    v_pk_mul_f32 v[168:169], v[160:161], v[160:161]
    v_pk_fma_f32 v[162:163], v[162:163], s[92:93], v[88:89]
    v_pk_fma_f32 v[164:165], v[164:165], s[92:93], v[88:89]
    v_pk_fma_f32 v[166:167], v[166:167], s[92:93], v[88:89]
    v_pk_fma_f32 v[168:169], v[168:169], s[92:93], v[88:89]
    v_pk_mul_f32 v[162:163], v[154:155], v[162:163]
    v_pk_mul_f32 v[164:165], v[156:157], v[164:165]
    v_pk_mul_f32 v[166:167], v[158:159], v[166:167]
    v_pk_mul_f32 v[168:169], v[160:161], v[168:169]
    v_exp_f32 v162, v162
    v_exp_f32 v163, v163
    v_exp_f32 v164, v164
    v_exp_f32 v165, v165
    v_exp_f32 v166, v166
    v_exp_f32 v167, v167
    v_exp_f32 v168, v168
    v_exp_f32 v169, v169
    v_pk_add_f32 v[162:163], v[162:163], s[94:95]
    v_pk_add_f32 v[164:165], v[164:165], s[94:95]
    v_pk_add_f32 v[166:167], v[166:167], s[94:95]
    v_pk_add_f32 v[168:169], v[168:169], s[94:95]
    v_rcp_f32 v162, v162
    v_rcp_f32 v163, v163
    v_rcp_f32 v164, v164
    v_rcp_f32 v165, v165
    v_rcp_f32 v166, v166
    v_rcp_f32 v167, v167
    v_rcp_f32 v168, v168
    v_rcp_f32 v169, v169
    v_pk_mul_f32 v[154:155], v[154:155], v[162:163]
    v_pk_mul_f32 v[156:157], v[156:157], v[164:165]
    v_pk_mul_f32 v[158:159], v[158:159], v[166:167]
    v_pk_mul_f32 v[160:161], v[160:161], v[168:169]
    v_cvt_pk_bf16_f32 v170, v154, v155
    v_cvt_pk_bf16_f32 v171, v156, v157
    v_cvt_pk_bf16_f32 v172, v158, v159
    v_cvt_pk_bf16_f32 v173, v160, v161
    buffer_store_dwordx4 v[170:173], v90, s[12:15], s83 offen offset:2048 sc1
    ds_write_b128 v92, v[170:173] offset:18432
    s_add_u32 m0, s73, 57344
    s_nop 0
    buffer_load_dwordx4 v122, s[40:43], s70 offen lds
    v_accvgpr_read_b32 v154, a44
    v_accvgpr_read_b32 v155, a45
    v_pk_fma_f32 v[162:163], v[40:41], v[134:135], v[68:69] op_sel:[0,1,0] op_sel_hi:[1,1,1] neg_lo:[0,1,0] neg_hi:[0,1,0]
    v_accvgpr_read_b32 v156, a46
    v_accvgpr_read_b32 v157, a47
    v_pk_fma_f32 v[164:165], v[42:43], v[134:135], v[70:71] op_sel:[0,1,0] op_sel_hi:[1,1,1] neg_lo:[0,1,0] neg_hi:[0,1,0]
    v_accvgpr_read_b32 v158, a60
    v_accvgpr_read_b32 v159, a61
    v_pk_fma_f32 v[166:167], v[44:45], v[134:135], v[72:73] op_sel:[0,1,0] op_sel_hi:[1,1,1] neg_lo:[0,1,0] neg_hi:[0,1,0]
    v_accvgpr_read_b32 v160, a62
    v_accvgpr_read_b32 v161, a63
    v_pk_fma_f32 v[168:169], v[46:47], v[134:135], v[74:75] op_sel:[0,1,0] op_sel_hi:[1,1,1] neg_lo:[0,1,0] neg_hi:[0,1,0]
    v_pk_fma_f32 v[154:155], v[154:155], v[134:135], v[162:163] op_sel_hi:[1,0,1]
    v_pk_fma_f32 v[156:157], v[156:157], v[134:135], v[164:165] op_sel_hi:[1,0,1]
    v_pk_fma_f32 v[158:159], v[158:159], v[134:135], v[166:167] op_sel_hi:[1,0,1]
    v_pk_fma_f32 v[160:161], v[160:161], v[134:135], v[168:169] op_sel_hi:[1,0,1]
    v_pk_mul_f32 v[162:163], v[154:155], v[154:155]
    v_pk_mul_f32 v[164:165], v[156:157], v[156:157]
    v_pk_mul_f32 v[166:167], v[158:159], v[158:159]
    v_pk_mul_f32 v[168:169], v[160:161], v[160:161]
    v_pk_fma_f32 v[162:163], v[162:163], s[92:93], v[88:89]
    v_pk_fma_f32 v[164:165], v[164:165], s[92:93], v[88:89]
    v_pk_fma_f32 v[166:167], v[166:167], s[92:93], v[88:89]
    v_pk_fma_f32 v[168:169], v[168:169], s[92:93], v[88:89]
    v_pk_mul_f32 v[162:163], v[154:155], v[162:163]
    v_pk_mul_f32 v[164:165], v[156:157], v[164:165]
    v_pk_mul_f32 v[166:167], v[158:159], v[166:167]
    v_pk_mul_f32 v[168:169], v[160:161], v[168:169]
    v_exp_f32 v162, v162
    v_exp_f32 v163, v163
    v_exp_f32 v164, v164
    v_exp_f32 v165, v165
    v_exp_f32 v166, v166
    v_exp_f32 v167, v167
    v_exp_f32 v168, v168
    v_exp_f32 v169, v169
    v_pk_add_f32 v[162:163], v[162:163], s[94:95]
    v_pk_add_f32 v[164:165], v[164:165], s[94:95]
    v_pk_add_f32 v[166:167], v[166:167], s[94:95]
    v_pk_add_f32 v[168:169], v[168:169], s[94:95]
    v_rcp_f32 v162, v162
    v_rcp_f32 v163, v163
    v_rcp_f32 v164, v164
    v_rcp_f32 v165, v165
    v_rcp_f32 v166, v166
    v_rcp_f32 v167, v167
    v_rcp_f32 v168, v168
    v_rcp_f32 v169, v169
    v_pk_mul_f32 v[154:155], v[154:155], v[162:163]
    v_pk_mul_f32 v[156:157], v[156:157], v[164:165]
    v_pk_mul_f32 v[158:159], v[158:159], v[166:167]
    v_pk_mul_f32 v[160:161], v[160:161], v[168:169]
    v_cvt_pk_bf16_f32 v174, v154, v155
    v_cvt_pk_bf16_f32 v175, v156, v157
    v_cvt_pk_bf16_f32 v176, v158, v159
    v_cvt_pk_bf16_f32 v177, v160, v161
    buffer_store_dwordx4 v[174:177], v90, s[12:15], s83 offen offset:3072 sc1
    ds_write_b128 v92, v[174:177] offset:19456
    buffer_load_dwordx4 v123, s[40:43], s70 offen offset:1024 lds
    s_add_u32 s70, s70, 65536
    s_waitcnt vmcnt(16)
    s_barrier
    s_cmp_lg_u32 s66, 0
    s_cbranch_scc1 L_pubUP
    s_lshl_b32 s76, s65, 7
    s_lshl_b32 s77, s64, 3
    s_add_u32 s76, s76, s77
    s_add_u32 s76, s76, 34623488
    v_mov_b32 v240, s76
    v_mov_b32 v242, s88
    v_mov_b32 v243, s89
    s_mov_b64 exec, 0x1
    buffer_store_dwordx2 v[242:243], v240, s[12:15], 0 offen sc1
    s_mov_b64 exec, -1
L_pubUP:
    v_accvgpr_read_b32 v154, a64
    v_accvgpr_read_b32 v155, a65
    v_pk_fma_f32 v[162:163], v[48:49], v[128:129], v[76:77] op_sel:[0,1,0] op_sel_hi:[1,1,1] neg_lo:[0,1,0] neg_hi:[0,1,0]
    v_accvgpr_read_b32 v156, a66
    v_accvgpr_read_b32 v157, a67
    v_pk_fma_f32 v[164:165], v[50:51], v[128:129], v[78:79] op_sel:[0,1,0] op_sel_hi:[1,1,1] neg_lo:[0,1,0] neg_hi:[0,1,0]
    v_accvgpr_read_b32 v158, a80
    v_accvgpr_read_b32 v159, a81
    v_pk_fma_f32 v[166:167], v[52:53], v[128:129], v[80:81] op_sel:[0,1,0] op_sel_hi:[1,1,1] neg_lo:[0,1,0] neg_hi:[0,1,0]
    v_accvgpr_read_b32 v160, a82
    v_accvgpr_read_b32 v161, a83
    v_pk_fma_f32 v[168:169], v[54:55], v[128:129], v[82:83] op_sel:[0,1,0] op_sel_hi:[1,1,1] neg_lo:[0,1,0] neg_hi:[0,1,0]
    v_pk_fma_f32 v[154:155], v[154:155], v[128:129], v[162:163] op_sel_hi:[1,0,1]
    v_pk_fma_f32 v[156:157], v[156:157], v[128:129], v[164:165] op_sel_hi:[1,0,1]
    v_pk_fma_f32 v[158:159], v[158:159], v[128:129], v[166:167] op_sel_hi:[1,0,1]
    v_pk_fma_f32 v[160:161], v[160:161], v[128:129], v[168:169] op_sel_hi:[1,0,1]
    v_pk_mul_f32 v[162:163], v[154:155], v[154:155]
    v_pk_mul_f32 v[164:165], v[156:157], v[156:157]
    v_pk_mul_f32 v[166:167], v[158:159], v[158:159]
    v_pk_mul_f32 v[168:169], v[160:161], v[160:161]
    v_pk_fma_f32 v[162:163], v[162:163], s[92:93], v[88:89]
    v_pk_fma_f32 v[164:165], v[164:165], s[92:93], v[88:89]
    v_pk_fma_f32 v[166:167], v[166:167], s[92:93], v[88:89]
    v_pk_fma_f32 v[168:169], v[168:169], s[92:93], v[88:89]
    v_pk_mul_f32 v[162:163], v[154:155], v[162:163]
    v_pk_mul_f32 v[164:165], v[156:157], v[164:165]
    v_pk_mul_f32 v[166:167], v[158:159], v[166:167]
    v_pk_mul_f32 v[168:169], v[160:161], v[168:169]
    v_exp_f32 v162, v162
    v_exp_f32 v163, v163
    v_exp_f32 v164, v164
    v_exp_f32 v165, v165
    v_exp_f32 v166, v166
    v_exp_f32 v167, v167
    v_exp_f32 v168, v168
    v_exp_f32 v169, v169
    v_pk_add_f32 v[162:163], v[162:163], s[94:95]
    v_pk_add_f32 v[164:165], v[164:165], s[94:95]
    v_pk_add_f32 v[166:167], v[166:167], s[94:95]
    v_pk_add_f32 v[168:169], v[168:169], s[94:95]
    v_rcp_f32 v162, v162
    v_rcp_f32 v163, v163
    v_rcp_f32 v164, v164
    v_rcp_f32 v165, v165
    v_rcp_f32 v166, v166
    v_rcp_f32 v167, v167
    v_rcp_f32 v168, v168
    v_rcp_f32 v169, v169
    v_pk_mul_f32 v[154:155], v[154:155], v[162:163]
    v_pk_mul_f32 v[156:157], v[156:157], v[164:165]
    v_pk_mul_f32 v[158:159], v[158:159], v[166:167]
    v_pk_mul_f32 v[160:161], v[160:161], v[168:169]
    v_cvt_pk_bf16_f32 v170, v154, v155
    v_cvt_pk_bf16_f32 v171, v156, v157
    v_cvt_pk_bf16_f32 v172, v158, v159
    v_cvt_pk_bf16_f32 v173, v160, v161
    buffer_store_dwordx4 v[170:173], v90, s[12:15], s84 offen offset:0 sc1
    ds_write_b128 v92, v[170:173] offset:32768
    s_add_u32 m0, s73, 73728
    s_nop 0
    buffer_load_dwordx4 v122, s[40:43], s70 offen lds
    v_accvgpr_read_b32 v154, a68
    v_accvgpr_read_b32 v155, a69
    v_pk_fma_f32 v[162:163], v[48:49], v[130:131], v[76:77] op_sel:[0,1,0] op_sel_hi:[1,1,1] neg_lo:[0,1,0] neg_hi:[0,1,0]
    v_accvgpr_read_b32 v156, a70
    v_accvgpr_read_b32 v157, a71
    v_pk_fma_f32 v[164:165], v[50:51], v[130:131], v[78:79] op_sel:[0,1,0] op_sel_hi:[1,1,1] neg_lo:[0,1,0] neg_hi:[0,1,0]
    v_accvgpr_read_b32 v158, a84
    v_accvgpr_read_b32 v159, a85
    v_pk_fma_f32 v[166:167], v[52:53], v[130:131], v[80:81] op_sel:[0,1,0] op_sel_hi:[1,1,1] neg_lo:[0,1,0] neg_hi:[0,1,0]
    v_accvgpr_read_b32 v160, a86
    v_accvgpr_read_b32 v161, a87
    v_pk_fma_f32 v[168:169], v[54:55], v[130:131], v[82:83] op_sel:[0,1,0] op_sel_hi:[1,1,1] neg_lo:[0,1,0] neg_hi:[0,1,0]
    v_pk_fma_f32 v[154:155], v[154:155], v[130:131], v[162:163] op_sel_hi:[1,0,1]
    v_pk_fma_f32 v[156:157], v[156:157], v[130:131], v[164:165] op_sel_hi:[1,0,1]
    v_pk_fma_f32 v[158:159], v[158:159], v[130:131], v[166:167] op_sel_hi:[1,0,1]
    v_pk_fma_f32 v[160:161], v[160:161], v[130:131], v[168:169] op_sel_hi:[1,0,1]
    v_pk_mul_f32 v[162:163], v[154:155], v[154:155]
    v_pk_mul_f32 v[164:165], v[156:157], v[156:157]
    v_pk_mul_f32 v[166:167], v[158:159], v[158:159]
    v_pk_mul_f32 v[168:169], v[160:161], v[160:161]
    v_pk_fma_f32 v[162:163], v[162:163], s[92:93], v[88:89]
    v_pk_fma_f32 v[164:165], v[164:165], s[92:93], v[88:89]
    v_pk_fma_f32 v[166:167], v[166:167], s[92:93], v[88:89]
    v_pk_fma_f32 v[168:169], v[168:169], s[92:93], v[88:89]
    v_pk_mul_f32 v[162:163], v[154:155], v[162:163]
    v_pk_mul_f32 v[164:165], v[156:157], v[164:165]
    v_pk_mul_f32 v[166:167], v[158:159], v[166:167]
    v_pk_mul_f32 v[168:169], v[160:161], v[168:169]
    v_exp_f32 v162, v162
    v_exp_f32 v163, v163
    v_exp_f32 v164, v164
    v_exp_f32 v165, v165
    v_exp_f32 v166, v166
    v_exp_f32 v167, v167
    v_exp_f32 v168, v168
    v_exp_f32 v169, v169
    v_pk_add_f32 v[162:163], v[162:163], s[94:95]
    v_pk_add_f32 v[164:165], v[164:165], s[94:95]
    v_pk_add_f32 v[166:167], v[166:167], s[94:95]
    v_pk_add_f32 v[168:169], v[168:169], s[94:95]
    v_rcp_f32 v162, v162
    v_rcp_f32 v163, v163
    v_rcp_f32 v164, v164
    v_rcp_f32 v165, v165
    v_rcp_f32 v166, v166
    v_rcp_f32 v167, v167
    v_rcp_f32 v168, v168
    v_rcp_f32 v169, v169
    v_pk_mul_f32 v[154:155], v[154:155], v[162:163]
    v_pk_mul_f32 v[156:157], v[156:157], v[164:165]
    v_pk_mul_f32 v[158:159], v[158:159], v[166:167]
    v_pk_mul_f32 v[160:161], v[160:161], v[168:169]
    v_cvt_pk_bf16_f32 v174, v154, v155
    v_cvt_pk_bf16_f32 v175, v156, v157
    v_cvt_pk_bf16_f32 v176, v158, v159
    v_cvt_pk_bf16_f32 v177, v160, v161
    buffer_store_dwordx4 v[174:177], v90, s[12:15], s84 offen offset:1024 sc1
    ds_write_b128 v92, v[174:177] offset:33792
    buffer_load_dwordx4 v123, s[40:43], s70 offen offset:1024 lds
    s_add_u32 s70, s70, 65536
    v_accvgpr_read_b32 v154, a72
    v_accvgpr_read_b32 v155, a73
    v_pk_fma_f32 v[162:163], v[48:49], v[132:133], v[76:77] op_sel:[0,1,0] op_sel_hi:[1,1,1] neg_lo:[0,1,0] neg_hi:[0,1,0]
    v_accvgpr_read_b32 v156, a74
    v_accvgpr_read_b32 v157, a75
    v_pk_fma_f32 v[164:165], v[50:51], v[132:133], v[78:79] op_sel:[0,1,0] op_sel_hi:[1,1,1] neg_lo:[0,1,0] neg_hi:[0,1,0]
    v_accvgpr_read_b32 v158, a88
    v_accvgpr_read_b32 v159, a89
    v_pk_fma_f32 v[166:167], v[52:53], v[132:133], v[80:81] op_sel:[0,1,0] op_sel_hi:[1,1,1] neg_lo:[0,1,0] neg_hi:[0,1,0]
    v_accvgpr_read_b32 v160, a90
    v_accvgpr_read_b32 v161, a91
    v_pk_fma_f32 v[168:169], v[54:55], v[132:133], v[82:83] op_sel:[0,1,0] op_sel_hi:[1,1,1] neg_lo:[0,1,0] neg_hi:[0,1,0]
    v_pk_fma_f32 v[154:155], v[154:155], v[132:133], v[162:163] op_sel_hi:[1,0,1]
    v_pk_fma_f32 v[156:157], v[156:157], v[132:133], v[164:165] op_sel_hi:[1,0,1]
    v_pk_fma_f32 v[158:159], v[158:159], v[132:133], v[166:167] op_sel_hi:[1,0,1]
    v_pk_fma_f32 v[160:161], v[160:161], v[132:133], v[168:169] op_sel_hi:[1,0,1]
    v_pk_mul_f32 v[162:163], v[154:155], v[154:155]
    v_pk_mul_f32 v[164:165], v[156:157], v[156:157]
    v_pk_mul_f32 v[166:167], v[158:159], v[158:159]
    v_pk_mul_f32 v[168:169], v[160:161], v[160:161]
    v_pk_fma_f32 v[162:163], v[162:163], s[92:93], v[88:89]
    v_pk_fma_f32 v[164:165], v[164:165], s[92:93], v[88:89]
    v_pk_fma_f32 v[166:167], v[166:167], s[92:93], v[88:89]
    v_pk_fma_f32 v[168:169], v[168:169], s[92:93], v[88:89]
    v_pk_mul_f32 v[162:163], v[154:155], v[162:163]
    v_pk_mul_f32 v[164:165], v[156:157], v[164:165]
    v_pk_mul_f32 v[166:167], v[158:159], v[166:167]
    v_pk_mul_f32 v[168:169], v[160:161], v[168:169]
    v_exp_f32 v162, v162
    v_exp_f32 v163, v163
    v_exp_f32 v164, v164
    v_exp_f32 v165, v165
    v_exp_f32 v166, v166
    v_exp_f32 v167, v167
    v_exp_f32 v168, v168
    v_exp_f32 v169, v169
    v_pk_add_f32 v[162:163], v[162:163], s[94:95]
    v_pk_add_f32 v[164:165], v[164:165], s[94:95]
    v_pk_add_f32 v[166:167], v[166:167], s[94:95]
    v_pk_add_f32 v[168:169], v[168:169], s[94:95]
    v_rcp_f32 v162, v162
    v_rcp_f32 v163, v163
    v_rcp_f32 v164, v164
    v_rcp_f32 v165, v165
    v_rcp_f32 v166, v166
    v_rcp_f32 v167, v167
    v_rcp_f32 v168, v168
    v_rcp_f32 v169, v169
    v_pk_mul_f32 v[154:155], v[154:155], v[162:163]
    v_pk_mul_f32 v[156:157], v[156:157], v[164:165]
    v_pk_mul_f32 v[158:159], v[158:159], v[166:167]
    v_pk_mul_f32 v[160:161], v[160:161], v[168:169]
    v_cvt_pk_bf16_f32 v170, v154, v155
    v_cvt_pk_bf16_f32 v171, v156, v157
    v_cvt_pk_bf16_f32 v172, v158, v159
    v_cvt_pk_bf16_f32 v173, v160, v161
    buffer_store_dwordx4 v[170:173], v90, s[12:15], s84 offen offset:2048 sc1
    ds_write_b128 v92, v[170:173] offset:34816
    s_add_u32 m0, s73, 90112
    s_nop 0
    buffer_load_dwordx4 v122, s[40:43], s70 offen lds
    v_accvgpr_read_b32 v154, a76
    v_accvgpr_read_b32 v155, a77
    v_pk_fma_f32 v[162:163], v[48:49], v[134:135], v[76:77] op_sel:[0,1,0] op_sel_hi:[1,1,1] neg_lo:[0,1,0] neg_hi:[0,1,0]
    v_accvgpr_read_b32 v156, a78
    v_accvgpr_read_b32 v157, a79
    v_pk_fma_f32 v[164:165], v[50:51], v[134:135], v[78:79] op_sel:[0,1,0] op_sel_hi:[1,1,1] neg_lo:[0,1,0] neg_hi:[0,1,0]
    v_accvgpr_read_b32 v158, a92
    v_accvgpr_read_b32 v159, a93
    v_pk_fma_f32 v[166:167], v[52:53], v[134:135], v[80:81] op_sel:[0,1,0] op_sel_hi:[1,1,1] neg_lo:[0,1,0] neg_hi:[0,1,0]
    v_accvgpr_read_b32 v160, a94
    v_accvgpr_read_b32 v161, a95
    v_pk_fma_f32 v[168:169], v[54:55], v[134:135], v[82:83] op_sel:[0,1,0] op_sel_hi:[1,1,1] neg_lo:[0,1,0] neg_hi:[0,1,0]
    v_pk_fma_f32 v[154:155], v[154:155], v[134:135], v[162:163] op_sel_hi:[1,0,1]
    v_pk_fma_f32 v[156:157], v[156:157], v[134:135], v[164:165] op_sel_hi:[1,0,1]
    v_pk_fma_f32 v[158:159], v[158:159], v[134:135], v[166:167] op_sel_hi:[1,0,1]
    v_pk_fma_f32 v[160:161], v[160:161], v[134:135], v[168:169] op_sel_hi:[1,0,1]
    v_pk_mul_f32 v[162:163], v[154:155], v[154:155]
    v_pk_mul_f32 v[164:165], v[156:157], v[156:157]
    v_pk_mul_f32 v[166:167], v[158:159], v[158:159]
    v_pk_mul_f32 v[168:169], v[160:161], v[160:161]
    v_pk_fma_f32 v[162:163], v[162:163], s[92:93], v[88:89]
    v_pk_fma_f32 v[164:165], v[164:165], s[92:93], v[88:89]
    v_pk_fma_f32 v[166:167], v[166:167], s[92:93], v[88:89]
    v_pk_fma_f32 v[168:169], v[168:169], s[92:93], v[88:89]
    v_pk_mul_f32 v[162:163], v[154:155], v[162:163]
    v_pk_mul_f32 v[164:165], v[156:157], v[164:165]
    v_pk_mul_f32 v[166:167], v[158:159], v[166:167]
    v_pk_mul_f32 v[168:169], v[160:161], v[168:169]
    v_exp_f32 v162, v162
    v_exp_f32 v163, v163
    v_exp_f32 v164, v164
    v_exp_f32 v165, v165
    v_exp_f32 v166, v166
    v_exp_f32 v167, v167
    v_exp_f32 v168, v168
    v_exp_f32 v169, v169
    v_pk_add_f32 v[162:163], v[162:163], s[94:95]
    v_pk_add_f32 v[164:165], v[164:165], s[94:95]
    v_pk_add_f32 v[166:167], v[166:167], s[94:95]
    v_pk_add_f32 v[168:169], v[168:169], s[94:95]
    v_rcp_f32 v162, v162
    v_rcp_f32 v163, v163
    v_rcp_f32 v164, v164
    v_rcp_f32 v165, v165
    v_rcp_f32 v166, v166
    v_rcp_f32 v167, v167
    v_rcp_f32 v168, v168
    v_rcp_f32 v169, v169
    v_pk_mul_f32 v[154:155], v[154:155], v[162:163]
    v_pk_mul_f32 v[156:157], v[156:157], v[164:165]
    v_pk_mul_f32 v[158:159], v[158:159], v[166:167]
    v_pk_mul_f32 v[160:161], v[160:161], v[168:169]
    v_cvt_pk_bf16_f32 v174, v154, v155
    v_cvt_pk_bf16_f32 v175, v156, v157
    v_cvt_pk_bf16_f32 v176, v158, v159
    v_cvt_pk_bf16_f32 v177, v160, v161
    buffer_store_dwordx4 v[174:177], v90, s[12:15], s84 offen offset:3072 sc1
    ds_write_b128 v92, v[174:177] offset:35840
    buffer_load_dwordx4 v123, s[40:43], s70 offen offset:1024 lds
    s_add_u32 s70, s70, 65536
    v_accvgpr_read_b32 v154, a96
    v_accvgpr_read_b32 v155, a97
    v_pk_fma_f32 v[162:163], v[56:57], v[128:129], v[84:85] op_sel:[0,1,0] op_sel_hi:[1,1,1] neg_lo:[0,1,0] neg_hi:[0,1,0]
    v_accvgpr_read_b32 v156, a98
    v_accvgpr_read_b32 v157, a99
    v_pk_fma_f32 v[164:165], v[58:59], v[128:129], v[86:87] op_sel:[0,1,0] op_sel_hi:[1,1,1] neg_lo:[0,1,0] neg_hi:[0,1,0]
    v_accvgpr_read_b32 v158, a100
    v_accvgpr_read_b32 v159, a101
    v_pk_fma_f32 v[166:167], v[56:57], v[130:131], v[84:85] op_sel:[0,1,0] op_sel_hi:[1,1,1] neg_lo:[0,1,0] neg_hi:[0,1,0]
    v_accvgpr_read_b32 v160, a102
    v_accvgpr_read_b32 v161, a103
    v_pk_fma_f32 v[168:169], v[58:59], v[130:131], v[86:87] op_sel:[0,1,0] op_sel_hi:[1,1,1] neg_lo:[0,1,0] neg_hi:[0,1,0]
    v_pk_fma_f32 v[154:155], v[154:155], v[128:129], v[162:163] op_sel_hi:[1,0,1]
    v_pk_fma_f32 v[156:157], v[156:157], v[128:129], v[164:165] op_sel_hi:[1,0,1]
    v_pk_fma_f32 v[158:159], v[158:159], v[130:131], v[166:167] op_sel_hi:[1,0,1]
    v_pk_fma_f32 v[160:161], v[160:161], v[130:131], v[168:169] op_sel_hi:[1,0,1]
    v_pk_mul_f32 v[162:163], v[154:155], v[154:155]
    v_pk_mul_f32 v[164:165], v[156:157], v[156:157]
    v_pk_mul_f32 v[166:167], v[158:159], v[158:159]
    v_pk_mul_f32 v[168:169], v[160:161], v[160:161]
    v_pk_fma_f32 v[162:163], v[162:163], s[92:93], v[88:89]
    v_pk_fma_f32 v[164:165], v[164:165], s[92:93], v[88:89]
    v_pk_fma_f32 v[166:167], v[166:167], s[92:93], v[88:89]
    v_pk_fma_f32 v[168:169], v[168:169], s[92:93], v[88:89]
    v_pk_mul_f32 v[162:163], v[154:155], v[162:163]
    v_pk_mul_f32 v[164:165], v[156:157], v[164:165]
    v_pk_mul_f32 v[166:167], v[158:159], v[166:167]
    v_pk_mul_f32 v[168:169], v[160:161], v[168:169]
    v_exp_f32 v162, v162
    v_exp_f32 v163, v163
    v_exp_f32 v164, v164
    v_exp_f32 v165, v165
    v_exp_f32 v166, v166
    v_exp_f32 v167, v167
    v_exp_f32 v168, v168
    v_exp_f32 v169, v169
    v_pk_add_f32 v[162:163], v[162:163], s[94:95]
    v_pk_add_f32 v[164:165], v[164:165], s[94:95]
    v_pk_add_f32 v[166:167], v[166:167], s[94:95]
    v_pk_add_f32 v[168:169], v[168:169], s[94:95]
    v_rcp_f32 v162, v162
    v_rcp_f32 v163, v163
    v_rcp_f32 v164, v164
    v_rcp_f32 v165, v165
    v_rcp_f32 v166, v166
    v_rcp_f32 v167, v167
    v_rcp_f32 v168, v168
    v_rcp_f32 v169, v169
    v_pk_mul_f32 v[154:155], v[154:155], v[162:163]
    v_pk_mul_f32 v[156:157], v[156:157], v[164:165]
    v_pk_mul_f32 v[158:159], v[158:159], v[166:167]
    v_pk_mul_f32 v[160:161], v[160:161], v[168:169]
    v_cvt_pk_bf16_f32 v170, v154, v155
    v_cvt_pk_bf16_f32 v171, v156, v157
    v_cvt_pk_bf16_f32 v172, v158, v159
    v_cvt_pk_bf16_f32 v173, v160, v161
    buffer_store_dwordx2 v[170:171], v91, s[12:15], s85 offen offset:0 sc1
    ds_write_b64 v91, v[170:171] offset:49152
    buffer_store_dwordx2 v[172:173], v91, s[12:15], s85 offen offset:1024 sc1
    ds_write_b64 v91, v[172:173] offset:50176
    s_add_u32 m0, s73, 106496
    s_nop 0
    buffer_load_dwordx4 v122, s[40:43], s70 offen lds
    v_accvgpr_read_b32 v154, a104
    v_accvgpr_read_b32 v155, a105
    v_pk_fma_f32 v[162:163], v[56:57], v[132:133], v[84:85] op_sel:[0,1,0] op_sel_hi:[1,1,1] neg_lo:[0,1,0] neg_hi:[0,1,0]
    v_accvgpr_read_b32 v156, a106
    v_accvgpr_read_b32 v157, a107
    v_pk_fma_f32 v[164:165], v[58:59], v[132:133], v[86:87] op_sel:[0,1,0] op_sel_hi:[1,1,1] neg_lo:[0,1,0] neg_hi:[0,1,0]
    v_accvgpr_read_b32 v158, a108
    v_accvgpr_read_b32 v159, a109
    v_pk_fma_f32 v[166:167], v[56:57], v[134:135], v[84:85] op_sel:[0,1,0] op_sel_hi:[1,1,1] neg_lo:[0,1,0] neg_hi:[0,1,0]
    v_accvgpr_read_b32 v160, a110
    v_accvgpr_read_b32 v161, a111
    v_pk_fma_f32 v[168:169], v[58:59], v[134:135], v[86:87] op_sel:[0,1,0] op_sel_hi:[1,1,1] neg_lo:[0,1,0] neg_hi:[0,1,0]
    v_pk_fma_f32 v[154:155], v[154:155], v[132:133], v[162:163] op_sel_hi:[1,0,1]
    v_pk_fma_f32 v[156:157], v[156:157], v[132:133], v[164:165] op_sel_hi:[1,0,1]
    v_pk_fma_f32 v[158:159], v[158:159], v[134:135], v[166:167] op_sel_hi:[1,0,1]
    v_pk_fma_f32 v[160:161], v[160:161], v[134:135], v[168:169] op_sel_hi:[1,0,1]
    v_pk_mul_f32 v[162:163], v[154:155], v[154:155]
    v_pk_mul_f32 v[164:165], v[156:157], v[156:157]
    v_pk_mul_f32 v[166:167], v[158:159], v[158:159]
    v_pk_mul_f32 v[168:169], v[160:161], v[160:161]
    v_pk_fma_f32 v[162:163], v[162:163], s[92:93], v[88:89]
    v_pk_fma_f32 v[164:165], v[164:165], s[92:93], v[88:89]
    v_pk_fma_f32 v[166:167], v[166:167], s[92:93], v[88:89]
    v_pk_fma_f32 v[168:169], v[168:169], s[92:93], v[88:89]
    v_pk_mul_f32 v[162:163], v[154:155], v[162:163]
    v_pk_mul_f32 v[164:165], v[156:157], v[164:165]
    v_pk_mul_f32 v[166:167], v[158:159], v[166:167]
    v_pk_mul_f32 v[168:169], v[160:161], v[168:169]
    v_exp_f32 v162, v162
    v_exp_f32 v163, v163
    v_exp_f32 v164, v164
    v_exp_f32 v165, v165
    v_exp_f32 v166, v166
    v_exp_f32 v167, v167
    v_exp_f32 v168, v168
    v_exp_f32 v169, v169
    v_pk_add_f32 v[162:163], v[162:163], s[94:95]
    v_pk_add_f32 v[164:165], v[164:165], s[94:95]
    v_pk_add_f32 v[166:167], v[166:167], s[94:95]
    v_pk_add_f32 v[168:169], v[168:169], s[94:95]
    v_rcp_f32 v162, v162
    v_rcp_f32 v163, v163
    v_rcp_f32 v164, v164
    v_rcp_f32 v165, v165
    v_rcp_f32 v166, v166
    v_rcp_f32 v167, v167
    v_rcp_f32 v168, v168
    v_rcp_f32 v169, v169
    v_pk_mul_f32 v[154:155], v[154:155], v[162:163]
    v_pk_mul_f32 v[156:157], v[156:157], v[164:165]
    v_pk_mul_f32 v[158:159], v[158:159], v[166:167]
    v_pk_mul_f32 v[160:161], v[160:161], v[168:169]
    v_cvt_pk_bf16_f32 v174, v154, v155
    v_cvt_pk_bf16_f32 v175, v156, v157
    v_cvt_pk_bf16_f32 v176, v158, v159
    v_cvt_pk_bf16_f32 v177, v160, v161
    buffer_store_dwordx2 v[174:175], v91, s[12:15], s85 offen offset:2048 sc1
    ds_write_b64 v91, v[174:175] offset:51200
    buffer_store_dwordx2 v[176:177], v91, s[12:15], s85 offen offset:3072 sc1
    ds_write_b64 v91, v[176:177] offset:52224
    buffer_load_dwordx4 v123, s[40:43], s70 offen offset:1024 lds
    s_cmp_ge_u32 s71, s74
    s_addc_u32 s76, s71, 0
    s_lshl_b32 s77, s100, 3
    s_add_u32 s76, s76, s77
    s_add_u32 s71, s71, 1
    s_mul_i32 s70, s76, 458752
    s_waitcnt vmcnt(18) lgkmcnt(0)
    s_barrier
    v_lshlrev_b32 v114, 3, v1
    s_lshl_b32 s76, s65, 7
    s_add_u32 s76, s76, 34623488
    v_add_u32 v114, s76, v114
    v_lshlrev_b32 v30, 4, v1
    s_lshl_b32 s76, s75, 12
    s_mul_i32 s77, s66, 4160
    s_add_u32 m0, s77, 136256
    s_nop 0
    buffer_load_dwordx4 v30, s[28:31], s76 offen nt lds
    buffer_load_dwordx4 v30, s[28:31], s76 offen offset:1024 nt lds
    buffer_load_dwordx4 v30, s[28:31], s76 offen offset:2048 nt lds
    buffer_load_dwordx4 v30, s[28:31], s76 offen offset:3072 nt lds
    s_lshl_b32 s76, s75, 1
    buffer_load_ushort v125, v124, s[32:35], s76 offen
    ds_read_b128 v[32:35], v2 offset:0
    ds_read_b64_tr_b16 v[64:65], v8 offset:0
    ds_read_b64_tr_b16 v[66:67], v8 offset:4096
    ds_read_b128 v[36:39], v2 offset:1024
    ds_read_b128 v[40:43], v4 offset:0
    ds_read_b128 v[44:47], v4 offset:1024
    ds_read_b64_tr_b16 v[68:69], v9 offset:0
    ds_read_b64_tr_b16 v[70:71], v9 offset:4096
    ds_read_b64_tr_b16 v[72:73], v10 offset:0
    ds_read_b64_tr_b16 v[74:75], v10 offset:4096
    ds_read_b64_tr_b16 v[76:77], v11 offset:0
    ds_read_b64_tr_b16 v[78:79], v11 offset:4096
    s_waitcnt vmcnt(23) lgkmcnt(0)
    s_barrier
    v_mfma_f32_16x16x32_bf16 a[0:3], v[64:67], v[32:35], 0
    ds_read_b128 v[48:51], v2 offset:16384
    ds_read_b64_tr_b16 v[80:81], v8 offset:16384
    v_mfma_f32_16x16x32_bf16 a[4:7], v[64:67], v[36:39], 0
    ds_read_b64_tr_b16 v[82:83], v8 offset:20480
    ds_read_b128 v[52:55], v2 offset:17408
    v_mfma_f32_16x16x32_bf16 a[8:11], v[64:67], v[40:43], 0
    ds_read_b128 v[56:59], v4 offset:16384
    v_mfma_f32_16x16x32_bf16 a[12:15], v[64:67], v[44:47], 0
    ds_read_b128 v[60:63], v4 offset:17408
    v_mfma_f32_16x16x32_bf16 a[16:19], v[68:71], v[32:35], 0
    ds_read_b64_tr_b16 v[84:85], v9 offset:16384
    v_mfma_f32_16x16x32_bf16 a[20:23], v[68:71], v[36:39], 0
    ds_read_b64_tr_b16 v[86:87], v9 offset:20480
    v_mfma_f32_16x16x32_bf16 a[24:27], v[68:71], v[40:43], 0
    ds_read_b64_tr_b16 v[88:89], v10 offset:16384
    v_mfma_f32_16x16x32_bf16 a[28:31], v[68:71], v[44:47], 0
    ds_read_b64_tr_b16 v[90:91], v10 offset:20480
    v_mfma_f32_16x16x32_bf16 a[32:35], v[72:75], v[32:35], 0
    ds_read_b64_tr_b16 v[92:93], v11 offset:16384
    v_mfma_f32_16x16x32_bf16 a[36:39], v[72:75], v[36:39], 0
    ds_read_b64_tr_b16 v[94:95], v11 offset:20480
    v_mfma_f32_16x16x32_bf16 a[40:43], v[72:75], v[40:43], 0
    v_mfma_f32_16x16x32_bf16 a[44:47], v[72:75], v[44:47], 0
    v_mfma_f32_16x16x32_bf16 a[48:51], v[76:79], v[32:35], 0
    v_mfma_f32_16x16x32_bf16 a[52:55], v[76:79], v[36:39], 0
    v_mfma_f32_16x16x32_bf16 a[56:59], v[76:79], v[40:43], 0
    v_mfma_f32_16x16x32_bf16 a[60:63], v[76:79], v[44:47], 0
    s_waitcnt lgkmcnt(0)
    v_mfma_f32_16x16x32_bf16 a[0:3], v[80:83], v[48:51], a[0:3]
    ds_read_b128 v[32:35], v2 offset:32768
    ds_read_b64_tr_b16 v[64:65], v8 offset:32768
    v_mfma_f32_16x16x32_bf16 a[4:7], v[80:83], v[52:55], a[4:7]
    ds_read_b64_tr_b16 v[66:67], v8 offset:36864
    ds_read_b128 v[36:39], v2 offset:33792
    v_mfma_f32_16x16x32_bf16 a[8:11], v[80:83], v[56:59], a[8:11]
    ds_read_b128 v[40:43], v4 offset:32768
    v_mfma_f32_16x16x32_bf16 a[12:15], v[80:83], v[60:63], a[12:15]
    ds_read_b128 v[44:47], v4 offset:33792
    v_mfma_f32_16x16x32_bf16 a[16:19], v[84:87], v[48:51], a[16:19]
    ds_read_b64_tr_b16 v[68:69], v9 offset:32768
    v_mfma_f32_16x16x32_bf16 a[20:23], v[84:87], v[52:55], a[20:23]
    ds_read_b64_tr_b16 v[70:71], v9 offset:36864
    v_mfma_f32_16x16x32_bf16 a[24:27], v[84:87], v[56:59], a[24:27]
    ds_read_b64_tr_b16 v[72:73], v10 offset:32768
    v_mfma_f32_16x16x32_bf16 a[28:31], v[84:87], v[60:63], a[28:31]
    ds_read_b64_tr_b16 v[74:75], v10 offset:36864
    v_mfma_f32_16x16x32_bf16 a[32:35], v[88:91], v[48:51], a[32:35]
    ds_read_b64_tr_b16 v[76:77], v11 offset:32768
    s_add_u32 m0, s73, 8192
    v_mfma_f32_16x16x32_bf16 a[36:39], v[88:91], v[52:55], a[36:39]
    ds_read_b64_tr_b16 v[78:79], v11 offset:36864
    buffer_load_dwordx4 v122, s[40:43], s70 offen lds
    v_mfma_f32_16x16x32_bf16 a[40:43], v[88:91], v[56:59], a[40:43]
    v_mfma_f32_16x16x32_bf16 a[44:47], v[88:91], v[60:63], a[44:47]
    v_mfma_f32_16x16x32_bf16 a[48:51], v[92:95], v[48:51], a[48:51]
    v_mfma_f32_16x16x32_bf16 a[52:55], v[92:95], v[52:55], a[52:55]
    buffer_load_dwordx4 v123, s[40:43], s70 offen offset:1024 lds
    v_mfma_f32_16x16x32_bf16 a[56:59], v[92:95], v[56:59], a[56:59]
    s_add_u32 s70, s70, 65536
    v_mfma_f32_16x16x32_bf16 a[60:63], v[92:95], v[60:63], a[60:63]
    s_waitcnt vmcnt(17) lgkmcnt(0)
    s_barrier
    v_mfma_f32_16x16x32_bf16 a[0:3], v[64:67], v[32:35], a[0:3]
    ds_read_b64 v[48:49], v6 offset:49152
    ds_read_b64 v[50:51], v6 offset:49664
    v_mfma_f32_16x16x32_bf16 a[4:7], v[64:67], v[36:39], a[4:7]
    ds_read_b64_tr_b16 v[80:81], v8 offset:49152
    ds_read_b64_tr_b16 v[82:83], v8 offset:53248
    v_mfma_f32_16x16x32_bf16 a[8:11], v[64:67], v[40:43], a[8:11]
    ds_read_b64 v[52:53], v6 offset:50176
    ds_read_b64 v[54:55], v6 offset:50688
    v_mfma_f32_16x16x32_bf16 a[12:15], v[64:67], v[44:47], a[12:15]
    ds_read_b64 v[56:57], v7 offset:49152
    ds_read_b64 v[58:59], v7 offset:49664
    v_mfma_f32_16x16x32_bf16 a[16:19], v[68:71], v[32:35], a[16:19]
    ds_read_b64 v[60:61], v7 offset:50176
    v_mfma_f32_16x16x32_bf16 a[20:23], v[68:71], v[36:39], a[20:23]
    ds_read_b64 v[62:63], v7 offset:50688
    v_mfma_f32_16x16x32_bf16 a[24:27], v[68:71], v[40:43], a[24:27]
    ds_read_b64_tr_b16 v[84:85], v9 offset:49152
    v_mfma_f32_16x16x32_bf16 a[28:31], v[68:71], v[44:47], a[28:31]
    ds_read_b64_tr_b16 v[86:87], v9 offset:53248
    v_mfma_f32_16x16x32_bf16 a[32:35], v[72:75], v[32:35], a[32:35]
    ds_read_b64_tr_b16 v[88:89], v10 offset:49152
    s_add_u32 m0, s73, 24576
    v_mfma_f32_16x16x32_bf16 a[36:39], v[72:75], v[36:39], a[36:39]
    ds_read_b64_tr_b16 v[90:91], v10 offset:53248
    buffer_load_dwordx4 v122, s[40:43], s70 offen lds
    v_mfma_f32_16x16x32_bf16 a[40:43], v[72:75], v[40:43], a[40:43]
    ds_read_b64_tr_b16 v[92:93], v11 offset:49152
    v_mfma_f32_16x16x32_bf16 a[44:47], v[72:75], v[44:47], a[44:47]
    ds_read_b64_tr_b16 v[94:95], v11 offset:53248
    v_mfma_f32_16x16x32_bf16 a[48:51], v[76:79], v[32:35], a[48:51]
    v_mfma_f32_16x16x32_bf16 a[52:55], v[76:79], v[36:39], a[52:55]
    buffer_load_dwordx4 v123, s[40:43], s70 offen offset:1024 lds
    v_mfma_f32_16x16x32_bf16 a[56:59], v[76:79], v[40:43], a[56:59]
    s_add_u32 s70, s70, 65536
    v_mfma_f32_16x16x32_bf16 a[60:63], v[76:79], v[44:47], a[60:63]
    s_waitcnt lgkmcnt(0)
    v_mfma_f32_16x16x32_bf16 a[0:3], v[80:83], v[48:51], a[0:3]
    ds_read_b128 v[32:35], v3 offset:0
    ds_read_b64_tr_b16 v[64:65], v12 offset:0
    v_mfma_f32_16x16x32_bf16 a[4:7], v[80:83], v[52:55], a[4:7]
    ds_read_b64_tr_b16 v[66:67], v12 offset:4096
    ds_read_b128 v[36:39], v3 offset:1024
    v_mfma_f32_16x16x32_bf16 a[8:11], v[80:83], v[56:59], a[8:11]
    ds_read_b128 v[40:43], v5 offset:0
    v_mfma_f32_16x16x32_bf16 a[12:15], v[80:83], v[60:63], a[12:15]
    ds_read_b128 v[44:47], v5 offset:1024
    v_mfma_f32_16x16x32_bf16 a[16:19], v[84:87], v[48:51], a[16:19]
    ds_read_b64_tr_b16 v[68:69], v13 offset:0
    v_mfma_f32_16x16x32_bf16 a[20:23], v[84:87], v[52:55], a[20:23]
    ds_read_b64_tr_b16 v[70:71], v13 offset:4096
    v_mfma_f32_16x16x32_bf16 a[24:27], v[84:87], v[56:59], a[24:27]
    ds_read_b64_tr_b16 v[72:73], v14 offset:0
    v_mfma_f32_16x16x32_bf16 a[28:31], v[84:87], v[60:63], a[28:31]
    ds_read_b64_tr_b16 v[74:75], v14 offset:4096
    v_mfma_f32_16x16x32_bf16 a[32:35], v[88:91], v[48:51], a[32:35]
    ds_read_b64_tr_b16 v[76:77], v15 offset:0
    s_add_u32 m0, s73, 40960
    v_mfma_f32_16x16x32_bf16 a[36:39], v[88:91], v[52:55], a[36:39]
    ds_read_b64_tr_b16 v[78:79], v15 offset:4096
    buffer_load_dwordx4 v122, s[40:43], s70 offen lds
    v_mfma_f32_16x16x32_bf16 a[40:43], v[88:91], v[56:59], a[40:43]
    v_mfma_f32_16x16x32_bf16 a[44:47], v[88:91], v[60:63], a[44:47]
    v_mfma_f32_16x16x32_bf16 a[48:51], v[92:95], v[48:51], a[48:51]
    v_mfma_f32_16x16x32_bf16 a[52:55], v[92:95], v[52:55], a[52:55]
    buffer_load_dwordx4 v123, s[40:43], s70 offen offset:1024 lds
    v_mfma_f32_16x16x32_bf16 a[56:59], v[92:95], v[56:59], a[56:59]
    s_add_u32 s70, s70, 65536
    v_mfma_f32_16x16x32_bf16 a[60:63], v[92:95], v[60:63], a[60:63]
    s_waitcnt vmcnt(11) lgkmcnt(0)
    s_barrier
    s_cmp_lg_u32 s66, 0
    s_cbranch_scc1 L_pubH
    s_lshl_b32 s76, s64, 7
    s_lshl_b32 s77, s65, 3
    s_add_u32 s76, s76, s77
    s_add_u32 s76, s76, 34611200
    v_mov_b32 v24, s76
    v_mov_b32 v26, s88
    v_mov_b32 v27, s89
    s_mov_b64 exec, 0x1
    buffer_store_dwordx2 v[26:27], v24, s[12:15], 0 offen sc1
    s_mov_b64 exec, -1
L_pubH:
    v_mfma_f32_16x16x32_bf16 a[0:3], v[64:67], v[32:35], a[0:3]
    ds_read_b128 v[48:51], v3 offset:16384
    ds_read_b64_tr_b16 v[80:81], v12 offset:16384
    v_mfma_f32_16x16x32_bf16 a[4:7], v[64:67], v[36:39], a[4:7]
    ds_read_b64_tr_b16 v[82:83], v12 offset:20480
    ds_read_b128 v[52:55], v3 offset:17408
    v_mfma_f32_16x16x32_bf16 a[8:11], v[64:67], v[40:43], a[8:11]
    ds_read_b128 v[56:59], v5 offset:16384
    buffer_load_dwordx2 v[26:27], v114, s[12:15], 0 offen sc1
    v_mfma_f32_16x16x32_bf16 a[12:15], v[64:67], v[44:47], a[12:15]
    ds_read_b128 v[60:63], v5 offset:17408
    v_mfma_f32_16x16x32_bf16 a[16:19], v[68:71], v[32:35], a[16:19]
    ds_read_b64_tr_b16 v[84:85], v13 offset:16384
    v_mfma_f32_16x16x32_bf16 a[20:23], v[68:71], v[36:39], a[20:23]
    ds_read_b64_tr_b16 v[86:87], v13 offset:20480
    v_mfma_f32_16x16x32_bf16 a[24:27], v[68:71], v[40:43], a[24:27]
    ds_read_b64_tr_b16 v[88:89], v14 offset:16384
    v_mfma_f32_16x16x32_bf16 a[28:31], v[68:71], v[44:47], a[28:31]
    ds_read_b64_tr_b16 v[90:91], v14 offset:20480
    v_mfma_f32_16x16x32_bf16 a[32:35], v[72:75], v[32:35], a[32:35]
    ds_read_b64_tr_b16 v[92:93], v15 offset:16384
    s_add_u32 m0, s73, 57344
    v_mfma_f32_16x16x32_bf16 a[36:39], v[72:75], v[36:39], a[36:39]
    ds_read_b64_tr_b16 v[94:95], v15 offset:20480
    buffer_load_dwordx4 v122, s[40:43], s70 offen lds
    v_mfma_f32_16x16x32_bf16 a[40:43], v[72:75], v[40:43], a[40:43]
    v_mfma_f32_16x16x32_bf16 a[44:47], v[72:75], v[44:47], a[44:47]
    v_mfma_f32_16x16x32_bf16 a[48:51], v[76:79], v[32:35], a[48:51]
    v_mfma_f32_16x16x32_bf16 a[52:55], v[76:79], v[36:39], a[52:55]
    buffer_load_dwordx4 v123, s[40:43], s70 offen offset:1024 lds
    v_mfma_f32_16x16x32_bf16 a[56:59], v[76:79], v[40:43], a[56:59]
    s_add_u32 s70, s70, 65536
    v_mfma_f32_16x16x32_bf16 a[60:63], v[76:79], v[44:47], a[60:63]
    s_waitcnt lgkmcnt(0)
    v_mfma_f32_16x16x32_bf16 a[0:3], v[80:83], v[48:51], a[0:3]
    ds_read_b128 v[32:35], v3 offset:32768
    ds_read_b64_tr_b16 v[64:65], v12 offset:32768
    v_mfma_f32_16x16x32_bf16 a[4:7], v[80:83], v[52:55], a[4:7]
    ds_read_b64_tr_b16 v[66:67], v12 offset:36864
    ds_read_b128 v[36:39], v3 offset:33792
    v_mfma_f32_16x16x32_bf16 a[8:11], v[80:83], v[56:59], a[8:11]
    ds_read_b128 v[40:43], v5 offset:32768
    v_mfma_f32_16x16x32_bf16 a[12:15], v[80:83], v[60:63], a[12:15]
    ds_read_b128 v[44:47], v5 offset:33792
    v_mfma_f32_16x16x32_bf16 a[16:19], v[84:87], v[48:51], a[16:19]
    ds_read_b64_tr_b16 v[68:69], v13 offset:32768
    v_mfma_f32_16x16x32_bf16 a[20:23], v[84:87], v[52:55], a[20:23]
    ds_read_b64_tr_b16 v[70:71], v13 offset:36864
    v_mfma_f32_16x16x32_bf16 a[24:27], v[84:87], v[56:59], a[24:27]
    ds_read_b64_tr_b16 v[72:73], v14 offset:32768
    v_mfma_f32_16x16x32_bf16 a[28:31], v[84:87], v[60:63], a[28:31]
    ds_read_b64_tr_b16 v[74:75], v14 offset:36864
    v_mfma_f32_16x16x32_bf16 a[32:35], v[88:91], v[48:51], a[32:35]
    ds_read_b64_tr_b16 v[76:77], v15 offset:32768
    s_add_u32 m0, s73, 73728
    v_mfma_f32_16x16x32_bf16 a[36:39], v[88:91], v[52:55], a[36:39]
    ds_read_b64_tr_b16 v[78:79], v15 offset:36864
    buffer_load_dwordx4 v122, s[40:43], s70 offen lds
    v_mfma_f32_16x16x32_bf16 a[40:43], v[88:91], v[56:59], a[40:43]
    v_mfma_f32_16x16x32_bf16 a[44:47], v[88:91], v[60:63], a[44:47]
    v_mfma_f32_16x16x32_bf16 a[48:51], v[92:95], v[48:51], a[48:51]
    v_mfma_f32_16x16x32_bf16 a[52:55], v[92:95], v[52:55], a[52:55]
    buffer_load_dwordx4 v123, s[40:43], s70 offen offset:1024 lds
    v_mfma_f32_16x16x32_bf16 a[56:59], v[92:95], v[56:59], a[56:59]
    s_add_u32 s70, s70, 65536
    v_mfma_f32_16x16x32_bf16 a[60:63], v[92:95], v[60:63], a[60:63]
    s_waitcnt vmcnt(4) lgkmcnt(0)
    s_barrier
    s_mov_b32 s80, 0
    s_mov_b32 s78, 0xffff
    s_mov_b32 s79, 0x0
    s_branch L_pollU_chk
L_pollU:
    buffer_load_dwordx2 v[26:27], v114, s[12:15], 0 offen sc1
    s_waitcnt vmcnt(0)
L_pollU_chk:
    v_cmp_ne_u32 vcc, s88, v26
    v_cmp_ne_u32 s[76:77], s89, v27
    s_add_u32 s80, s80, 1
    s_nop 0
    s_or_b64 vcc, vcc, s[76:77]
    s_and_b64 vcc, vcc, s[78:79]
    s_cmp_gt_u32 s80, 0x20000
    s_cbranch_scc1 L_pollU_done
    s_cbranch_vccnz L_pollU
L_pollU_done:
    v_lshrrev_b32 v240, 2, v1
    v_lshlrev_b32 v240, 8, v240
    v_and_b32 v241, 3, v1
    v_lshl_add_u32 v240, v241, 4, v240
    s_lshl_b32 s76, s75, 12
    s_add_u32 s76, s76, 16777216
    s_mul_i32 s77, s66, 5376
    s_add_u32 s77, s77, 114800
    s_add_u32 m0, s77, 0
    s_add_u32 s78, s76, 0
    buffer_load_dwordx4 v240, s[12:15], s78 offen sc1 lds
    s_add_u32 m0, s77, 1344
    s_add_u32 s78, s76, 64
    buffer_load_dwordx4 v240, s[12:15], s78 offen sc1 lds
    s_add_u32 m0, s77, 2688
    s_add_u32 s78, s76, 128
    buffer_load_dwordx4 v240, s[12:15], s78 offen sc1 lds
    s_add_u32 m0, s77, 4032
    s_add_u32 s78, s76, 192
    buffer_load_dwordx4 v240, s[12:15], s78 offen sc1 lds
    v_mul_u32_u24 v240, 37, v1
    v_lshrrev_b32 v240, 8, v240
    v_mul_u32_u24 v241, 7, v240
    v_sub_u32 v241, v1, v241
    v_mul_u32_u24 v240, 1344, v240
    v_lshl_add_u32 v240, v241, 4, v240
    s_mul_i32 s76, s66, 5376
    s_add_u32 s76, s76, 114688
    v_add_u32 v240, s76, v240
    s_mul_i32 s76, s66, 4160
    s_add_u32 s76, s76, 135744
    v_lshl_add_u32 v241, v1, 4, s76
    v_cmp_gt_u32 vcc, 28, v1
    v_mov_b32 v244, 0
    v_mov_b32 v245, 0
    v_cndmask_b32 v240, v241, v240, vcc
    v_mov_b32 v246, 0
    v_mov_b32 v247, 0
    s_mov_b32 exec_hi, 0
    ds_write_b128 v240, v[244:247]
    s_mov_b32 exec_hi, -1
    v_mfma_f32_16x16x32_bf16 a[0:3], v[64:67], v[32:35], a[0:3]
    v_mfma_f32_16x16x32_bf16 a[4:7], v[64:67], v[36:39], a[4:7]
    v_mfma_f32_16x16x32_bf16 a[8:11], v[64:67], v[40:43], a[8:11]
    v_mfma_f32_16x16x32_bf16 a[12:15], v[64:67], v[44:47], a[12:15]
    v_mfma_f32_16x16x32_bf16 a[16:19], v[68:71], v[32:35], a[16:19]
    v_mfma_f32_16x16x32_bf16 a[20:23], v[68:71], v[36:39], a[20:23]
    v_mfma_f32_16x16x32_bf16 a[24:27], v[68:71], v[40:43], a[24:27]
    v_mfma_f32_16x16x32_bf16 a[28:31], v[68:71], v[44:47], a[28:31]
    v_mfma_f32_16x16x32_bf16 a[32:35], v[72:75], v[32:35], a[32:35]
    s_add_u32 m0, s73, 90112
    v_mfma_f32_16x16x32_bf16 a[36:39], v[72:75], v[36:39], a[36:39]
    buffer_load_dwordx4 v122, s[40:43], s70 offen lds
    v_mfma_f32_16x16x32_bf16 a[40:43], v[72:75], v[40:43], a[40:43]
    v_mfma_f32_16x16x32_bf16 a[44:47], v[72:75], v[44:47], a[44:47]
    v_mfma_f32_16x16x32_bf16 a[48:51], v[76:79], v[32:35], a[48:51]
    v_mfma_f32_16x16x32_bf16 a[52:55], v[76:79], v[36:39], a[52:55]
    buffer_load_dwordx4 v123, s[40:43], s70 offen offset:1024 lds
    v_mfma_f32_16x16x32_bf16 a[56:59], v[76:79], v[40:43], a[56:59]
    s_add_u32 s70, s70, 65536
    v_mfma_f32_16x16x32_bf16 a[60:63], v[76:79], v[44:47], a[60:63]
    s_waitcnt vmcnt(2)
    s_mul_i32 s76, s66, 4160
    s_add_u32 s76, s76, 136192
    v_mov_b32 v24, s76
    ds_read_u16 v25, v24 offset:64
    v_lshrrev_b32 v26, 4, v1
    v_and_b32 v27, 1, v26
    v_lshlrev_b32 v27, 5, v27
    v_lshrrev_b32 v26, 1, v26
    v_lshlrev_b32 v26, 6, v26
    v_sub_u32 v27, v27, v26
    v_and_b32 v26, 3, v1
    v_lshl_add_u32 v27, v26, 3, v27
    v_lshrrev_b32 v26, 2, v1
    v_and_b32 v26, 3, v26
    v_lshlrev_b32 v26, 3, v26
    v_sub_u32 v27, v27, v26
    s_add_u32 s76, s76, 96
    v_add_u32 v120, s76, v27
    v_and_b32 v26, 3, v1
    v_mul_u32_u24 v26, 1344, v26
    v_and_b32 v27, 31, v1
    v_lshrrev_b32 v27, 2, v27
    v_lshrrev_b32 v28, 5, v1
    v_add_u32 v27, v27, v28
    v_lshl_add_u32 v26, v27, 4, v26
    s_mul_i32 s76, s66, 5376
    s_add_u32 s76, s76, 114688
    v_add_u32 v121, s76, v26
    v_lshlrev_b32 v125, 16, v125
    s_waitcnt lgkmcnt(0)
    v_lshlrev_b32 v25, 16, v25
    v_add_f32 v25, v25, v125
    v_cvt_pk_bf16_f32 v25, v25, v25
    ds_write_b16 v24, v25 offset:64
    ds_read_b64_tr_b16 a[140:141], v120 offset:416
    ds_read_b64_tr_b16 a[142:143], v120 offset:384
    ds_read_b64_tr_b16 a[156:157], v120 offset:928
    ds_read_b64_tr_b16 a[158:159], v120 offset:896
    ds_read_b64_tr_b16 a[172:173], v120 offset:1440
    ds_read_b64_tr_b16 a[174:175], v120 offset:1408
    ds_read_b64_tr_b16 a[188:189], v120 offset:1952
    ds_read_b64_tr_b16 a[190:191], v120 offset:1920
    ds_read_b64_tr_b16 a[204:205], v120 offset:2464
    ds_read_b64_tr_b16 a[206:207], v120 offset:2432
    ds_read_b64_tr_b16 a[220:221], v120 offset:2976
    ds_read_b64_tr_b16 a[222:223], v120 offset:2944
    ds_read_b64_tr_b16 a[236:237], v120 offset:3488
    ds_read_b64_tr_b16 a[238:239], v120 offset:3456
    ds_read_b64_tr_b16 a[252:253], v120 offset:4000
    ds_read_b64_tr_b16 a[254:255], v120 offset:3968
    ds_read_b128 v[32:35], v121 offset:0
    ds_read_b128 v[36:39], v121 offset:32
    ds_read_b128 v[40:43], v121 offset:64
    ds_read_b128 v[44:47], v121 offset:96
    ds_read_b128 v[48:51], v121 offset:128
    ds_read_b128 v[52:55], v121 offset:160
    v_lshlrev_b32 v97, 3, v1
    s_lshl_b32 s76, s66, 1
    s_add_u32 s76, s76, 98304
    v_add_u32 v97, s76, v97
    s_waitcnt lgkmcnt(0)
    v_mfma_f32_32x32x16_bf16 v[128:143], v[32:35], a[140:143], 0
    ds_read_b64_tr_b16 a[136:137], v120 offset:288
    ds_read_b64_tr_b16 a[138:139], v120 offset:256
    ds_read_b128 v[56:59], v121 offset:192
    v_mfma_f32_32x32x16_bf16 v[144:159], v[32:35], a[156:159], 0
    ds_read_b64_tr_b16 a[152:153], v120 offset:800
    ds_read_b64_tr_b16 a[154:155], v120 offset:768
    v_mfma_f32_32x32x16_bf16 v[160:175], v[32:35], a[172:175], 0
    ds_read_b64_tr_b16 a[168:169], v120 offset:1312
    ds_read_b64_tr_b16 a[170:171], v120 offset:1280
    v_mfma_f32_32x32x16_bf16 v[176:191], v[32:35], a[188:191], 0
    ds_read_b64_tr_b16 a[184:185], v120 offset:1824
    ds_read_b64_tr_b16 a[186:187], v120 offset:1792
    v_mfma_f32_32x32x16_bf16 v[192:207], v[32:35], a[204:207], 0
    ds_read_b64_tr_b16 a[200:201], v120 offset:2336
    ds_read_b64_tr_b16 a[202:203], v120 offset:2304
    v_mfma_f32_32x32x16_bf16 v[208:223], v[32:35], a[220:223], 0
    ds_read_b64_tr_b16 a[216:217], v120 offset:2848
    ds_read_b64_tr_b16 a[218:219], v120 offset:2816
    v_mfma_f32_32x32x16_bf16 v[224:239], v[32:35], a[236:239], 0
    ds_read_b64_tr_b16 a[232:233], v120 offset:3360
    ds_read_b64_tr_b16 a[234:235], v120 offset:3328
    v_mfma_f32_32x32x16_bf16 v[240:255], v[32:35], a[252:255], 0
    ds_read_b64_tr_b16 a[248:249], v120 offset:3872
    ds_read_b64_tr_b16 a[250:251], v120 offset:3840
    v_lshlrev_b32 v114, 3, v1
    s_lshl_b32 s76, s64, 7
    s_lshl_b32 s77, s100, 6
    s_add_u32 s76, s76, s77
    s_add_u32 s76, s76, 34611200
    v_add_u32 v114, s76, v114
    buffer_load_dwordx2 v[26:27], v114, s[12:15], 0 offen sc1
    s_waitcnt lgkmcnt(0)
    v_mfma_f32_32x32x16_bf16 v[128:143], v[36:39], a[136:139], v[128:143]
    ds_read_b64_tr_b16 a[132:133], v120 offset:160
    ds_read_b64_tr_b16 a[134:135], v120 offset:128
    ds_read_b128 v[60:63], v121 offset:224
    v_mfma_f32_32x32x16_bf16 v[144:159], v[36:39], a[152:155], v[144:159]
    ds_read_b64_tr_b16 a[148:149], v120 offset:672
    ds_read_b64_tr_b16 a[150:151], v120 offset:640
    v_mfma_f32_32x32x16_bf16 v[160:175], v[36:39], a[168:171], v[160:175]
    ds_read_b64_tr_b16 a[164:165], v120 offset:1184
    ds_read_b64_tr_b16 a[166:167], v120 offset:1152
    v_mfma_f32_32x32x16_bf16 v[176:191], v[36:39], a[184:187], v[176:191]
    ds_read_b64_tr_b16 a[180:181], v120 offset:1696
    ds_read_b64_tr_b16 a[182:183], v120 offset:1664
    v_mfma_f32_32x32x16_bf16 v[192:207], v[36:39], a[200:203], v[192:207]
    ds_read_b64_tr_b16 a[196:197], v120 offset:2208
    ds_read_b64_tr_b16 a[198:199], v120 offset:2176
    v_mfma_f32_32x32x16_bf16 v[208:223], v[36:39], a[216:219], v[208:223]
    ds_read_b64_tr_b16 a[212:213], v120 offset:2720
    ds_read_b64_tr_b16 a[214:215], v120 offset:2688
    v_mfma_f32_32x32x16_bf16 v[224:239], v[36:39], a[232:235], v[224:239]
    ds_read_b64_tr_b16 a[228:229], v120 offset:3232
    ds_read_b64_tr_b16 a[230:231], v120 offset:3200
    v_mfma_f32_32x32x16_bf16 v[240:255], v[36:39], a[248:251], v[240:255]
    ds_read_b64_tr_b16 a[244:245], v120 offset:3744
    ds_read_b64_tr_b16 a[246:247], v120 offset:3712
    s_waitcnt lgkmcnt(0)
    v_mfma_f32_32x32x16_bf16 v[128:143], v[40:43], a[132:135], v[128:143]
    ds_read_b64_tr_b16 a[128:129], v120 offset:32
    ds_read_b64_tr_b16 a[130:131], v120 offset:0
    ds_read_b128 v[32:35], v121 offset:256
    v_mfma_f32_32x32x16_bf16 v[144:159], v[40:43], a[148:151], v[144:159]
    ds_read_b64_tr_b16 a[144:145], v120 offset:544
    ds_read_b64_tr_b16 a[146:147], v120 offset:512
    v_mfma_f32_32x32x16_bf16 v[160:175], v[40:43], a[164:167], v[160:175]
    ds_read_b64_tr_b16 a[160:161], v120 offset:1056
    ds_read_b64_tr_b16 a[162:163], v120 offset:1024
    v_mfma_f32_32x32x16_bf16 v[176:191], v[40:43], a[180:183], v[176:191]
    ds_read_b64_tr_b16 a[176:177], v120 offset:1568
    ds_read_b64_tr_b16 a[178:179], v120 offset:1536
    v_mfma_f32_32x32x16_bf16 v[192:207], v[40:43], a[196:199], v[192:207]
    ds_read_b64_tr_b16 a[192:193], v120 offset:2080
    ds_read_b64_tr_b16 a[194:195], v120 offset:2048
    v_mfma_f32_32x32x16_bf16 v[208:223], v[40:43], a[212:215], v[208:223]
    ds_read_b64_tr_b16 a[208:209], v120 offset:2592
    ds_read_b64_tr_b16 a[210:211], v120 offset:2560
    v_mfma_f32_32x32x16_bf16 v[224:239], v[40:43], a[228:231], v[224:239]
    ds_read_b64_tr_b16 a[224:225], v120 offset:3104
    ds_read_b64_tr_b16 a[226:227], v120 offset:3072
    v_mfma_f32_32x32x16_bf16 v[240:255], v[40:43], a[244:247], v[240:255]
    ds_read_b64_tr_b16 a[240:241], v120 offset:3616
    ds_read_b64_tr_b16 a[242:243], v120 offset:3584
    s_waitcnt lgkmcnt(0)
    v_mfma_f32_32x32x16_bf16 v[128:143], v[44:47], a[128:131], v[128:143]
    ds_read_b128 v[36:39], v121 offset:288
    v_mfma_f32_32x32x16_bf16 v[144:159], v[44:47], a[144:147], v[144:159]
    v_mfma_f32_32x32x16_bf16 v[160:175], v[44:47], a[160:163], v[160:175]
    v_mfma_f32_32x32x16_bf16 v[176:191], v[44:47], a[176:179], v[176:191]
    v_mfma_f32_32x32x16_bf16 v[192:207], v[44:47], a[192:195], v[192:207]
    v_mfma_f32_32x32x16_bf16 v[208:223], v[44:47], a[208:211], v[208:223]
    v_mfma_f32_32x32x16_bf16 v[224:239], v[44:47], a[224:227], v[224:239]
    v_mfma_f32_32x32x16_bf16 v[240:255], v[44:47], a[240:243], v[240:255]
    s_waitcnt vmcnt(0)
    s_mov_b32 s80, 0
    s_mov_b32 s78, 0xff
    s_mov_b32 s79, 0x0
    s_branch L_pollH_chk
L_pollH:
    buffer_load_dwordx2 v[26:27], v114, s[12:15], 0 offen sc1
    s_waitcnt vmcnt(0)
L_pollH_chk:
    v_cmp_ne_u32 vcc, s88, v26
    v_cmp_ne_u32 s[76:77], s89, v27
    s_add_u32 s80, s80, 1
    s_nop 0
    s_or_b64 vcc, vcc, s[76:77]
    s_and_b64 vcc, vcc, s[78:79]
    s_cmp_gt_u32 s80, 0x20000
    s_cbranch_scc1 L_pollH_done
    s_cbranch_vccnz L_pollH
L_pollH_done:
    s_mul_i32 s76, s66, 56
    v_add_u32 v24, s76, v1
    v_lshlrev_b32 v24, 7, v24
    s_lshl_b32 s76, s64, 4
    s_add_u32 s76, s76, s65
    s_mul_i32 s76, s76, 28672
    s_mov_b32 exec_hi, 0x00ffffff
    buffer_load_dword v127, v24, s[40:43], s76 offen
    s_mov_b32 exec_hi, -1
    s_waitcnt lgkmcnt(0)
    v_mfma_f32_32x32x16_bf16 v[144:159], v[48:51], a[140:143], v[144:159]
    ds_read_b128 v[40:43], v121 offset:320
    v_mfma_f32_32x32x16_bf16 v[160:175], v[48:51], a[156:159], v[160:175]
    v_mfma_f32_32x32x16_bf16 v[176:191], v[48:51], a[172:175], v[176:191]
    v_mfma_f32_32x32x16_bf16 v[192:207], v[48:51], a[188:191], v[192:207]
    v_mfma_f32_32x32x16_bf16 v[208:223], v[48:51], a[204:207], v[208:223]
    v_mfma_f32_32x32x16_bf16 v[224:239], v[48:51], a[220:223], v[224:239]
    v_mfma_f32_32x32x16_bf16 v[240:255], v[48:51], a[236:239], v[240:255]
    s_add_u32 m0, s73, 0
    s_nop 0
    buffer_load_dwordx4 v16, s[16:19], s69 offen sc1 lds
    s_waitcnt lgkmcnt(0)
    v_mfma_f32_32x32x16_bf16 v[144:159], v[52:55], a[136:139], v[144:159]
    ds_read_b128 v[44:47], v121 offset:352
    v_mov_b32 v96, v130
    v_add_f32_dpp v96, v131, v130 wave_shr:1 row_mask:0xf bank_mask:0xf
    v_mfma_f32_32x32x16_bf16 v[160:175], v[52:55], a[152:155], v[160:175]
    v_add_f32_dpp v131, v131, v134 wave_ror:1 row_mask:0xf bank_mask:0xf
    v_add_f32_dpp v131, v135, v134 wave_shr:1 row_mask:0xf bank_mask:0xf
    v_mfma_f32_32x32x16_bf16 v[176:191], v[52:55], a[168:171], v[176:191]
    v_add_f32_dpp v135, v135, v138 wave_ror:1 row_mask:0xf bank_mask:0xf
    v_add_f32_dpp v135, v139, v138 wave_shr:1 row_mask:0xf bank_mask:0xf
    v_mfma_f32_32x32x16_bf16 v[192:207], v[52:55], a[184:187], v[192:207]
    v_add_f32_dpp v139, v139, v142 wave_ror:1 row_mask:0xf bank_mask:0xf
    v_add_f32_dpp v139, v143, v142 wave_shr:1 row_mask:0xf bank_mask:0xf
    v_mfma_f32_32x32x16_bf16 v[208:223], v[52:55], a[200:203], v[208:223]
    s_nop 0
    v_mov_b32 v130, v129
    v_mfma_f32_32x32x16_bf16 v[224:239], v[52:55], a[216:219], v[224:239]
    v_add_f32_dpp v130, v96, v129 wave_shr:1 row_mask:0xf bank_mask:0xf
    v_add_f32_dpp v134, v96, v133 wave_ror:1 row_mask:0xf bank_mask:0xf
    v_mfma_f32_32x32x16_bf16 v[240:255], v[52:55], a[232:235], v[240:255]
    v_add_f32_dpp v134, v131, v133 wave_shr:1 row_mask:0xf bank_mask:0xf
    v_add_f32_dpp v138, v131, v137 wave_ror:1 row_mask:0xf bank_mask:0xf
    s_waitcnt lgkmcnt(15)
    v_mfma_f32_32x32x16_bf16 v[144:159], v[56:59], a[132:135], v[144:159]
    ds_read_b128 v[48:51], v121 offset:384
    v_add_f32_dpp v138, v135, v137 wave_shr:1 row_mask:0xf bank_mask:0xf
    v_add_f32_dpp v142, v135, v141 wave_ror:1 row_mask:0xf bank_mask:0xf
    v_mfma_f32_32x32x16_bf16 v[160:175], v[56:59], a[148:151], v[160:175]
    v_add_f32_dpp v142, v139, v141 wave_shr:1 row_mask:0xf bank_mask:0xf
    s_nop 0
    v_mfma_f32_32x32x16_bf16 v[176:191], v[56:59], a[164:167], v[176:191]
    v_mov_b32 v129, v128
    v_add_f32_dpp v129, v130, v128 wave_shr:1 row_mask:0xf bank_mask:0xf
    v_mfma_f32_32x32x16_bf16 v[192:207], v[56:59], a[180:183], v[192:207]
    v_add_f32_dpp v133, v130, v132 wave_ror:1 row_mask:0xf bank_mask:0xf
    v_add_f32_dpp v133, v134, v132 wave_shr:1 row_mask:0xf bank_mask:0xf
    v_mfma_f32_32x32x16_bf16 v[208:223], v[56:59], a[196:199], v[208:223]
    v_add_f32_dpp v137, v134, v136 wave_ror:1 row_mask:0xf bank_mask:0xf
    v_add_f32_dpp v137, v138, v136 wave_shr:1 row_mask:0xf bank_mask:0xf
    v_mfma_f32_32x32x16_bf16 v[224:239], v[56:59], a[212:215], v[224:239]
    v_add_f32_dpp v141, v138, v140 wave_ror:1 row_mask:0xf bank_mask:0xf
    v_add_f32_dpp v141, v142, v140 wave_shr:1 row_mask:0xf bank_mask:0xf
    v_mfma_f32_32x32x16_bf16 v[240:255], v[56:59], a[228:231], v[240:255]
    v_cvt_pk_bf16_f32 v128, v129, v133
    ds_write_b16 v97, v128 offset:0
    buffer_load_dwordx4 v16, s[16:19], s69 offen offset:1024 sc1 lds
    s_add_u32 s69, s69, 8192
    s_waitcnt lgkmcnt(15)
    v_mfma_f32_32x32x16_bf16 v[144:159], v[60:63], a[128:131], v[144:159]
    ds_read_b128 v[52:55], v121 offset:416
    ds_write_b16_d16_hi v97, v128 offset:512
    v_cvt_pk_bf16_f32 v136, v137, v141
    v_mfma_f32_32x32x16_bf16 v[160:175], v[60:63], a[144:147], v[160:175]
    ds_write_b16 v97, v136 offset:1024
    ds_write_b16_d16_hi v97, v136 offset:1536
    v_mfma_f32_32x32x16_bf16 v[176:191], v[60:63], a[160:163], v[176:191]
    v_mfma_f32_32x32x16_bf16 v[192:207], v[60:63], a[176:179], v[192:207]
    v_mfma_f32_32x32x16_bf16 v[208:223], v[60:63], a[192:195], v[208:223]
    v_mfma_f32_32x32x16_bf16 v[224:239], v[60:63], a[208:211], v[224:239]
    v_mfma_f32_32x32x16_bf16 v[240:255], v[60:63], a[224:227], v[240:255]
    s_waitcnt lgkmcnt(15)
    v_mfma_f32_32x32x16_bf16 v[160:175], v[32:35], a[140:143], v[160:175]
    ds_read_b128 v[56:59], v121 offset:448
    v_mfma_f32_32x32x16_bf16 v[176:191], v[32:35], a[156:159], v[176:191]
    v_mfma_f32_32x32x16_bf16 v[192:207], v[32:35], a[172:175], v[192:207]
    v_mfma_f32_32x32x16_bf16 v[208:223], v[32:35], a[188:191], v[208:223]
    v_mfma_f32_32x32x16_bf16 v[224:239], v[32:35], a[204:207], v[224:239]
    v_mfma_f32_32x32x16_bf16 v[240:255], v[32:35], a[220:223], v[240:255]
    s_add_u32 m0, s73, 16384
    s_nop 0
    buffer_load_dwordx4 v16, s[16:19], s69 offen sc1 lds
    s_waitcnt lgkmcnt(9)
    v_mfma_f32_32x32x16_bf16 v[160:175], v[36:39], a[136:139], v[160:175]
    ds_read_b128 v[60:63], v121 offset:480
    v_add_f32_dpp v143, v143, v146 wave_ror:1 row_mask:0xf bank_mask:0xf
    v_add_f32_dpp v143, v147, v146 wave_shr:1 row_mask:0xf bank_mask:0xf
    v_mfma_f32_32x32x16_bf16 v[176:191], v[36:39], a[152:155], v[176:191]
    v_add_f32_dpp v147, v147, v150 wave_ror:1 row_mask:0xf bank_mask:0xf
    v_add_f32_dpp v147, v151, v150 wave_shr:1 row_mask:0xf bank_mask:0xf
    v_mfma_f32_32x32x16_bf16 v[192:207], v[36:39], a[168:171], v[192:207]
    v_add_f32_dpp v151, v151, v154 wave_ror:1 row_mask:0xf bank_mask:0xf
    v_add_f32_dpp v151, v155, v154 wave_shr:1 row_mask:0xf bank_mask:0xf
    v_mfma_f32_32x32x16_bf16 v[208:223], v[36:39], a[184:187], v[208:223]
    v_add_f32_dpp v155, v155, v158 wave_ror:1 row_mask:0xf bank_mask:0xf
    v_add_f32_dpp v155, v159, v158 wave_shr:1 row_mask:0xf bank_mask:0xf
    v_mfma_f32_32x32x16_bf16 v[224:239], v[36:39], a[200:203], v[224:239]
    s_nop 0
    v_add_f32_dpp v146, v139, v145 wave_ror:1 row_mask:0xf bank_mask:0xf
    v_mfma_f32_32x32x16_bf16 v[240:255], v[36:39], a[216:219], v[240:255]
    v_add_f32_dpp v146, v143, v145 wave_shr:1 row_mask:0xf bank_mask:0xf
    v_add_f32_dpp v150, v143, v149 wave_ror:1 row_mask:0xf bank_mask:0xf
    s_waitcnt lgkmcnt(9)
    v_mfma_f32_32x32x16_bf16 v[160:175], v[40:43], a[132:135], v[160:175]
    ds_read_b128 v[32:35], v121 offset:512
    v_add_f32_dpp v150, v147, v149 wave_shr:1 row_mask:0xf bank_mask:0xf
    v_add_f32_dpp v154, v147, v153 wave_ror:1 row_mask:0xf bank_mask:0xf
    v_mfma_f32_32x32x16_bf16 v[176:191], v[40:43], a[148:151], v[176:191]
    v_add_f32_dpp v154, v151, v153 wave_shr:1 row_mask:0xf bank_mask:0xf
    v_add_f32_dpp v158, v151, v157 wave_ror:1 row_mask:0xf bank_mask:0xf
    v_mfma_f32_32x32x16_bf16 v[192:207], v[40:43], a[164:167], v[192:207]
    v_add_f32_dpp v158, v155, v157 wave_shr:1 row_mask:0xf bank_mask:0xf
    s_nop 0
    v_mfma_f32_32x32x16_bf16 v[208:223], v[40:43], a[180:183], v[208:223]
    v_add_f32_dpp v145, v142, v144 wave_ror:1 row_mask:0xf bank_mask:0xf
    v_add_f32_dpp v145, v146, v144 wave_shr:1 row_mask:0xf bank_mask:0xf
    v_mfma_f32_32x32x16_bf16 v[224:239], v[40:43], a[196:199], v[224:239]
    v_add_f32_dpp v149, v146, v148 wave_ror:1 row_mask:0xf bank_mask:0xf
    v_add_f32_dpp v149, v150, v148 wave_shr:1 row_mask:0xf bank_mask:0xf
    v_mfma_f32_32x32x16_bf16 v[240:255], v[40:43], a[212:215], v[240:255]
    v_add_f32_dpp v153, v150, v152 wave_ror:1 row_mask:0xf bank_mask:0xf
    v_add_f32_dpp v153, v154, v152 wave_shr:1 row_mask:0xf bank_mask:0xf
    s_lshr_b32 s76, s2, 3
    s_lshl_b32 s76, s76, 2
    s_add_u32 s76, s76, s66
    s_lshl_b32 s76, s76, 8
    s_add_u32 s76, s76, (L_convend-L_pc)
    v_and_b32 v28, 1, v1
    v_lshl_add_u32 v28, v28, 7, s76
    v_min_u32 v28, (L_end-L_pc), v28
    v_mov_b32 v31, s59
    v_add_co_u32 v30, vcc, s58, v28
    s_nop 1
    v_addc_co_u32 v31, vcc, 0, v31, vcc
    s_mov_b64 exec, 3
    global_load_dword v127, v[30:31], off
    s_mov_b64 exec, -1
    buffer_load_dwordx4 v16, s[16:19], s69 offen offset:1024 sc1 lds
    s_add_u32 s69, s69, 8192
    s_waitcnt lgkmcnt(9)
    v_mfma_f32_32x32x16_bf16 v[160:175], v[44:47], a[128:131], v[160:175]
    ds_read_b128 v[36:39], v121 offset:544
    v_add_f32_dpp v157, v154, v156 wave_ror:1 row_mask:0xf bank_mask:0xf
    v_add_f32_dpp v157, v158, v156 wave_shr:1 row_mask:0xf bank_mask:0xf
    v_mfma_f32_32x32x16_bf16 v[176:191], v[44:47], a[144:147], v[176:191]
    v_cvt_pk_bf16_f32 v144, v145, v149
    ds_write_b16 v97, v144 offset:2048
    v_mfma_f32_32x32x16_bf16 v[192:207], v[44:47], a[160:163], v[192:207]
    ds_write_b16_d16_hi v97, v144 offset:2560
    v_cvt_pk_bf16_f32 v152, v153, v157
    v_mfma_f32_32x32x16_bf16 v[208:223], v[44:47], a[176:179], v[208:223]
    ds_write_b16 v97, v152 offset:3072
    ds_write_b16_d16_hi v97, v152 offset:3584
    v_mfma_f32_32x32x16_bf16 v[224:239], v[44:47], a[192:195], v[224:239]
    v_mfma_f32_32x32x16_bf16 v[240:255], v[44:47], a[208:211], v[240:255]
    s_waitcnt lgkmcnt(13)
    v_mfma_f32_32x32x16_bf16 v[176:191], v[48:51], a[140:143], v[176:191]
    ds_read_b128 v[40:43], v121 offset:576
    v_mfma_f32_32x32x16_bf16 v[192:207], v[48:51], a[156:159], v[192:207]
    v_mfma_f32_32x32x16_bf16 v[208:223], v[48:51], a[172:175], v[208:223]
    v_mfma_f32_32x32x16_bf16 v[224:239], v[48:51], a[188:191], v[224:239]
    v_mfma_f32_32x32x16_bf16 v[240:255], v[48:51], a[204:207], v[240:255]
    s_add_u32 m0, s73, 32768
    s_nop 0
    buffer_load_dwordx4 v16, s[16:19], s69 offen sc1 lds
    s_waitcnt lgkmcnt(12)
    v_mfma_f32_32x32x16_bf16 v[176:191], v[52:55], a[136:139], v[176:191]
    ds_read_b128 v[44:47], v121 offset:608
    v_add_f32_dpp v159, v159, v162 wave_ror:1 row_mask:0xf bank_mask:0xf
    v_add_f32_dpp v159, v163, v162 wave_shr:1 row_mask:0xf bank_mask:0xf
    v_mfma_f32_32x32x16_bf16 v[192:207], v[52:55], a[152:155], v[192:207]
    v_add_f32_dpp v163, v163, v166 wave_ror:1 row_mask:0xf bank_mask:0xf
    v_add_f32_dpp v163, v167, v166 wave_shr:1 row_mask:0xf bank_mask:0xf
    v_mfma_f32_32x32x16_bf16 v[208:223], v[52:55], a[168:171], v[208:223]
    v_add_f32_dpp v167, v167, v170 wave_ror:1 row_mask:0xf bank_mask:0xf
    v_add_f32_dpp v167, v171, v170 wave_shr:1 row_mask:0xf bank_mask:0xf
    v_mfma_f32_32x32x16_bf16 v[224:239], v[52:55], a[184:187], v[224:239]
    v_add_f32_dpp v171, v171, v174 wave_ror:1 row_mask:0xf bank_mask:0xf
    v_add_f32_dpp v171, v175, v174 wave_shr:1 row_mask:0xf bank_mask:0xf
    v_mfma_f32_32x32x16_bf16 v[240:255], v[52:55], a[200:203], v[240:255]
    s_nop 0
    v_add_f32_dpp v162, v155, v161 wave_ror:1 row_mask:0xf bank_mask:0xf
    s_waitcnt lgkmcnt(9)
    v_mfma_f32_32x32x16_bf16 v[176:191], v[56:59], a[132:135], v[176:191]
    ds_read_b128 v[48:51], v121 offset:640
    v_add_f32_dpp v162, v159, v161 wave_shr:1 row_mask:0xf bank_mask:0xf
    v_add_f32_dpp v166, v159, v165 wave_ror:1 row_mask:0xf bank_mask:0xf
    v_mfma_f32_32x32x16_bf16 v[192:207], v[56:59], a[148:151], v[192:207]
    v_add_f32_dpp v166, v163, v165 wave_shr:1 row_mask:0xf bank_mask:0xf
    v_add_f32_dpp v170, v163, v169 wave_ror:1 row_mask:0xf bank_mask:0xf
    v_mfma_f32_32x32x16_bf16 v[208:223], v[56:59], a[164:167], v[208:223]
    v_add_f32_dpp v170, v167, v169 wave_shr:1 row_mask:0xf bank_mask:0xf
    v_add_f32_dpp v174, v167, v173 wave_ror:1 row_mask:0xf bank_mask:0xf
    v_mfma_f32_32x32x16_bf16 v[224:239], v[56:59], a[180:183], v[224:239]
    v_add_f32_dpp v174, v171, v173 wave_shr:1 row_mask:0xf bank_mask:0xf
    s_nop 0
    v_mfma_f32_32x32x16_bf16 v[240:255], v[56:59], a[196:199], v[240:255]
    v_add_f32_dpp v161, v158, v160 wave_ror:1 row_mask:0xf bank_mask:0xf
    v_add_f32_dpp v161, v162, v160 wave_shr:1 row_mask:0xf bank_mask:0xf
    buffer_load_dwordx4 v16, s[16:19], s69 offen offset:1024 sc1 lds
    s_add_u32 s69, s69, 8192
    s_waitcnt lgkmcnt(9)
    v_mfma_f32_32x32x16_bf16 v[176:191], v[60:63], a[128:131], v[176:191]
    ds_read_b128 v[52:55], v121 offset:672
    v_add_f32_dpp v165, v162, v164 wave_ror:1 row_mask:0xf bank_mask:0xf
    v_add_f32_dpp v165, v166, v164 wave_shr:1 row_mask:0xf bank_mask:0xf
    v_mfma_f32_32x32x16_bf16 v[192:207], v[60:63], a[144:147], v[192:207]
    v_add_f32_dpp v169, v166, v168 wave_ror:1 row_mask:0xf bank_mask:0xf
    v_add_f32_dpp v169, v170, v168 wave_shr:1 row_mask:0xf bank_mask:0xf
    v_mfma_f32_32x32x16_bf16 v[208:223], v[60:63], a[160:163], v[208:223]
    v_add_f32_dpp v173, v170, v172 wave_ror:1 row_mask:0xf bank_mask:0xf
    v_add_f32_dpp v173, v174, v172 wave_shr:1 row_mask:0xf bank_mask:0xf
    v_mfma_f32_32x32x16_bf16 v[224:239], v[60:63], a[176:179], v[224:239]
    v_cvt_pk_bf16_f32 v160, v161, v165
    ds_write_b16 v97, v160 offset:4096
    v_mfma_f32_32x32x16_bf16 v[240:255], v[60:63], a[192:195], v[240:255]
    ds_write_b16_d16_hi v97, v160 offset:4608
    v_cvt_pk_bf16_f32 v168, v169, v173
    s_waitcnt lgkmcnt(11)
    v_mfma_f32_32x32x16_bf16 v[192:207], v[32:35], a[140:143], v[192:207]
    ds_read_b128 v[56:59], v121 offset:704
    ds_write_b16 v97, v168 offset:5120
    ds_write_b16_d16_hi v97, v168 offset:5632
    v_mfma_f32_32x32x16_bf16 v[208:223], v[32:35], a[156:159], v[208:223]
    v_mfma_f32_32x32x16_bf16 v[224:239], v[32:35], a[172:175], v[224:239]
    v_mfma_f32_32x32x16_bf16 v[240:255], v[32:35], a[188:191], v[240:255]
    s_add_u32 m0, s73, 49152
    s_nop 0
    buffer_load_dwordx4 v16, s[16:19], s69 offen sc1 lds
    s_waitcnt lgkmcnt(13)
    v_mfma_f32_32x32x16_bf16 v[192:207], v[36:39], a[136:139], v[192:207]
    ds_read_b128 v[60:63], v121 offset:736
    v_add_f32_dpp v175, v175, v178 wave_ror:1 row_mask:0xf bank_mask:0xf
    v_add_f32_dpp v175, v179, v178 wave_shr:1 row_mask:0xf bank_mask:0xf
    v_add_f32_dpp v179, v179, v182 wave_ror:1 row_mask:0xf bank_mask:0xf
    v_mfma_f32_32x32x16_bf16 v[208:223], v[36:39], a[152:155], v[208:223]
    v_add_f32_dpp v179, v183, v182 wave_shr:1 row_mask:0xf bank_mask:0xf
    v_add_f32_dpp v183, v183, v186 wave_ror:1 row_mask:0xf bank_mask:0xf
    v_add_f32_dpp v183, v187, v186 wave_shr:1 row_mask:0xf bank_mask:0xf
    v_mfma_f32_32x32x16_bf16 v[224:239], v[36:39], a[168:171], v[224:239]
    v_add_f32_dpp v187, v187, v190 wave_ror:1 row_mask:0xf bank_mask:0xf
    v_add_f32_dpp v187, v191, v190 wave_shr:1 row_mask:0xf bank_mask:0xf
    s_nop 0
    v_mfma_f32_32x32x16_bf16 v[240:255], v[36:39], a[184:187], v[240:255]
    v_add_f32_dpp v178, v171, v177 wave_ror:1 row_mask:0xf bank_mask:0xf
    v_add_f32_dpp v178, v175, v177 wave_shr:1 row_mask:0xf bank_mask:0xf
    v_add_f32_dpp v182, v175, v181 wave_ror:1 row_mask:0xf bank_mask:0xf
    s_waitcnt lgkmcnt(9)
    v_mfma_f32_32x32x16_bf16 v[192:207], v[40:43], a[132:135], v[192:207]
    ds_read_b128 v[32:35], v121 offset:768
    v_add_f32_dpp v182, v179, v181 wave_shr:1 row_mask:0xf bank_mask:0xf
    v_add_f32_dpp v186, v179, v185 wave_ror:1 row_mask:0xf bank_mask:0xf
    v_add_f32_dpp v186, v183, v185 wave_shr:1 row_mask:0xf bank_mask:0xf
    v_mfma_f32_32x32x16_bf16 v[208:223], v[40:43], a[148:151], v[208:223]
    v_add_f32_dpp v190, v183, v189 wave_ror:1 row_mask:0xf bank_mask:0xf
    v_add_f32_dpp v190, v187, v189 wave_shr:1 row_mask:0xf bank_mask:0xf
    s_nop 0
    v_mfma_f32_32x32x16_bf16 v[224:239], v[40:43], a[164:167], v[224:239]
    v_add_f32_dpp v177, v174, v176 wave_ror:1 row_mask:0xf bank_mask:0xf
    v_add_f32_dpp v177, v178, v176 wave_shr:1 row_mask:0xf bank_mask:0xf
    v_add_f32_dpp v181, v178, v180 wave_ror:1 row_mask:0xf bank_mask:0xf
    v_mfma_f32_32x32x16_bf16 v[240:255], v[40:43], a[180:183], v[240:255]
    v_add_f32_dpp v181, v182, v180 wave_shr:1 row_mask:0xf bank_mask:0xf
    v_add_f32_dpp v185, v182, v184 wave_ror:1 row_mask:0xf bank_mask:0xf
    v_add_f32_dpp v185, v186, v184 wave_shr:1 row_mask:0xf bank_mask:0xf
    buffer_load_dwordx4 v16, s[16:19], s69 offen offset:1024 sc1 lds
    s_add_u32 s69, s69, 8192
    s_waitcnt lgkmcnt(9)
    v_mfma_f32_32x32x16_bf16 v[192:207], v[44:47], a[128:131], v[192:207]
    ds_read_b128 v[36:39], v121 offset:800
    v_add_f32_dpp v189, v186, v188 wave_ror:1 row_mask:0xf bank_mask:0xf
    v_add_f32_dpp v189, v190, v188 wave_shr:1 row_mask:0xf bank_mask:0xf
    v_cvt_pk_bf16_f32 v176, v177, v181
    v_mfma_f32_32x32x16_bf16 v[208:223], v[44:47], a[144:147], v[208:223]
    ds_write_b16 v97, v176 offset:6144
    ds_write_b16_d16_hi v97, v176 offset:6656
    v_cvt_pk_bf16_f32 v184, v185, v189
    v_mfma_f32_32x32x16_bf16 v[224:239], v[44:47], a[160:163], v[224:239]
    ds_write_b16 v97, v184 offset:7168
    ds_write_b16_d16_hi v97, v184 offset:7680
    v_mfma_f32_32x32x16_bf16 v[240:255], v[44:47], a[176:179], v[240:255]
    s_waitcnt lgkmcnt(13)
    v_mfma_f32_32x32x16_bf16 v[208:223], v[48:51], a[140:143], v[208:223]
    ds_read_b128 v[40:43], v121 offset:832
    v_mfma_f32_32x32x16_bf16 v[224:239], v[48:51], a[156:159], v[224:239]
    v_mfma_f32_32x32x16_bf16 v[240:255], v[48:51], a[172:175], v[240:255]
    s_add_u32 m0, s73, 65536
    s_nop 0
    buffer_load_dwordx4 v16, s[16:19], s69 offen sc1 lds
    s_waitcnt lgkmcnt(13)
    v_mfma_f32_32x32x16_bf16 v[208:223], v[52:55], a[136:139], v[208:223]
    ds_read_b128 v[44:47], v121 offset:864
    v_add_f32_dpp v191, v191, v194 wave_ror:1 row_mask:0xf bank_mask:0xf
    v_add_f32_dpp v191, v195, v194 wave_shr:1 row_mask:0xf bank_mask:0xf
    v_add_f32_dpp v195, v195, v198 wave_ror:1 row_mask:0xf bank_mask:0xf
    v_mfma_f32_32x32x16_bf16 v[224:239], v[52:55], a[152:155], v[224:239]
    v_add_f32_dpp v195, v199, v198 wave_shr:1 row_mask:0xf bank_mask:0xf
    v_add_f32_dpp v199, v199, v202 wave_ror:1 row_mask:0xf bank_mask:0xf
    v_add_f32_dpp v199, v203, v202 wave_shr:1 row_mask:0xf bank_mask:0xf
    v_mfma_f32_32x32x16_bf16 v[240:255], v[52:55], a[168:171], v[240:255]
    v_add_f32_dpp v203, v203, v206 wave_ror:1 row_mask:0xf bank_mask:0xf
    v_add_f32_dpp v203, v207, v206 wave_shr:1 row_mask:0xf bank_mask:0xf
    s_nop 0
    s_waitcnt lgkmcnt(11)
    v_mfma_f32_32x32x16_bf16 v[208:223], v[56:59], a[132:135], v[208:223]
    ds_read_b128 v[48:51], v121 offset:896
    v_add_f32_dpp v194, v187, v193 wave_ror:1 row_mask:0xf bank_mask:0xf
    v_add_f32_dpp v194, v191, v193 wave_shr:1 row_mask:0xf bank_mask:0xf
    v_add_f32_dpp v198, v191, v197 wave_ror:1 row_mask:0xf bank_mask:0xf
    v_mfma_f32_32x32x16_bf16 v[224:239], v[56:59], a[148:151], v[224:239]
    v_add_f32_dpp v198, v195, v197 wave_shr:1 row_mask:0xf bank_mask:0xf
    v_add_f32_dpp v202, v195, v201 wave_ror:1 row_mask:0xf bank_mask:0xf
    v_add_f32_dpp v202, v199, v201 wave_shr:1 row_mask:0xf bank_mask:0xf
    v_mfma_f32_32x32x16_bf16 v[240:255], v[56:59], a[164:167], v[240:255]
    v_add_f32_dpp v206, v199, v205 wave_ror:1 row_mask:0xf bank_mask:0xf
    v_add_f32_dpp v206, v203, v205 wave_shr:1 row_mask:0xf bank_mask:0xf
    s_nop 0
    buffer_load_dwordx4 v16, s[16:19], s69 offen offset:1024 sc1 lds
    s_add_u32 s69, s69, 8192
    s_waitcnt lgkmcnt(9)
    v_mfma_f32_32x32x16_bf16 v[208:223], v[60:63], a[128:131], v[208:223]
    ds_read_b128 v[52:55], v121 offset:928
    v_add_f32_dpp v193, v190, v192 wave_ror:1 row_mask:0xf bank_mask:0xf
    v_add_f32_dpp v193, v194, v192 wave_shr:1 row_mask:0xf bank_mask:0xf
    v_add_f32_dpp v197, v194, v196 wave_ror:1 row_mask:0xf bank_mask:0xf
    v_mfma_f32_32x32x16_bf16 v[224:239], v[60:63], a[144:147], v[224:239]
    v_add_f32_dpp v197, v198, v196 wave_shr:1 row_mask:0xf bank_mask:0xf
    v_add_f32_dpp v201, v198, v200 wave_ror:1 row_mask:0xf bank_mask:0xf
    v_add_f32_dpp v201, v202, v200 wave_shr:1 row_mask:0xf bank_mask:0xf
    v_mfma_f32_32x32x16_bf16 v[240:255], v[60:63], a[160:163], v[240:255]
    v_add_f32_dpp v205, v202, v204 wave_ror:1 row_mask:0xf bank_mask:0xf
    v_add_f32_dpp v205, v206, v204 wave_shr:1 row_mask:0xf bank_mask:0xf
    v_cvt_pk_bf16_f32 v192, v193, v197
    s_waitcnt lgkmcnt(9)
    v_mfma_f32_32x32x16_bf16 v[224:239], v[32:35], a[140:143], v[224:239]
    ds_read_b128 v[56:59], v121 offset:960
    ds_write_b16 v97, v192 offset:8192
    ds_write_b16_d16_hi v97, v192 offset:8704
    v_cvt_pk_bf16_f32 v200, v201, v205
    v_mfma_f32_32x32x16_bf16 v[240:255], v[32:35], a[156:159], v[240:255]
    ds_write_b16 v97, v200 offset:9216
    ds_write_b16_d16_hi v97, v200 offset:9728
    s_add_u32 m0, s73, 81920
    s_nop 0
    buffer_load_dwordx4 v16, s[16:19], s69 offen sc1 lds
    s_waitcnt lgkmcnt(13)
    v_mfma_f32_32x32x16_bf16 v[224:239], v[36:39], a[136:139], v[224:239]
    ds_read_b128 v[60:63], v121 offset:992
    v_add_f32_dpp v207, v207, v210 wave_ror:1 row_mask:0xf bank_mask:0xf
    v_add_f32_dpp v207, v211, v210 wave_shr:1 row_mask:0xf bank_mask:0xf
    v_add_f32_dpp v211, v211, v214 wave_ror:1 row_mask:0xf bank_mask:0xf
    v_add_f32_dpp v211, v215, v214 wave_shr:1 row_mask:0xf bank_mask:0xf
    v_add_f32_dpp v215, v215, v218 wave_ror:1 row_mask:0xf bank_mask:0xf
    v_mfma_f32_32x32x16_bf16 v[240:255], v[36:39], a[152:155], v[240:255]
    v_add_f32_dpp v215, v219, v218 wave_shr:1 row_mask:0xf bank_mask:0xf
    v_add_f32_dpp v219, v219, v222 wave_ror:1 row_mask:0xf bank_mask:0xf
    v_add_f32_dpp v219, v223, v222 wave_shr:1 row_mask:0xf bank_mask:0xf
    s_nop 0
    v_add_f32_dpp v210, v203, v209 wave_ror:1 row_mask:0xf bank_mask:0xf
    s_waitcnt lgkmcnt(9)
    v_mfma_f32_32x32x16_bf16 v[224:239], v[40:43], a[132:135], v[224:239]
    v_add_f32_dpp v210, v207, v209 wave_shr:1 row_mask:0xf bank_mask:0xf
    v_add_f32_dpp v214, v207, v213 wave_ror:1 row_mask:0xf bank_mask:0xf
    v_add_f32_dpp v214, v211, v213 wave_shr:1 row_mask:0xf bank_mask:0xf
    v_add_f32_dpp v218, v211, v217 wave_ror:1 row_mask:0xf bank_mask:0xf
    v_add_f32_dpp v218, v215, v217 wave_shr:1 row_mask:0xf bank_mask:0xf
    v_mfma_f32_32x32x16_bf16 v[240:255], v[40:43], a[148:151], v[240:255]
    v_add_f32_dpp v222, v215, v221 wave_ror:1 row_mask:0xf bank_mask:0xf
    v_add_f32_dpp v222, v219, v221 wave_shr:1 row_mask:0xf bank_mask:0xf
    s_nop 0
    v_add_f32_dpp v209, v206, v208 wave_ror:1 row_mask:0xf bank_mask:0xf
    v_add_f32_dpp v209, v210, v208 wave_shr:1 row_mask:0xf bank_mask:0xf
    buffer_load_dwordx4 v16, s[16:19], s69 offen offset:1024 sc1 lds
    s_add_u32 s69, s69, 8192
    s_waitcnt lgkmcnt(8)
    v_mfma_f32_32x32x16_bf16 v[224:239], v[44:47], a[128:131], v[224:239]
    v_add_f32_dpp v213, v210, v212 wave_ror:1 row_mask:0xf bank_mask:0xf
    v_add_f32_dpp v213, v214, v212 wave_shr:1 row_mask:0xf bank_mask:0xf
    v_add_f32_dpp v217, v214, v216 wave_ror:1 row_mask:0xf bank_mask:0xf
    v_add_f32_dpp v217, v218, v216 wave_shr:1 row_mask:0xf bank_mask:0xf
    v_add_f32_dpp v221, v218, v220 wave_ror:1 row_mask:0xf bank_mask:0xf
    v_mfma_f32_32x32x16_bf16 v[240:255], v[44:47], a[144:147], v[240:255]
    v_add_f32_dpp v221, v222, v220 wave_shr:1 row_mask:0xf bank_mask:0xf
    v_cvt_pk_bf16_f32 v208, v209, v213
    ds_write_b16 v97, v208 offset:10240
    ds_write_b16_d16_hi v97, v208 offset:10752
    v_cvt_pk_bf16_f32 v216, v217, v221
    s_waitcnt lgkmcnt(9)
    v_mfma_f32_32x32x16_bf16 v[240:255], v[48:51], a[140:143], v[240:255]
    ds_write_b16 v97, v216 offset:11264
    ds_write_b16_d16_hi v97, v216 offset:11776
    s_waitcnt lgkmcnt(10)
    v_mfma_f32_32x32x16_bf16 v[240:255], v[52:55], a[136:139], v[240:255]
    v_add_f32_dpp v223, v223, v226 wave_ror:1 row_mask:0xf bank_mask:0xf
    v_add_f32_dpp v223, v227, v226 wave_shr:1 row_mask:0xf bank_mask:0xf
    v_add_f32_dpp v227, v227, v230 wave_ror:1 row_mask:0xf bank_mask:0xf
    v_add_f32_dpp v227, v231, v230 wave_shr:1 row_mask:0xf bank_mask:0xf
    v_add_f32_dpp v231, v231, v234 wave_ror:1 row_mask:0xf bank_mask:0xf
    s_waitcnt lgkmcnt(9)
    v_mfma_f32_32x32x16_bf16 v[240:255], v[56:59], a[132:135], v[240:255]
    v_add_f32_dpp v231, v235, v234 wave_shr:1 row_mask:0xf bank_mask:0xf
    v_add_f32_dpp v235, v235, v238 wave_ror:1 row_mask:0xf bank_mask:0xf
    v_add_f32_dpp v235, v239, v238 wave_shr:1 row_mask:0xf bank_mask:0xf
    s_nop 0
    v_add_f32_dpp v226, v219, v225 wave_ror:1 row_mask:0xf bank_mask:0xf
    s_waitcnt lgkmcnt(4)
    v_mfma_f32_32x32x16_bf16 v[240:255], v[60:63], a[128:131], v[240:255]
    v_add_f32_dpp v226, v223, v225 wave_shr:1 row_mask:0xf bank_mask:0xf
    v_add_f32_dpp v230, v223, v229 wave_ror:1 row_mask:0xf bank_mask:0xf
    v_add_f32_dpp v230, v227, v229 wave_shr:1 row_mask:0xf bank_mask:0xf
    v_add_f32_dpp v234, v227, v233 wave_ror:1 row_mask:0xf bank_mask:0xf
    v_add_f32_dpp v234, v231, v233 wave_shr:1 row_mask:0xf bank_mask:0xf
    s_nop 7
    s_nop 3
    v_add_f32_dpp v238, v231, v237 wave_ror:1 row_mask:0xf bank_mask:0xf
    v_add_f32_dpp v238, v235, v237 wave_shr:1 row_mask:0xf bank_mask:0xf
    s_nop 0
    v_add_f32_dpp v225, v222, v224 wave_ror:1 row_mask:0xf bank_mask:0xf
    v_add_f32_dpp v225, v226, v224 wave_shr:1 row_mask:0xf bank_mask:0xf
    v_add_f32_dpp v229, v226, v228 wave_ror:1 row_mask:0xf bank_mask:0xf
    v_add_f32_dpp v229, v230, v228 wave_shr:1 row_mask:0xf bank_mask:0xf
    v_add_f32_dpp v233, v230, v232 wave_ror:1 row_mask:0xf bank_mask:0xf
    v_add_f32_dpp v233, v234, v232 wave_shr:1 row_mask:0xf bank_mask:0xf
    v_add_f32_dpp v237, v234, v236 wave_ror:1 row_mask:0xf bank_mask:0xf
    v_add_f32_dpp v237, v238, v236 wave_shr:1 row_mask:0xf bank_mask:0xf
    v_cvt_pk_bf16_f32 v224, v225, v229
    ds_write_b16 v97, v224 offset:12288
    ds_write_b16_d16_hi v97, v224 offset:12800
    v_cvt_pk_bf16_f32 v232, v233, v237
    ds_write_b16 v97, v232 offset:13312
    ds_write_b16_d16_hi v97, v232 offset:13824
    v_add_f32_dpp v239, v239, v242 wave_ror:1 row_mask:0xf bank_mask:0xf
    v_add_f32_dpp v239, v243, v242 wave_shr:1 row_mask:0xf bank_mask:0xf
    v_add_f32_dpp v243, v243, v246 wave_ror:1 row_mask:0xf bank_mask:0xf
    v_add_f32_dpp v243, v247, v246 wave_shr:1 row_mask:0xf bank_mask:0xf
    v_add_f32_dpp v247, v247, v250 wave_ror:1 row_mask:0xf bank_mask:0xf
    v_add_f32_dpp v247, v251, v250 wave_shr:1 row_mask:0xf bank_mask:0xf
    v_add_f32_dpp v251, v251, v254 wave_ror:1 row_mask:0xf bank_mask:0xf
    v_add_f32_dpp v251, v255, v254 wave_shr:1 row_mask:0xf bank_mask:0xf
    s_nop 0
    v_add_f32_dpp v242, v235, v241 wave_ror:1 row_mask:0xf bank_mask:0xf
    v_add_f32_dpp v242, v239, v241 wave_shr:1 row_mask:0xf bank_mask:0xf
    v_add_f32_dpp v246, v239, v245 wave_ror:1 row_mask:0xf bank_mask:0xf
    v_add_f32_dpp v246, v243, v245 wave_shr:1 row_mask:0xf bank_mask:0xf
    v_add_f32_dpp v250, v243, v249 wave_ror:1 row_mask:0xf bank_mask:0xf
    v_add_f32_dpp v250, v247, v249 wave_shr:1 row_mask:0xf bank_mask:0xf
    v_add_f32_dpp v254, v247, v253 wave_ror:1 row_mask:0xf bank_mask:0xf
    v_add_f32_dpp v254, v251, v253 wave_shr:1 row_mask:0xf bank_mask:0xf
    s_nop 0
    v_add_f32_dpp v241, v238, v240 wave_ror:1 row_mask:0xf bank_mask:0xf
    v_add_f32_dpp v241, v242, v240 wave_shr:1 row_mask:0xf bank_mask:0xf
    v_add_f32_dpp v245, v242, v244 wave_ror:1 row_mask:0xf bank_mask:0xf
    v_add_f32_dpp v245, v246, v244 wave_shr:1 row_mask:0xf bank_mask:0xf
    v_add_f32_dpp v249, v246, v248 wave_ror:1 row_mask:0xf bank_mask:0xf
    v_add_f32_dpp v249, v250, v248 wave_shr:1 row_mask:0xf bank_mask:0xf
    v_add_f32_dpp v253, v250, v252 wave_ror:1 row_mask:0xf bank_mask:0xf
    v_add_f32_dpp v253, v254, v252 wave_shr:1 row_mask:0xf bank_mask:0xf
    v_cvt_pk_bf16_f32 v240, v241, v245
    ds_write_b16 v97, v240 offset:14336
    ds_write_b16_d16_hi v97, v240 offset:14848
    v_cvt_pk_bf16_f32 v248, v249, v253
    ds_write_b16 v97, v248 offset:15360
    ds_write_b16_d16_hi v97, v248 offset:15872
L_convend:
    s_waitcnt vmcnt(6) lgkmcnt(0)
    s_barrier
    v_lshlrev_b32 v98, 4, v1
    s_lshl_b32 s76, s66, 12
    v_add_u32 v98, s76, v98
    v_add_u32 v99, 98304, v98
    s_lshl_b32 s86, s65, 4
    s_add_u32 s86, s86, s64
    s_lshl_b32 s86, s86, 14
    s_add_u32 s86, s86, 20971520
    ds_read_b128 v[132:135], v99 offset:0
    ds_read_b128 v[136:139], v99 offset:1024
    ds_read_b128 v[140:143], v99 offset:2048
    ds_read_b128 v[144:147], v99 offset:3072
    ds_read_b128 v[48:51], v2 offset:0
    ds_read_b64_tr_b16 v[80:81], v8 offset:0
    ds_read_b64_tr_b16 v[82:83], v8 offset:4096
    ds_read_b128 v[52:55], v2 offset:1024
    ds_read_b128 v[56:59], v4 offset:0
    ds_read_b128 v[60:63], v4 offset:1024
    ds_read_b64_tr_b16 v[84:85], v9 offset:0
    ds_read_b64_tr_b16 v[86:87], v9 offset:4096
    ds_read_b64_tr_b16 v[88:89], v10 offset:0
    ds_read_b64_tr_b16 v[90:91], v10 offset:4096
    ds_read_b64_tr_b16 v[92:93], v11 offset:0
    ds_read_b64_tr_b16 v[94:95], v11 offset:4096
    s_waitcnt lgkmcnt(12)
    buffer_store_dwordx4 v[132:135], v98, s[12:15], s86 offen offset:0 sc1
    buffer_store_dwordx4 v[136:139], v98, s[12:15], s86 offen offset:1024 sc1
    buffer_store_dwordx4 v[140:143], v98, s[12:15], s86 offen offset:2048 sc1
    buffer_store_dwordx4 v[144:147], v98, s[12:15], s86 offen offset:3072 sc1
    v_lshlrev_b32 v114, 3, v1
    s_lshl_b32 s82, s101, 8
    s_add_u32 s82, s82, 34615296
    v_add_u32 v114, s82, v114
    s_mov_b32 s57, 0
L_g2loop:
    s_waitcnt vmcnt(12) lgkmcnt(0)
    s_barrier
    v_mfma_f32_16x16x32_bf16 a[0:3], v[80:83], v[48:51], a[0:3]
    ds_read_b128 v[32:35], v2 offset:16384
    ds_read_b64_tr_b16 v[64:65], v8 offset:16384
    s_add_u32 m0, s73, 98304
    v_mfma_f32_16x16x32_bf16 a[4:7], v[80:83], v[52:55], a[4:7]
    ds_read_b64_tr_b16 v[66:67], v8 offset:20480
    ds_read_b128 v[36:39], v2 offset:17408
    buffer_load_dwordx4 v16, s[16:19], s69 offen sc1 lds
    v_mfma_f32_16x16x32_bf16 a[8:11], v[80:83], v[56:59], a[8:11]
    ds_read_b128 v[40:43], v4 offset:16384
    v_mfma_f32_16x16x32_bf16 a[12:15], v[80:83], v[60:63], a[12:15]
    ds_read_b128 v[44:47], v4 offset:17408
    v_mfma_f32_16x16x32_bf16 a[16:19], v[84:87], v[48:51], a[16:19]
    ds_read_b64_tr_b16 v[68:69], v9 offset:16384
    v_mfma_f32_16x16x32_bf16 a[20:23], v[84:87], v[52:55], a[20:23]
    ds_read_b64_tr_b16 v[70:71], v9 offset:20480
    buffer_load_dwordx4 v16, s[16:19], s69 offen offset:1024 sc1 lds
    v_mfma_f32_16x16x32_bf16 a[24:27], v[84:87], v[56:59], a[24:27]
    ds_read_b64_tr_b16 v[72:73], v10 offset:16384
    s_cmp_ge_u32 s72, s74
    s_addc_u32 s78, s72, 0
    v_mfma_f32_16x16x32_bf16 a[28:31], v[84:87], v[60:63], a[28:31]
    ds_read_b64_tr_b16 v[74:75], v10 offset:20480
    s_lshl_b32 s79, s100, 3
    v_mfma_f32_16x16x32_bf16 a[32:35], v[88:91], v[48:51], a[32:35]
    ds_read_b64_tr_b16 v[76:77], v11 offset:16384
    s_add_u32 s78, s78, s79
    s_add_u32 m0, s73, 106496
    v_mfma_f32_16x16x32_bf16 a[36:39], v[88:91], v[52:55], a[36:39]
    ds_read_b64_tr_b16 v[78:79], v11 offset:20480
    s_add_u32 s72, s72, 1
    buffer_load_dwordx4 v122, s[40:43], s70 offen lds
    v_mfma_f32_16x16x32_bf16 a[40:43], v[88:91], v[56:59], a[40:43]
    s_lshl_b32 s79, s64, 4
    v_mfma_f32_16x16x32_bf16 a[44:47], v[88:91], v[60:63], a[44:47]
    s_add_u32 s78, s78, s79
    v_mfma_f32_16x16x32_bf16 a[48:51], v[92:95], v[48:51], a[48:51]
    s_mul_i32 s69, s78, 57344
    v_mfma_f32_16x16x32_bf16 a[52:55], v[92:95], v[52:55], a[52:55]
    s_add_u32 s69, s69, 0
    buffer_load_dwordx4 v123, s[40:43], s70 offen offset:1024 lds
    v_mfma_f32_16x16x32_bf16 a[56:59], v[92:95], v[56:59], a[56:59]
    s_cmp_ge_u32 s71, s74
    s_addc_u32 s76, s71, 0
    s_lshl_b32 s77, s100, 3
    s_add_u32 s76, s76, s77
    s_add_u32 s71, s71, 1
    v_mfma_f32_16x16x32_bf16 a[60:63], v[92:95], v[60:63], a[60:63]
    s_mul_i32 s70, s76, 458752
    s_waitcnt lgkmcnt(0)
    v_mfma_f32_16x16x32_bf16 a[0:3], v[64:67], v[32:35], a[0:3]
    ds_read_b128 v[48:51], v2 offset:32768
    ds_read_b64_tr_b16 v[80:81], v8 offset:32768
    s_add_u32 m0, s73, 0
    v_mfma_f32_16x16x32_bf16 a[4:7], v[64:67], v[36:39], a[4:7]
    ds_read_b64_tr_b16 v[82:83], v8 offset:36864
    ds_read_b128 v[52:55], v2 offset:33792
    buffer_load_dwordx4 v16, s[16:19], s69 offen sc1 lds
    v_mfma_f32_16x16x32_bf16 a[8:11], v[64:67], v[40:43], a[8:11]
    ds_read_b128 v[56:59], v4 offset:32768
    v_mfma_f32_16x16x32_bf16 a[12:15], v[64:67], v[44:47], a[12:15]
    ds_read_b128 v[60:63], v4 offset:33792
    v_mfma_f32_16x16x32_bf16 a[16:19], v[68:71], v[32:35], a[16:19]
    ds_read_b64_tr_b16 v[84:85], v9 offset:32768
    v_mfma_f32_16x16x32_bf16 a[20:23], v[68:71], v[36:39], a[20:23]
    ds_read_b64_tr_b16 v[86:87], v9 offset:36864
    buffer_load_dwordx4 v16, s[16:19], s69 offen offset:1024 sc1 lds
    v_mfma_f32_16x16x32_bf16 a[24:27], v[68:71], v[40:43], a[24:27]
    ds_read_b64_tr_b16 v[88:89], v10 offset:32768
    s_add_u32 s69, s69, 8192
    v_mfma_f32_16x16x32_bf16 a[28:31], v[68:71], v[44:47], a[28:31]
    ds_read_b64_tr_b16 v[90:91], v10 offset:36864
    v_mfma_f32_16x16x32_bf16 a[32:35], v[72:75], v[32:35], a[32:35]
    ds_read_b64_tr_b16 v[92:93], v11 offset:32768
    s_add_u32 m0, s73, 8192
    v_mfma_f32_16x16x32_bf16 a[36:39], v[72:75], v[36:39], a[36:39]
    ds_read_b64_tr_b16 v[94:95], v11 offset:36864
    buffer_load_dwordx4 v122, s[40:43], s70 offen lds
    v_mfma_f32_16x16x32_bf16 a[40:43], v[72:75], v[40:43], a[40:43]
    v_mfma_f32_16x16x32_bf16 a[44:47], v[72:75], v[44:47], a[44:47]
    v_mfma_f32_16x16x32_bf16 a[48:51], v[76:79], v[32:35], a[48:51]
    v_mfma_f32_16x16x32_bf16 a[52:55], v[76:79], v[36:39], a[52:55]
    buffer_load_dwordx4 v123, s[40:43], s70 offen offset:1024 lds
    v_mfma_f32_16x16x32_bf16 a[56:59], v[76:79], v[40:43], a[56:59]
    s_add_u32 s70, s70, 65536
    v_mfma_f32_16x16x32_bf16 a[60:63], v[76:79], v[44:47], a[60:63]
    s_waitcnt vmcnt(12) lgkmcnt(0)
    s_barrier
    v_mfma_f32_16x16x32_bf16 a[0:3], v[80:83], v[48:51], a[0:3]
    ds_read_b64 v[32:33], v6 offset:49152
    ds_read_b64 v[34:35], v6 offset:49664
    s_add_u32 m0, s73, 16384
    v_mfma_f32_16x16x32_bf16 a[4:7], v[80:83], v[52:55], a[4:7]
    ds_read_b64_tr_b16 v[64:65], v8 offset:49152
    ds_read_b64_tr_b16 v[66:67], v8 offset:53248
    buffer_load_dwordx4 v16, s[16:19], s69 offen sc1 lds
    v_mfma_f32_16x16x32_bf16 a[8:11], v[80:83], v[56:59], a[8:11]
    ds_read_b64 v[36:37], v6 offset:50176
    ds_read_b64 v[38:39], v6 offset:50688
    v_mfma_f32_16x16x32_bf16 a[12:15], v[80:83], v[60:63], a[12:15]
    ds_read_b64 v[40:41], v7 offset:49152
    ds_read_b64 v[42:43], v7 offset:49664
    v_mfma_f32_16x16x32_bf16 a[16:19], v[84:87], v[48:51], a[16:19]
    ds_read_b64 v[44:45], v7 offset:50176
    v_mfma_f32_16x16x32_bf16 a[20:23], v[84:87], v[52:55], a[20:23]
    ds_read_b64 v[46:47], v7 offset:50688
    buffer_load_dwordx4 v16, s[16:19], s69 offen offset:1024 sc1 lds
    v_mfma_f32_16x16x32_bf16 a[24:27], v[84:87], v[56:59], a[24:27]
    ds_read_b64_tr_b16 v[68:69], v9 offset:49152
    s_add_u32 s69, s69, 8192
    v_mfma_f32_16x16x32_bf16 a[28:31], v[84:87], v[60:63], a[28:31]
    ds_read_b64_tr_b16 v[70:71], v9 offset:53248
    v_mfma_f32_16x16x32_bf16 a[32:35], v[88:91], v[48:51], a[32:35]
    ds_read_b64_tr_b16 v[72:73], v10 offset:49152
    s_add_u32 m0, s73, 24576
    v_mfma_f32_16x16x32_bf16 a[36:39], v[88:91], v[52:55], a[36:39]
    ds_read_b64_tr_b16 v[74:75], v10 offset:53248
    buffer_load_dwordx4 v122, s[40:43], s70 offen lds
    v_mfma_f32_16x16x32_bf16 a[40:43], v[88:91], v[56:59], a[40:43]
    ds_read_b64_tr_b16 v[76:77], v11 offset:49152
    v_mfma_f32_16x16x32_bf16 a[44:47], v[88:91], v[60:63], a[44:47]
    ds_read_b64_tr_b16 v[78:79], v11 offset:53248
    v_mfma_f32_16x16x32_bf16 a[48:51], v[92:95], v[48:51], a[48:51]
    v_mfma_f32_16x16x32_bf16 a[52:55], v[92:95], v[52:55], a[52:55]
    buffer_load_dwordx4 v123, s[40:43], s70 offen offset:1024 lds
    v_mfma_f32_16x16x32_bf16 a[56:59], v[92:95], v[56:59], a[56:59]
    s_add_u32 s70, s70, 65536
    v_mfma_f32_16x16x32_bf16 a[60:63], v[92:95], v[60:63], a[60:63]
    s_waitcnt lgkmcnt(0)
    v_mfma_f32_16x16x32_bf16 a[0:3], v[64:67], v[32:35], a[0:3]
    ds_read_b128 v[48:51], v3 offset:0
    ds_read_b64_tr_b16 v[80:81], v12 offset:0
    s_add_u32 m0, s73, 32768
    v_mfma_f32_16x16x32_bf16 a[4:7], v[64:67], v[36:39], a[4:7]
    ds_read_b64_tr_b16 v[82:83], v12 offset:4096
    ds_read_b128 v[52:55], v3 offset:1024
    buffer_load_dwordx4 v16, s[16:19], s69 offen sc1 lds
    v_mfma_f32_16x16x32_bf16 a[8:11], v[64:67], v[40:43], a[8:11]
    ds_read_b128 v[56:59], v5 offset:0
    v_mfma_f32_16x16x32_bf16 a[12:15], v[64:67], v[44:47], a[12:15]
    ds_read_b128 v[60:63], v5 offset:1024
    v_mfma_f32_16x16x32_bf16 a[16:19], v[68:71], v[32:35], a[16:19]
    ds_read_b64_tr_b16 v[84:85], v13 offset:0
    v_mfma_f32_16x16x32_bf16 a[20:23], v[68:71], v[36:39], a[20:23]
    ds_read_b64_tr_b16 v[86:87], v13 offset:4096
    buffer_load_dwordx4 v16, s[16:19], s69 offen offset:1024 sc1 lds
    v_mfma_f32_16x16x32_bf16 a[24:27], v[68:71], v[40:43], a[24:27]
    ds_read_b64_tr_b16 v[88:89], v14 offset:0
    s_add_u32 s69, s69, 8192
    v_mfma_f32_16x16x32_bf16 a[28:31], v[68:71], v[44:47], a[28:31]
    ds_read_b64_tr_b16 v[90:91], v14 offset:4096
    v_mfma_f32_16x16x32_bf16 a[32:35], v[72:75], v[32:35], a[32:35]
    ds_read_b64_tr_b16 v[92:93], v15 offset:0
    s_add_u32 m0, s73, 40960
    v_mfma_f32_16x16x32_bf16 a[36:39], v[72:75], v[36:39], a[36:39]
    ds_read_b64_tr_b16 v[94:95], v15 offset:4096
    buffer_load_dwordx4 v122, s[40:43], s70 offen lds
    v_mfma_f32_16x16x32_bf16 a[40:43], v[72:75], v[40:43], a[40:43]
    v_mfma_f32_16x16x32_bf16 a[44:47], v[72:75], v[44:47], a[44:47]
    v_mfma_f32_16x16x32_bf16 a[48:51], v[76:79], v[32:35], a[48:51]
    v_mfma_f32_16x16x32_bf16 a[52:55], v[76:79], v[36:39], a[52:55]
    buffer_load_dwordx4 v123, s[40:43], s70 offen offset:1024 lds
    v_mfma_f32_16x16x32_bf16 a[56:59], v[76:79], v[40:43], a[56:59]
    s_add_u32 s70, s70, 65536
    v_mfma_f32_16x16x32_bf16 a[60:63], v[76:79], v[44:47], a[60:63]
    s_waitcnt vmcnt(12) lgkmcnt(0)
    s_barrier
    v_mfma_f32_16x16x32_bf16 a[0:3], v[80:83], v[48:51], a[0:3]
    ds_read_b128 v[32:35], v3 offset:16384
    ds_read_b64_tr_b16 v[64:65], v12 offset:16384
    s_add_u32 m0, s73, 49152
    v_mfma_f32_16x16x32_bf16 a[4:7], v[80:83], v[52:55], a[4:7]
    ds_read_b64_tr_b16 v[66:67], v12 offset:20480
    ds_read_b128 v[36:39], v3 offset:17408
    buffer_load_dwordx4 v16, s[16:19], s69 offen sc1 lds
    v_mfma_f32_16x16x32_bf16 a[8:11], v[80:83], v[56:59], a[8:11]
    ds_read_b128 v[40:43], v5 offset:16384
    v_mfma_f32_16x16x32_bf16 a[12:15], v[80:83], v[60:63], a[12:15]
    ds_read_b128 v[44:47], v5 offset:17408
    v_mfma_f32_16x16x32_bf16 a[16:19], v[84:87], v[48:51], a[16:19]
    ds_read_b64_tr_b16 v[68:69], v13 offset:16384
    v_mfma_f32_16x16x32_bf16 a[20:23], v[84:87], v[52:55], a[20:23]
    ds_read_b64_tr_b16 v[70:71], v13 offset:20480
    buffer_load_dwordx4 v16, s[16:19], s69 offen offset:1024 sc1 lds
    v_mfma_f32_16x16x32_bf16 a[24:27], v[84:87], v[56:59], a[24:27]
    ds_read_b64_tr_b16 v[72:73], v14 offset:16384
    s_add_u32 s69, s69, 8192
    v_mfma_f32_16x16x32_bf16 a[28:31], v[84:87], v[60:63], a[28:31]
    ds_read_b64_tr_b16 v[74:75], v14 offset:20480
    v_mfma_f32_16x16x32_bf16 a[32:35], v[88:91], v[48:51], a[32:35]
    ds_read_b64_tr_b16 v[76:77], v15 offset:16384
    s_add_u32 m0, s73, 57344
    v_mfma_f32_16x16x32_bf16 a[36:39], v[88:91], v[52:55], a[36:39]
    ds_read_b64_tr_b16 v[78:79], v15 offset:20480
    buffer_load_dwordx4 v122, s[40:43], s70 offen lds
    v_mfma_f32_16x16x32_bf16 a[40:43], v[88:91], v[56:59], a[40:43]
    v_mfma_f32_16x16x32_bf16 a[44:47], v[88:91], v[60:63], a[44:47]
    v_mfma_f32_16x16x32_bf16 a[48:51], v[92:95], v[48:51], a[48:51]
    v_mfma_f32_16x16x32_bf16 a[52:55], v[92:95], v[52:55], a[52:55]
    buffer_load_dwordx4 v123, s[40:43], s70 offen offset:1024 lds
    v_mfma_f32_16x16x32_bf16 a[56:59], v[92:95], v[56:59], a[56:59]
    s_add_u32 s70, s70, 65536
    v_mfma_f32_16x16x32_bf16 a[60:63], v[92:95], v[60:63], a[60:63]
    s_waitcnt lgkmcnt(0)
    v_mfma_f32_16x16x32_bf16 a[0:3], v[64:67], v[32:35], a[0:3]
    ds_read_b128 v[48:51], v3 offset:32768
    ds_read_b64_tr_b16 v[80:81], v12 offset:32768
    s_add_u32 m0, s73, 65536
    v_mfma_f32_16x16x32_bf16 a[4:7], v[64:67], v[36:39], a[4:7]
    ds_read_b64_tr_b16 v[82:83], v12 offset:36864
    ds_read_b128 v[52:55], v3 offset:33792
    buffer_load_dwordx4 v16, s[16:19], s69 offen sc1 lds
    v_mfma_f32_16x16x32_bf16 a[8:11], v[64:67], v[40:43], a[8:11]
    ds_read_b128 v[56:59], v5 offset:32768
    v_mfma_f32_16x16x32_bf16 a[12:15], v[64:67], v[44:47], a[12:15]
    ds_read_b128 v[60:63], v5 offset:33792
    v_mfma_f32_16x16x32_bf16 a[16:19], v[68:71], v[32:35], a[16:19]
    ds_read_b64_tr_b16 v[84:85], v13 offset:32768
    v_mfma_f32_16x16x32_bf16 a[20:23], v[68:71], v[36:39], a[20:23]
    ds_read_b64_tr_b16 v[86:87], v13 offset:36864
    buffer_load_dwordx4 v16, s[16:19], s69 offen offset:1024 sc1 lds
    v_mfma_f32_16x16x32_bf16 a[24:27], v[68:71], v[40:43], a[24:27]
    ds_read_b64_tr_b16 v[88:89], v14 offset:32768
    s_add_u32 s69, s69, 8192
    v_mfma_f32_16x16x32_bf16 a[28:31], v[68:71], v[44:47], a[28:31]
    ds_read_b64_tr_b16 v[90:91], v14 offset:36864
    v_mfma_f32_16x16x32_bf16 a[32:35], v[72:75], v[32:35], a[32:35]
    ds_read_b64_tr_b16 v[92:93], v15 offset:32768
    s_add_u32 m0, s73, 73728
    v_mfma_f32_16x16x32_bf16 a[36:39], v[72:75], v[36:39], a[36:39]
    ds_read_b64_tr_b16 v[94:95], v15 offset:36864
    buffer_load_dwordx4 v122, s[40:43], s70 offen lds
    v_mfma_f32_16x16x32_bf16 a[40:43], v[72:75], v[40:43], a[40:43]
    v_mfma_f32_16x16x32_bf16 a[44:47], v[72:75], v[44:47], a[44:47]
    v_mfma_f32_16x16x32_bf16 a[48:51], v[76:79], v[32:35], a[48:51]
    v_mfma_f32_16x16x32_bf16 a[52:55], v[76:79], v[36:39], a[52:55]
    buffer_load_dwordx4 v123, s[40:43], s70 offen offset:1024 lds
    v_mfma_f32_16x16x32_bf16 a[56:59], v[76:79], v[40:43], a[56:59]
    s_add_u32 s70, s70, 65536
    v_mfma_f32_16x16x32_bf16 a[60:63], v[76:79], v[44:47], a[60:63]
    s_waitcnt vmcnt(12) lgkmcnt(0)
    s_barrier
    v_mfma_f32_16x16x32_bf16 a[0:3], v[80:83], v[48:51], a[0:3]
    ds_read_b128 v[32:35], v2 offset:0
    ds_read_b64_tr_b16 v[64:65], v8 offset:0
    s_add_u32 m0, s73, 81920
    v_mfma_f32_16x16x32_bf16 a[4:7], v[80:83], v[52:55], a[4:7]
    ds_read_b64_tr_b16 v[66:67], v8 offset:4096
    ds_read_b128 v[36:39], v2 offset:1024
    buffer_load_dwordx4 v16, s[16:19], s69 offen sc1 lds
    v_mfma_f32_16x16x32_bf16 a[8:11], v[80:83], v[56:59], a[8:11]
    ds_read_b128 v[40:43], v4 offset:0
    v_mfma_f32_16x16x32_bf16 a[12:15], v[80:83], v[60:63], a[12:15]
    ds_read_b128 v[44:47], v4 offset:1024
    v_mfma_f32_16x16x32_bf16 a[16:19], v[84:87], v[48:51], a[16:19]
    ds_read_b64_tr_b16 v[68:69], v9 offset:0
    v_mfma_f32_16x16x32_bf16 a[20:23], v[84:87], v[52:55], a[20:23]
    ds_read_b64_tr_b16 v[70:71], v9 offset:4096
    buffer_load_dwordx4 v16, s[16:19], s69 offen offset:1024 sc1 lds
    v_mfma_f32_16x16x32_bf16 a[24:27], v[84:87], v[56:59], a[24:27]
    ds_read_b64_tr_b16 v[72:73], v10 offset:0
    s_add_u32 s69, s69, 8192
    v_mfma_f32_16x16x32_bf16 a[28:31], v[84:87], v[60:63], a[28:31]
    ds_read_b64_tr_b16 v[74:75], v10 offset:4096
    v_mfma_f32_16x16x32_bf16 a[32:35], v[88:91], v[48:51], a[32:35]
    ds_read_b64_tr_b16 v[76:77], v11 offset:0
    s_add_u32 m0, s73, 90112
    v_mfma_f32_16x16x32_bf16 a[36:39], v[88:91], v[52:55], a[36:39]
    ds_read_b64_tr_b16 v[78:79], v11 offset:4096
    buffer_load_dwordx4 v122, s[40:43], s70 offen lds
    v_mfma_f32_16x16x32_bf16 a[40:43], v[88:91], v[56:59], a[40:43]
    v_mfma_f32_16x16x32_bf16 a[44:47], v[88:91], v[60:63], a[44:47]
    v_mfma_f32_16x16x32_bf16 a[48:51], v[92:95], v[48:51], a[48:51]
    v_mfma_f32_16x16x32_bf16 a[52:55], v[92:95], v[52:55], a[52:55]
    buffer_load_dwordx4 v123, s[40:43], s70 offen offset:1024 lds
    v_mfma_f32_16x16x32_bf16 a[56:59], v[92:95], v[56:59], a[56:59]
    s_add_u32 s70, s70, 65536
    v_mfma_f32_16x16x32_bf16 a[60:63], v[92:95], v[60:63], a[60:63]
    s_waitcnt lgkmcnt(0)
    s_cmp_eq_u32 s57, 2
    s_cbranch_scc0 L_noFY
    buffer_load_dwordx2 v[26:27], v114, s[12:15], 0 offen sc1
L_noFY:
    v_mfma_f32_16x16x32_bf16 a[0:3], v[64:67], v[32:35], a[0:3]
    ds_read_b128 v[48:51], v2 offset:16384
    ds_read_b64_tr_b16 v[80:81], v8 offset:16384
    s_add_u32 m0, s73, 98304
    v_mfma_f32_16x16x32_bf16 a[4:7], v[64:67], v[36:39], a[4:7]
    ds_read_b64_tr_b16 v[82:83], v8 offset:20480
    ds_read_b128 v[52:55], v2 offset:17408
    buffer_load_dwordx4 v16, s[16:19], s69 offen sc1 lds
    v_mfma_f32_16x16x32_bf16 a[8:11], v[64:67], v[40:43], a[8:11]
    ds_read_b128 v[56:59], v4 offset:16384
    v_mfma_f32_16x16x32_bf16 a[12:15], v[64:67], v[44:47], a[12:15]
    ds_read_b128 v[60:63], v4 offset:17408
    v_mfma_f32_16x16x32_bf16 a[16:19], v[68:71], v[32:35], a[16:19]
    ds_read_b64_tr_b16 v[84:85], v9 offset:16384
    v_mfma_f32_16x16x32_bf16 a[20:23], v[68:71], v[36:39], a[20:23]
    ds_read_b64_tr_b16 v[86:87], v9 offset:20480
    buffer_load_dwordx4 v16, s[16:19], s69 offen offset:1024 sc1 lds
    v_mfma_f32_16x16x32_bf16 a[24:27], v[68:71], v[40:43], a[24:27]
    ds_read_b64_tr_b16 v[88:89], v10 offset:16384
    s_cmp_ge_u32 s72, s74
    s_addc_u32 s78, s72, 0
    v_mfma_f32_16x16x32_bf16 a[28:31], v[68:71], v[44:47], a[28:31]
    ds_read_b64_tr_b16 v[90:91], v10 offset:20480
    s_lshl_b32 s79, s100, 3
    v_mfma_f32_16x16x32_bf16 a[32:35], v[72:75], v[32:35], a[32:35]
    ds_read_b64_tr_b16 v[92:93], v11 offset:16384
    s_add_u32 s78, s78, s79
    s_add_u32 m0, s73, 106496
    v_mfma_f32_16x16x32_bf16 a[36:39], v[72:75], v[36:39], a[36:39]
    ds_read_b64_tr_b16 v[94:95], v11 offset:20480
    s_add_u32 s72, s72, 1
    buffer_load_dwordx4 v122, s[40:43], s70 offen lds
    v_mfma_f32_16x16x32_bf16 a[40:43], v[72:75], v[40:43], a[40:43]
    s_lshl_b32 s79, s64, 4
    v_mfma_f32_16x16x32_bf16 a[44:47], v[72:75], v[44:47], a[44:47]
    s_add_u32 s78, s78, s79
    v_mfma_f32_16x16x32_bf16 a[48:51], v[76:79], v[32:35], a[48:51]
    s_mul_i32 s69, s78, 57344
    v_mfma_f32_16x16x32_bf16 a[52:55], v[76:79], v[36:39], a[52:55]
    s_add_u32 s69, s69, 0
    buffer_load_dwordx4 v123, s[40:43], s70 offen offset:1024 lds
    v_mfma_f32_16x16x32_bf16 a[56:59], v[76:79], v[40:43], a[56:59]
    s_cmp_ge_u32 s71, s74
    s_addc_u32 s76, s71, 0
    s_lshl_b32 s77, s100, 3
    s_add_u32 s76, s76, s77
    s_add_u32 s71, s71, 1
    v_mfma_f32_16x16x32_bf16 a[60:63], v[76:79], v[44:47], a[60:63]
    s_mul_i32 s70, s76, 458752
    s_waitcnt vmcnt(12) lgkmcnt(0)
    s_barrier
    s_cmp_eq_u32 s57, 0
    s_cbranch_scc0 L_noPubY
    s_cmp_lg_u32 s66, 0
    s_cbranch_scc1 L_pubY
    s_lshl_b32 s76, s65, 7
    s_lshl_b32 s77, s64, 3
    s_add_u32 s76, s76, s77
    s_add_u32 s76, s76, 34615296
    v_mov_b32 v24, s76
    v_mov_b32 v26, s88
    v_mov_b32 v27, s89
    s_mov_b64 exec, 0x1
    buffer_store_dwordx2 v[26:27], v24, s[12:15], 0 offen sc1
    s_mov_b64 exec, -1
L_pubY:
L_noPubY:
    v_mfma_f32_16x16x32_bf16 a[0:3], v[80:83], v[48:51], a[0:3]
    ds_read_b128 v[32:35], v2 offset:32768
    ds_read_b64_tr_b16 v[64:65], v8 offset:32768
    s_add_u32 m0, s73, 0
    v_mfma_f32_16x16x32_bf16 a[4:7], v[80:83], v[52:55], a[4:7]
    ds_read_b64_tr_b16 v[66:67], v8 offset:36864
    ds_read_b128 v[36:39], v2 offset:33792
    buffer_load_dwordx4 v16, s[16:19], s69 offen sc1 lds
    v_mfma_f32_16x16x32_bf16 a[8:11], v[80:83], v[56:59], a[8:11]
    ds_read_b128 v[40:43], v4 offset:32768
    v_mfma_f32_16x16x32_bf16 a[12:15], v[80:83], v[60:63], a[12:15]
    ds_read_b128 v[44:47], v4 offset:33792
    v_mfma_f32_16x16x32_bf16 a[16:19], v[84:87], v[48:51], a[16:19]
    ds_read_b64_tr_b16 v[68:69], v9 offset:32768
    v_mfma_f32_16x16x32_bf16 a[20:23], v[84:87], v[52:55], a[20:23]
    ds_read_b64_tr_b16 v[70:71], v9 offset:36864
    buffer_load_dwordx4 v16, s[16:19], s69 offen offset:1024 sc1 lds
    v_mfma_f32_16x16x32_bf16 a[24:27], v[84:87], v[56:59], a[24:27]
    ds_read_b64_tr_b16 v[72:73], v10 offset:32768
    s_add_u32 s69, s69, 8192
    v_mfma_f32_16x16x32_bf16 a[28:31], v[84:87], v[60:63], a[28:31]
    ds_read_b64_tr_b16 v[74:75], v10 offset:36864
    v_mfma_f32_16x16x32_bf16 a[32:35], v[88:91], v[48:51], a[32:35]
    ds_read_b64_tr_b16 v[76:77], v11 offset:32768
    s_add_u32 m0, s73, 8192
    v_mfma_f32_16x16x32_bf16 a[36:39], v[88:91], v[52:55], a[36:39]
    ds_read_b64_tr_b16 v[78:79], v11 offset:36864
    buffer_load_dwordx4 v122, s[40:43], s70 offen lds
    v_mfma_f32_16x16x32_bf16 a[40:43], v[88:91], v[56:59], a[40:43]
    v_mfma_f32_16x16x32_bf16 a[44:47], v[88:91], v[60:63], a[44:47]
    v_mfma_f32_16x16x32_bf16 a[48:51], v[92:95], v[48:51], a[48:51]
    v_mfma_f32_16x16x32_bf16 a[52:55], v[92:95], v[52:55], a[52:55]
    buffer_load_dwordx4 v123, s[40:43], s70 offen offset:1024 lds
    v_mfma_f32_16x16x32_bf16 a[56:59], v[92:95], v[56:59], a[56:59]
    s_add_u32 s70, s70, 65536
    v_mfma_f32_16x16x32_bf16 a[60:63], v[92:95], v[60:63], a[60:63]
    s_waitcnt lgkmcnt(0)
    v_mfma_f32_16x16x32_bf16 a[0:3], v[64:67], v[32:35], a[0:3]
    ds_read_b64 v[48:49], v6 offset:49152
    ds_read_b64 v[50:51], v6 offset:49664
    s_add_u32 m0, s73, 16384
    v_mfma_f32_16x16x32_bf16 a[4:7], v[64:67], v[36:39], a[4:7]
    ds_read_b64_tr_b16 v[80:81], v8 offset:49152
    ds_read_b64_tr_b16 v[82:83], v8 offset:53248
    buffer_load_dwordx4 v16, s[16:19], s69 offen sc1 lds
    v_mfma_f32_16x16x32_bf16 a[8:11], v[64:67], v[40:43], a[8:11]
    ds_read_b64 v[52:53], v6 offset:50176
    ds_read_b64 v[54:55], v6 offset:50688
    v_mfma_f32_16x16x32_bf16 a[12:15], v[64:67], v[44:47], a[12:15]
    ds_read_b64 v[56:57], v7 offset:49152
    ds_read_b64 v[58:59], v7 offset:49664
    v_mfma_f32_16x16x32_bf16 a[16:19], v[68:71], v[32:35], a[16:19]
    ds_read_b64 v[60:61], v7 offset:50176
    v_mfma_f32_16x16x32_bf16 a[20:23], v[68:71], v[36:39], a[20:23]
    ds_read_b64 v[62:63], v7 offset:50688
    buffer_load_dwordx4 v16, s[16:19], s69 offen offset:1024 sc1 lds
    v_mfma_f32_16x16x32_bf16 a[24:27], v[68:71], v[40:43], a[24:27]
    ds_read_b64_tr_b16 v[84:85], v9 offset:49152
    s_add_u32 s69, s69, 8192
    v_mfma_f32_16x16x32_bf16 a[28:31], v[68:71], v[44:47], a[28:31]
    ds_read_b64_tr_b16 v[86:87], v9 offset:53248
    v_mfma_f32_16x16x32_bf16 a[32:35], v[72:75], v[32:35], a[32:35]
    ds_read_b64_tr_b16 v[88:89], v10 offset:49152
    s_add_u32 m0, s73, 24576
    v_mfma_f32_16x16x32_bf16 a[36:39], v[72:75], v[36:39], a[36:39]
    ds_read_b64_tr_b16 v[90:91], v10 offset:53248
    buffer_load_dwordx4 v122, s[40:43], s70 offen lds
    v_mfma_f32_16x16x32_bf16 a[40:43], v[72:75], v[40:43], a[40:43]
    ds_read_b64_tr_b16 v[92:93], v11 offset:49152
    v_mfma_f32_16x16x32_bf16 a[44:47], v[72:75], v[44:47], a[44:47]
    ds_read_b64_tr_b16 v[94:95], v11 offset:53248
    v_mfma_f32_16x16x32_bf16 a[48:51], v[76:79], v[32:35], a[48:51]
    v_mfma_f32_16x16x32_bf16 a[52:55], v[76:79], v[36:39], a[52:55]
    buffer_load_dwordx4 v123, s[40:43], s70 offen offset:1024 lds
    v_mfma_f32_16x16x32_bf16 a[56:59], v[76:79], v[40:43], a[56:59]
    s_add_u32 s70, s70, 65536
    v_mfma_f32_16x16x32_bf16 a[60:63], v[76:79], v[44:47], a[60:63]
    s_waitcnt vmcnt(12) lgkmcnt(0)
    s_barrier
    v_mfma_f32_16x16x32_bf16 a[0:3], v[80:83], v[48:51], a[0:3]
    ds_read_b128 v[32:35], v3 offset:0
    ds_read_b64_tr_b16 v[64:65], v12 offset:0
    s_add_u32 m0, s73, 32768
    v_mfma_f32_16x16x32_bf16 a[4:7], v[80:83], v[52:55], a[4:7]
    ds_read_b64_tr_b16 v[66:67], v12 offset:4096
    ds_read_b128 v[36:39], v3 offset:1024
    buffer_load_dwordx4 v16, s[16:19], s69 offen sc1 lds
    v_mfma_f32_16x16x32_bf16 a[8:11], v[80:83], v[56:59], a[8:11]
    ds_read_b128 v[40:43], v5 offset:0
    v_mfma_f32_16x16x32_bf16 a[12:15], v[80:83], v[60:63], a[12:15]
    ds_read_b128 v[44:47], v5 offset:1024
    v_mfma_f32_16x16x32_bf16 a[16:19], v[84:87], v[48:51], a[16:19]
    ds_read_b64_tr_b16 v[68:69], v13 offset:0
    v_mfma_f32_16x16x32_bf16 a[20:23], v[84:87], v[52:55], a[20:23]
    ds_read_b64_tr_b16 v[70:71], v13 offset:4096
    buffer_load_dwordx4 v16, s[16:19], s69 offen offset:1024 sc1 lds
    v_mfma_f32_16x16x32_bf16 a[24:27], v[84:87], v[56:59], a[24:27]
    ds_read_b64_tr_b16 v[72:73], v14 offset:0
    s_add_u32 s69, s69, 8192
    v_mfma_f32_16x16x32_bf16 a[28:31], v[84:87], v[60:63], a[28:31]
    ds_read_b64_tr_b16 v[74:75], v14 offset:4096
    v_mfma_f32_16x16x32_bf16 a[32:35], v[88:91], v[48:51], a[32:35]
    ds_read_b64_tr_b16 v[76:77], v15 offset:0
    s_add_u32 m0, s73, 40960
    v_mfma_f32_16x16x32_bf16 a[36:39], v[88:91], v[52:55], a[36:39]
    ds_read_b64_tr_b16 v[78:79], v15 offset:4096
    buffer_load_dwordx4 v122, s[40:43], s70 offen lds
    v_mfma_f32_16x16x32_bf16 a[40:43], v[88:91], v[56:59], a[40:43]
    v_mfma_f32_16x16x32_bf16 a[44:47], v[88:91], v[60:63], a[44:47]
    v_mfma_f32_16x16x32_bf16 a[48:51], v[92:95], v[48:51], a[48:51]
    v_mfma_f32_16x16x32_bf16 a[52:55], v[92:95], v[52:55], a[52:55]
    buffer_load_dwordx4 v123, s[40:43], s70 offen offset:1024 lds
    v_mfma_f32_16x16x32_bf16 a[56:59], v[92:95], v[56:59], a[56:59]
    s_add_u32 s70, s70, 65536
    v_mfma_f32_16x16x32_bf16 a[60:63], v[92:95], v[60:63], a[60:63]
    s_waitcnt lgkmcnt(0)
    v_mfma_f32_16x16x32_bf16 a[0:3], v[64:67], v[32:35], a[0:3]
    ds_read_b128 v[48:51], v3 offset:16384
    ds_read_b64_tr_b16 v[80:81], v12 offset:16384
    s_add_u32 m0, s73, 49152
    v_mfma_f32_16x16x32_bf16 a[4:7], v[64:67], v[36:39], a[4:7]
    ds_read_b64_tr_b16 v[82:83], v12 offset:20480
    ds_read_b128 v[52:55], v3 offset:17408
    buffer_load_dwordx4 v16, s[16:19], s69 offen sc1 lds
    v_mfma_f32_16x16x32_bf16 a[8:11], v[64:67], v[40:43], a[8:11]
    ds_read_b128 v[56:59], v5 offset:16384
    v_mfma_f32_16x16x32_bf16 a[12:15], v[64:67], v[44:47], a[12:15]
    ds_read_b128 v[60:63], v5 offset:17408
    v_mfma_f32_16x16x32_bf16 a[16:19], v[68:71], v[32:35], a[16:19]
    ds_read_b64_tr_b16 v[84:85], v13 offset:16384
    v_mfma_f32_16x16x32_bf16 a[20:23], v[68:71], v[36:39], a[20:23]
    ds_read_b64_tr_b16 v[86:87], v13 offset:20480
    buffer_load_dwordx4 v16, s[16:19], s69 offen offset:1024 sc1 lds
    v_mfma_f32_16x16x32_bf16 a[24:27], v[68:71], v[40:43], a[24:27]
    ds_read_b64_tr_b16 v[88:89], v14 offset:16384
    s_add_u32 s69, s69, 8192
    v_mfma_f32_16x16x32_bf16 a[28:31], v[68:71], v[44:47], a[28:31]
    ds_read_b64_tr_b16 v[90:91], v14 offset:20480
    v_mfma_f32_16x16x32_bf16 a[32:35], v[72:75], v[32:35], a[32:35]
    ds_read_b64_tr_b16 v[92:93], v15 offset:16384
    s_add_u32 m0, s73, 57344
    v_mfma_f32_16x16x32_bf16 a[36:39], v[72:75], v[36:39], a[36:39]
    ds_read_b64_tr_b16 v[94:95], v15 offset:20480
    buffer_load_dwordx4 v122, s[40:43], s70 offen lds
    v_mfma_f32_16x16x32_bf16 a[40:43], v[72:75], v[40:43], a[40:43]
    v_mfma_f32_16x16x32_bf16 a[44:47], v[72:75], v[44:47], a[44:47]
    v_mfma_f32_16x16x32_bf16 a[48:51], v[76:79], v[32:35], a[48:51]
    v_mfma_f32_16x16x32_bf16 a[52:55], v[76:79], v[36:39], a[52:55]
    buffer_load_dwordx4 v123, s[40:43], s70 offen offset:1024 lds
    v_mfma_f32_16x16x32_bf16 a[56:59], v[76:79], v[40:43], a[56:59]
    s_add_u32 s70, s70, 65536
    v_mfma_f32_16x16x32_bf16 a[60:63], v[76:79], v[44:47], a[60:63]
    s_waitcnt vmcnt(12) lgkmcnt(0)
    s_cmp_eq_u32 s57, 2
    s_cbranch_scc0 L_noPollY
    s_mov_b32 s80, 0
    s_mov_b32 s78, 0xffffffff
    s_mov_b32 s79, 0x0
    s_branch L_pollY_chk
L_pollY:
    buffer_load_dwordx2 v[26:27], v114, s[12:15], 0 offen sc1
    s_waitcnt vmcnt(0)
L_pollY_chk:
    v_cmp_ne_u32 vcc, s88, v26
    v_cmp_ne_u32 s[76:77], s89, v27
    s_add_u32 s80, s80, 1
    s_nop 0
    s_or_b64 vcc, vcc, s[76:77]
    s_and_b64 vcc, vcc, s[78:79]
    s_cmp_gt_u32 s80, 0x20000
    s_cbranch_scc1 L_pollY_done
    s_cbranch_vccnz L_pollY
L_pollY_done:
L_noPollY:
    s_barrier
    v_mfma_f32_16x16x32_bf16 a[0:3], v[80:83], v[48:51], a[0:3]
    ds_read_b128 v[32:35], v3 offset:32768
    ds_read_b64_tr_b16 v[64:65], v12 offset:32768
    s_add_u32 m0, s73, 65536
    v_mfma_f32_16x16x32_bf16 a[4:7], v[80:83], v[52:55], a[4:7]
    ds_read_b64_tr_b16 v[66:67], v12 offset:36864
    ds_read_b128 v[36:39], v3 offset:33792
    buffer_load_dwordx4 v16, s[16:19], s69 offen sc1 lds
    v_mfma_f32_16x16x32_bf16 a[8:11], v[80:83], v[56:59], a[8:11]
    ds_read_b128 v[40:43], v5 offset:32768
    v_mfma_f32_16x16x32_bf16 a[12:15], v[80:83], v[60:63], a[12:15]
    ds_read_b128 v[44:47], v5 offset:33792
    v_mfma_f32_16x16x32_bf16 a[16:19], v[84:87], v[48:51], a[16:19]
    ds_read_b64_tr_b16 v[68:69], v13 offset:32768
    v_mfma_f32_16x16x32_bf16 a[20:23], v[84:87], v[52:55], a[20:23]
    ds_read_b64_tr_b16 v[70:71], v13 offset:36864
    buffer_load_dwordx4 v16, s[16:19], s69 offen offset:1024 sc1 lds
    v_mfma_f32_16x16x32_bf16 a[24:27], v[84:87], v[56:59], a[24:27]
    ds_read_b64_tr_b16 v[72:73], v14 offset:32768
    s_add_u32 s69, s69, 8192
    v_mfma_f32_16x16x32_bf16 a[28:31], v[84:87], v[60:63], a[28:31]
    ds_read_b64_tr_b16 v[74:75], v14 offset:36864
    v_mfma_f32_16x16x32_bf16 a[32:35], v[88:91], v[48:51], a[32:35]
    ds_read_b64_tr_b16 v[76:77], v15 offset:32768
    s_add_u32 m0, s73, 73728
    v_mfma_f32_16x16x32_bf16 a[36:39], v[88:91], v[52:55], a[36:39]
    ds_read_b64_tr_b16 v[78:79], v15 offset:36864
    buffer_load_dwordx4 v122, s[40:43], s70 offen lds
    v_mfma_f32_16x16x32_bf16 a[40:43], v[88:91], v[56:59], a[40:43]
    v_mfma_f32_16x16x32_bf16 a[44:47], v[88:91], v[60:63], a[44:47]
    v_mfma_f32_16x16x32_bf16 a[48:51], v[92:95], v[48:51], a[48:51]
    v_mfma_f32_16x16x32_bf16 a[52:55], v[92:95], v[52:55], a[52:55]
    buffer_load_dwordx4 v123, s[40:43], s70 offen offset:1024 lds
    v_mfma_f32_16x16x32_bf16 a[56:59], v[92:95], v[56:59], a[56:59]
    s_add_u32 s70, s70, 65536
    v_mfma_f32_16x16x32_bf16 a[60:63], v[92:95], v[60:63], a[60:63]
    s_waitcnt lgkmcnt(0)
    v_mfma_f32_16x16x32_bf16 a[0:3], v[64:67], v[32:35], a[0:3]
    ds_read_b128 v[48:51], v2 offset:0
    ds_read_b64_tr_b16 v[80:81], v8 offset:0
    s_add_u32 m0, s73, 81920
    v_mfma_f32_16x16x32_bf16 a[4:7], v[64:67], v[36:39], a[4:7]
    ds_read_b64_tr_b16 v[82:83], v8 offset:4096
    ds_read_b128 v[52:55], v2 offset:1024
    buffer_load_dwordx4 v16, s[16:19], s69 offen sc1 lds
    v_mfma_f32_16x16x32_bf16 a[8:11], v[64:67], v[40:43], a[8:11]
    ds_read_b128 v[56:59], v4 offset:0
    v_mfma_f32_16x16x32_bf16 a[12:15], v[64:67], v[44:47], a[12:15]
    ds_read_b128 v[60:63], v4 offset:1024
    v_mfma_f32_16x16x32_bf16 a[16:19], v[68:71], v[32:35], a[16:19]
    ds_read_b64_tr_b16 v[84:85], v9 offset:0
    v_mfma_f32_16x16x32_bf16 a[20:23], v[68:71], v[36:39], a[20:23]
    ds_read_b64_tr_b16 v[86:87], v9 offset:4096
    buffer_load_dwordx4 v16, s[16:19], s69 offen offset:1024 sc1 lds
    v_mfma_f32_16x16x32_bf16 a[24:27], v[68:71], v[40:43], a[24:27]
    ds_read_b64_tr_b16 v[88:89], v10 offset:0
    s_add_u32 s69, s69, 8192
    v_mfma_f32_16x16x32_bf16 a[28:31], v[68:71], v[44:47], a[28:31]
    ds_read_b64_tr_b16 v[90:91], v10 offset:4096
    v_mfma_f32_16x16x32_bf16 a[32:35], v[72:75], v[32:35], a[32:35]
    ds_read_b64_tr_b16 v[92:93], v11 offset:0
    s_add_u32 m0, s73, 90112
    v_mfma_f32_16x16x32_bf16 a[36:39], v[72:75], v[36:39], a[36:39]
    ds_read_b64_tr_b16 v[94:95], v11 offset:4096
    buffer_load_dwordx4 v122, s[40:43], s70 offen lds
    v_mfma_f32_16x16x32_bf16 a[40:43], v[72:75], v[40:43], a[40:43]
    v_mfma_f32_16x16x32_bf16 a[44:47], v[72:75], v[44:47], a[44:47]
    v_mfma_f32_16x16x32_bf16 a[48:51], v[76:79], v[32:35], a[48:51]
    v_mfma_f32_16x16x32_bf16 a[52:55], v[76:79], v[36:39], a[52:55]
    buffer_load_dwordx4 v123, s[40:43], s70 offen offset:1024 lds
    v_mfma_f32_16x16x32_bf16 a[56:59], v[76:79], v[40:43], a[56:59]
    s_add_u32 s70, s70, 65536
    v_mfma_f32_16x16x32_bf16 a[60:63], v[76:79], v[44:47], a[60:63]
    s_add_u32 s57, s57, 1
    s_cmp_lt_u32 s57, 3
    s_cbranch_scc1 L_g2loop
    s_waitcnt vmcnt(12) lgkmcnt(0)
    s_barrier
    v_mfma_f32_16x16x32_bf16 a[0:3], v[80:83], v[48:51], a[0:3]
    ds_read_b128 v[32:35], v2 offset:16384
    ds_read_b64_tr_b16 v[64:65], v8 offset:16384
    s_add_u32 m0, s73, 98304
    v_and_b32 v24, 15, v1
    s_lshl_b32 s82, s64, 7
    v_mfma_f32_16x16x32_bf16 a[4:7], v[80:83], v[52:55], a[4:7]
    ds_read_b64_tr_b16 v[66:67], v8 offset:20480
    ds_read_b128 v[36:39], v2 offset:17408
    buffer_load_dwordx4 v16, s[16:19], s69 offen sc1 lds
    s_lshl_b32 s83, s67, 6
    s_add_u32 s82, s82, s83
    v_mfma_f32_16x16x32_bf16 a[8:11], v[80:83], v[56:59], a[8:11]
    ds_read_b128 v[40:43], v4 offset:16384
    s_lshl_b32 s83, s100, 5
    v_mfma_f32_16x16x32_bf16 a[12:15], v[80:83], v[60:63], a[12:15]
    ds_read_b128 v[44:47], v4 offset:17408
    s_add_u32 s82, s82, s83
    v_add_u32 v24, s82, v24
    v_mfma_f32_16x16x32_bf16 a[16:19], v[84:87], v[48:51], a[16:19]
    ds_read_b64_tr_b16 v[68:69], v9 offset:16384
    v_lshrrev_b32 v25, 4, v1
    s_lshl_b32 s82, s101, 8
    v_mfma_f32_16x16x32_bf16 a[20:23], v[84:87], v[52:55], a[20:23]
    ds_read_b64_tr_b16 v[70:71], v9 offset:20480
    buffer_load_dwordx4 v16, s[16:19], s69 offen offset:1024 sc1 lds
    s_lshl_b32 s83, s68, 7
    v_mfma_f32_16x16x32_bf16 a[24:27], v[84:87], v[56:59], a[24:27]
    ds_read_b64_tr_b16 v[72:73], v10 offset:16384
    s_cmp_ge_u32 s72, s74
    s_addc_u32 s78, s72, 0
    s_add_u32 s82, s82, s83
    v_lshlrev_b32 v115, 11, v24
    v_mfma_f32_16x16x32_bf16 a[28:31], v[84:87], v[60:63], a[28:31]
    ds_read_b64_tr_b16 v[74:75], v10 offset:20480
    s_lshl_b32 s79, s100, 3
    v_lshl_add_u32 v115, v25, 3, v115
    v_mfma_f32_16x16x32_bf16 a[32:35], v[88:91], v[48:51], a[32:35]
    ds_read_b64_tr_b16 v[76:77], v11 offset:16384
    s_add_u32 s78, s78, s79
    s_add_u32 m0, s73, 106496
    v_add_u32 v115, s82, v115
    v_add_u32 v116, 32768, v115
    v_mfma_f32_16x16x32_bf16 a[36:39], v[88:91], v[52:55], a[36:39]
    ds_read_b64_tr_b16 v[78:79], v11 offset:20480
    s_add_u32 s72, s72, 1
    buffer_load_dwordx4 v122, s[40:43], s70 offen lds
    v_lshlrev_b32 v117, 3, v24
    v_lshl_add_u32 v117, v25, 14, v117
    v_mfma_f32_16x16x32_bf16 a[40:43], v[88:91], v[56:59], a[40:43]
    s_lshl_b32 s79, s64, 4
    v_lshlrev_b32 v118, 4, v24
    v_mfma_f32_16x16x32_bf16 a[44:47], v[88:91], v[60:63], a[44:47]
    s_add_u32 s78, s78, s79
    v_lshlrev_b32 v119, 3, v25
    v_add_u32 v119, s82, v119
    v_mfma_f32_16x16x32_bf16 a[48:51], v[92:95], v[48:51], a[48:51]
    s_mul_i32 s69, s78, 57344
    s_lshl_b32 s84, s101, 5
    s_lshl_b32 s85, s68, 4
    v_mfma_f32_16x16x32_bf16 a[52:55], v[92:95], v[52:55], a[52:55]
    s_add_u32 s69, s69, 0
    buffer_load_dwordx4 v123, s[40:43], s70 offen offset:1024 lds
    s_add_u32 s84, s84, s85
    v_mfma_f32_16x16x32_bf16 a[56:59], v[92:95], v[56:59], a[56:59]
    s_cmp_ge_u32 s71, s74
    s_addc_u32 s76, s71, 0
    s_lshl_b32 s77, s100, 3
    s_add_u32 s76, s76, s77
    s_add_u32 s71, s71, 1
    s_lshl_b32 s84, s84, 14
    s_add_u32 s84, s84, 20971520
    v_mfma_f32_16x16x32_bf16 a[60:63], v[92:95], v[60:63], a[60:63]
    s_mul_i32 s70, s76, 458752
    s_mov_b32 s85, 33554432
    s_waitcnt lgkmcnt(0)
    v_mfma_f32_16x16x32_bf16 a[0:3], v[64:67], v[32:35], a[0:3]
    ds_read_b128 v[56:59], v4 offset:32768
    buffer_load_dwordx2 v[128:129], v115, s[4:7], 0 offen offset:0
    buffer_load_dwordx2 v[130:131], v116, s[4:7], 0 offen offset:0
    v_mfma_f32_16x16x32_bf16 a[4:7], v[64:67], v[36:39], a[4:7]
    ds_read_b64_tr_b16 v[80:81], v8 offset:32768
    buffer_load_dwordx2 v[132:133], v115, s[4:7], 0 offen offset:32
    buffer_load_dwordx2 v[134:135], v116, s[4:7], 0 offen offset:32
    v_mfma_f32_16x16x32_bf16 a[8:11], v[64:67], v[40:43], a[8:11]
    ds_read_b64_tr_b16 v[82:83], v8 offset:36864
    buffer_load_dwordx2 v[136:137], v115, s[4:7], 0 offen offset:64
    v_mfma_f32_16x16x32_bf16 a[12:15], v[64:67], v[44:47], a[12:15]
    buffer_load_dwordx2 v[138:139], v116, s[4:7], 0 offen offset:64
    buffer_load_dwordx2 v[140:141], v115, s[4:7], 0 offen offset:96
    v_mfma_f32_16x16x32_bf16 a[16:19], v[68:71], v[32:35], a[16:19]
    ds_read_b128 v[60:63], v4 offset:33792
    buffer_load_dwordx2 v[142:143], v116, s[4:7], 0 offen offset:96
    buffer_load_dwordx2 v[144:145], v117, s[12:15], s84 offen offset:0 sc1
    v_mfma_f32_16x16x32_bf16 a[20:23], v[68:71], v[36:39], a[20:23]
    ds_read_b64_tr_b16 v[84:85], v9 offset:32768
    buffer_load_dwordx2 v[146:147], v117, s[12:15], s84 offen offset:128 sc1
    v_mfma_f32_16x16x32_bf16 a[24:27], v[68:71], v[40:43], a[24:27]
    s_add_u32 s84, s84, 65536
    buffer_load_dwordx2 v[148:149], v117, s[12:15], s84 offen offset:0 sc1
    v_mfma_f32_16x16x32_bf16 a[28:31], v[68:71], v[44:47], a[28:31]
    ds_read_b64_tr_b16 v[86:87], v9 offset:36864
    buffer_load_dwordx2 v[150:151], v117, s[12:15], s84 offen offset:128 sc1
    v_mfma_f32_16x16x32_bf16 a[32:35], v[72:75], v[32:35], a[32:35]
    ds_read_b64_tr_b16 v[88:89], v10 offset:32768
    s_add_u32 s84, s84, 65536
    buffer_load_dwordx2 v[152:153], v117, s[12:15], s84 offen offset:0 sc1
    v_mfma_f32_16x16x32_bf16 a[36:39], v[72:75], v[36:39], a[36:39]
    ds_read_b64_tr_b16 v[90:91], v10 offset:36864
    buffer_load_dwordx2 v[154:155], v117, s[12:15], s84 offen offset:128 sc1
    s_add_u32 s84, s84, 65536
    v_mfma_f32_16x16x32_bf16 a[40:43], v[72:75], v[40:43], a[40:43]
    buffer_load_dwordx2 v[156:157], v117, s[12:15], s84 offen offset:0 sc1
    v_mfma_f32_16x16x32_bf16 a[44:47], v[72:75], v[44:47], a[44:47]
    ds_read_b64_tr_b16 v[92:93], v11 offset:32768
    buffer_load_dwordx2 v[158:159], v117, s[12:15], s84 offen offset:128 sc1
    s_add_u32 s84, s84, 65536
    v_mfma_f32_16x16x32_bf16 a[48:51], v[76:79], v[32:35], a[48:51]
    ds_read_b64_tr_b16 v[94:95], v11 offset:36864
    buffer_load_dwordx2 v[168:169], v118, s[12:15], s85 offen offset:0 sc1
    buffer_load_dwordx2 v[170:171], v118, s[12:15], s85 offen offset:256 sc1
    v_mfma_f32_16x16x32_bf16 a[52:55], v[76:79], v[36:39], a[52:55]
    buffer_load_dwordx2 v[160:161], v119, s[44:47], 0 offen offset:0
    v_mfma_f32_16x16x32_bf16 a[56:59], v[76:79], v[40:43], a[56:59]
    buffer_load_dwordx2 v[162:163], v119, s[44:47], 0 offen offset:32
    buffer_load_dwordx2 v[164:165], v119, s[44:47], 0 offen offset:64
    v_mfma_f32_16x16x32_bf16 a[60:63], v[76:79], v[44:47], a[60:63]
    buffer_load_dwordx2 v[166:167], v119, s[44:47], 0 offen offset:96
    s_waitcnt vmcnt(30) lgkmcnt(0)
    s_barrier
    v_mfma_f32_16x16x32_bf16 a[8:11], v[80:83], v[56:59], a[8:11]
    ds_read_b64 v[40:41], v7 offset:49152
    ds_read_b64 v[42:43], v7 offset:49664
    v_mfma_f32_16x16x32_bf16 a[12:15], v[80:83], v[60:63], a[12:15]
    ds_read_b64_tr_b16 v[64:65], v8 offset:49152
    ds_read_b64_tr_b16 v[66:67], v8 offset:53248
    v_mfma_f32_16x16x32_bf16 a[24:27], v[84:87], v[56:59], a[24:27]
    ds_read_b64 v[44:45], v7 offset:50176
    ds_read_b64 v[46:47], v7 offset:50688
    v_mfma_f32_16x16x32_bf16 a[28:31], v[84:87], v[60:63], a[28:31]
    ds_read_b64_tr_b16 v[68:69], v9 offset:49152
    ds_read_b64_tr_b16 v[70:71], v9 offset:53248
    v_mfma_f32_16x16x32_bf16 a[40:43], v[88:91], v[56:59], a[40:43]
    ds_read_b64_tr_b16 v[72:73], v10 offset:49152
    ds_read_b64_tr_b16 v[74:75], v10 offset:53248
    v_mfma_f32_16x16x32_bf16 a[44:47], v[88:91], v[60:63], a[44:47]
    ds_read_b64_tr_b16 v[76:77], v11 offset:49152
    ds_read_b64_tr_b16 v[78:79], v11 offset:53248
    v_mfma_f32_16x16x32_bf16 a[56:59], v[92:95], v[56:59], a[56:59]
    v_mfma_f32_16x16x32_bf16 a[60:63], v[92:95], v[60:63], a[60:63]
    s_waitcnt lgkmcnt(0)
    v_mfma_f32_16x16x32_bf16 a[8:11], v[64:67], v[40:43], a[8:11]
    ds_read_b128 v[56:59], v5 offset:0
    ds_read_b64_tr_b16 v[80:81], v12 offset:0
    v_mfma_f32_16x16x32_bf16 a[12:15], v[64:67], v[44:47], a[12:15]
    ds_read_b64_tr_b16 v[82:83], v12 offset:4096
    ds_read_b128 v[60:63], v5 offset:1024
    v_mfma_f32_16x16x32_bf16 a[24:27], v[68:71], v[40:43], a[24:27]
    ds_read_b64_tr_b16 v[84:85], v13 offset:0
    v_mfma_f32_16x16x32_bf16 a[28:31], v[68:71], v[44:47], a[28:31]
    ds_read_b64_tr_b16 v[86:87], v13 offset:4096
    ds_read_b64_tr_b16 v[88:89], v14 offset:0
    v_mfma_f32_16x16x32_bf16 a[40:43], v[72:75], v[40:43], a[40:43]
    ds_read_b64_tr_b16 v[90:91], v14 offset:4096
    ds_read_b64_tr_b16 v[92:93], v15 offset:0
    v_mfma_f32_16x16x32_bf16 a[44:47], v[72:75], v[44:47], a[44:47]
    ds_read_b64_tr_b16 v[94:95], v15 offset:4096
    v_mfma_f32_16x16x32_bf16 a[56:59], v[76:79], v[40:43], a[56:59]
    v_mfma_f32_16x16x32_bf16 a[60:63], v[76:79], v[44:47], a[60:63]
    s_waitcnt vmcnt(22) lgkmcnt(0)
    s_barrier
    v_mfma_f32_16x16x32_bf16 a[8:11], v[80:83], v[56:59], a[8:11]
    ds_read_b128 v[40:43], v5 offset:16384
    ds_read_b64_tr_b16 v[64:65], v12 offset:16384
    v_mfma_f32_16x16x32_bf16 a[12:15], v[80:83], v[60:63], a[12:15]
    ds_read_b64_tr_b16 v[66:67], v12 offset:20480
    ds_read_b128 v[44:47], v5 offset:17408
    v_mfma_f32_16x16x32_bf16 a[24:27], v[84:87], v[56:59], a[24:27]
    ds_read_b64_tr_b16 v[68:69], v13 offset:16384
    v_mfma_f32_16x16x32_bf16 a[28:31], v[84:87], v[60:63], a[28:31]
    ds_read_b64_tr_b16 v[70:71], v13 offset:20480
    ds_read_b64_tr_b16 v[72:73], v14 offset:16384
    v_mfma_f32_16x16x32_bf16 a[40:43], v[88:91], v[56:59], a[40:43]
    ds_read_b64_tr_b16 v[74:75], v14 offset:20480
    ds_read_b64_tr_b16 v[76:77], v15 offset:16384
    v_mfma_f32_16x16x32_bf16 a[44:47], v[88:91], v[60:63], a[44:47]
    ds_read_b64_tr_b16 v[78:79], v15 offset:20480
    v_mfma_f32_16x16x32_bf16 a[56:59], v[92:95], v[56:59], a[56:59]
    v_mfma_f32_16x16x32_bf16 a[60:63], v[92:95], v[60:63], a[60:63]
    s_waitcnt lgkmcnt(0)
    v_mfma_f32_16x16x32_bf16 a[8:11], v[64:67], v[40:43], a[8:11]
    ds_read_b128 v[56:59], v5 offset:32768
    ds_read_b64_tr_b16 v[80:81], v12 offset:32768
    s_xor_b32 s76, s65, 8
    s_lshl_b32 s77, s64, 4
    v_mfma_f32_16x16x32_bf16 a[12:15], v[64:67], v[44:47], a[12:15]
    ds_read_b64_tr_b16 v[82:83], v12 offset:36864
    ds_read_b128 v[60:63], v5 offset:33792
    s_add_u32 s76, s76, s77
    v_mfma_f32_16x16x32_bf16 a[24:27], v[68:71], v[40:43], a[24:27]
    ds_read_b64_tr_b16 v[84:85], v13 offset:32768
    s_lshl_b32 s76, s76, 2
    v_mfma_f32_16x16x32_bf16 a[28:31], v[68:71], v[44:47], a[28:31]
    ds_read_b64_tr_b16 v[86:87], v13 offset:36864
    ds_read_b64_tr_b16 v[88:89], v14 offset:32768
    s_add_u32 s76, s76, s66
    v_mfma_f32_16x16x32_bf16 a[40:43], v[72:75], v[40:43], a[40:43]
    ds_read_b64_tr_b16 v[90:91], v14 offset:36864
    ds_read_b64_tr_b16 v[92:93], v15 offset:32768
    s_lshl_b32 s76, s76, 13
    v_mfma_f32_16x16x32_bf16 a[44:47], v[72:75], v[44:47], a[44:47]
    ds_read_b64_tr_b16 v[94:95], v15 offset:36864
    s_add_u32 s76, s76, 25165824
    v_mfma_f32_16x16x32_bf16 a[56:59], v[76:79], v[40:43], a[56:59]
    s_add_u32 s77, s76, 4096
    v_mfma_f32_16x16x32_bf16 a[60:63], v[76:79], v[44:47], a[60:63]
    v_lshlrev_b32 v113, 4, v1
    s_waitcnt lgkmcnt(0)
    v_mfma_f32_16x16x32_bf16 a[8:11], v[80:83], v[56:59], a[8:11]
    ds_read_b128 v[32:35], v2 offset:32768
    ds_read_b64_tr_b16 v[64:65], v8 offset:32768
    s_and_b32 s78, s88, 0xff
    v_mov_b32 v96, s78
    v_mfma_f32_16x16x32_bf16 a[12:15], v[80:83], v[60:63], a[12:15]
    ds_read_b64_tr_b16 v[66:67], v8 offset:36864
    ds_read_b128 v[36:39], v2 offset:33792
    s_bfe_u32 s78, s88, 0x80008
    v_mfma_f32_16x16x32_bf16 a[24:27], v[84:87], v[56:59], a[24:27]
    ds_read_b64_tr_b16 v[68:69], v9 offset:32768
    v_mov_b32 v97, s78
    v_mfma_f32_16x16x32_bf16 a[28:31], v[84:87], v[60:63], a[28:31]
    ds_read_b64_tr_b16 v[70:71], v9 offset:36864
    ds_read_b64_tr_b16 v[72:73], v10 offset:32768
    s_bfe_u32 s78, s88, 0x80010
    v_mfma_f32_16x16x32_bf16 a[40:43], v[88:91], v[56:59], a[40:43]
    ds_read_b64_tr_b16 v[74:75], v10 offset:36864
    ds_read_b64_tr_b16 v[76:77], v11 offset:32768
    v_mov_b32 v98, s78
    v_mfma_f32_16x16x32_bf16 a[44:47], v[88:91], v[60:63], a[44:47]
    ds_read_b64_tr_b16 v[78:79], v11 offset:36864
    s_lshr_b32 s78, s88, 24
    v_mfma_f32_16x16x32_bf16 a[56:59], v[92:95], v[56:59], a[56:59]
    v_mov_b32 v99, s78
    v_mfma_f32_16x16x32_bf16 a[60:63], v[92:95], v[60:63], a[60:63]
    s_mov_b32 s78, 0xffffff00
    s_waitcnt lgkmcnt(0)
    v_mfma_f32_16x16x32_bf16 a[0:3], v[64:67], v[32:35], a[0:3]
    ds_read_b64 v[48:49], v6 offset:49152
    ds_read_b64 v[50:51], v6 offset:49664
    v_mfma_f32_16x16x32_bf16 a[4:7], v[64:67], v[36:39], a[4:7]
    ds_read_b64_tr_b16 v[80:81], v8 offset:49152
    ds_read_b64_tr_b16 v[82:83], v8 offset:53248
    v_mfma_f32_16x16x32_bf16 a[16:19], v[68:71], v[32:35], a[16:19]
    ds_read_b64 v[52:53], v6 offset:50176
    ds_read_b64 v[54:55], v6 offset:50688
    v_mfma_f32_16x16x32_bf16 a[20:23], v[68:71], v[36:39], a[20:23]
    ds_read_b64_tr_b16 v[84:85], v9 offset:49152
    ds_read_b64_tr_b16 v[86:87], v9 offset:53248
    v_mfma_f32_16x16x32_bf16 a[32:35], v[72:75], v[32:35], a[32:35]
    ds_read_b64_tr_b16 v[88:89], v10 offset:49152
    ds_read_b64_tr_b16 v[90:91], v10 offset:53248
    v_accvgpr_read_b32 v176, a8
    v_accvgpr_read_b32 v177, a9
    v_mfma_f32_16x16x32_bf16 a[36:39], v[72:75], v[36:39], a[36:39]
    ds_read_b64_tr_b16 v[92:93], v11 offset:49152
    ds_read_b64_tr_b16 v[94:95], v11 offset:53248
    v_accvgpr_read_b32 v178, a10
    v_accvgpr_read_b32 v179, a11
    v_mfma_f32_16x16x32_bf16 a[48:51], v[76:79], v[32:35], a[48:51]
    v_and_or_b32 v176, v176, s78, v96
    v_and_or_b32 v177, v177, s78, v97
    v_mfma_f32_16x16x32_bf16 a[52:55], v[76:79], v[36:39], a[52:55]
    v_and_or_b32 v178, v178, s78, v98
    v_and_or_b32 v179, v179, s78, v99
    s_waitcnt lgkmcnt(0)
    v_mfma_f32_16x16x32_bf16 a[0:3], v[80:83], v[48:51], a[0:3]
    ds_read_b128 v[32:35], v3 offset:0
    ds_read_b64_tr_b16 v[64:65], v12 offset:0
    buffer_store_dwordx4 v[176:179], v113, s[12:15], s76 offen offset:0 sc1
    v_accvgpr_read_b32 v180, a12
    v_mfma_f32_16x16x32_bf16 a[4:7], v[80:83], v[52:55], a[4:7]
    ds_read_b64_tr_b16 v[66:67], v12 offset:4096
    ds_read_b128 v[36:39], v3 offset:1024
    v_accvgpr_read_b32 v181, a13
    v_accvgpr_read_b32 v182, a14
    v_mfma_f32_16x16x32_bf16 a[16:19], v[84:87], v[48:51], a[16:19]
    ds_read_b64_tr_b16 v[68:69], v13 offset:0
    v_accvgpr_read_b32 v183, a15
    v_and_or_b32 v180, v180, s78, v96
    v_mfma_f32_16x16x32_bf16 a[20:23], v[84:87], v[52:55], a[20:23]
    ds_read_b64_tr_b16 v[70:71], v13 offset:4096
    ds_read_b64_tr_b16 v[72:73], v14 offset:0
    v_and_or_b32 v181, v181, s78, v97
    v_and_or_b32 v182, v182, s78, v98
    v_mfma_f32_16x16x32_bf16 a[32:35], v[88:91], v[48:51], a[32:35]
    ds_read_b64_tr_b16 v[74:75], v14 offset:4096
    ds_read_b64_tr_b16 v[76:77], v15 offset:0
    v_and_or_b32 v183, v183, s78, v99
    buffer_store_dwordx4 v[180:183], v113, s[12:15], s76 offen offset:1024 sc1
    v_mfma_f32_16x16x32_bf16 a[36:39], v[88:91], v[52:55], a[36:39]
    ds_read_b64_tr_b16 v[78:79], v15 offset:4096
    v_accvgpr_read_b32 v184, a24
    v_accvgpr_read_b32 v185, a25
    v_mfma_f32_16x16x32_bf16 a[48:51], v[92:95], v[48:51], a[48:51]
    v_accvgpr_read_b32 v186, a26
    v_accvgpr_read_b32 v187, a27
    v_mfma_f32_16x16x32_bf16 a[52:55], v[92:95], v[52:55], a[52:55]
    v_and_or_b32 v184, v184, s78, v96
    v_and_or_b32 v185, v185, s78, v97
    s_waitcnt lgkmcnt(0)
    v_mfma_f32_16x16x32_bf16 a[0:3], v[64:67], v[32:35], a[0:3]
    ds_read_b128 v[48:51], v3 offset:16384
    ds_read_b64_tr_b16 v[80:81], v12 offset:16384
    v_and_or_b32 v186, v186, s78, v98
    v_and_or_b32 v187, v187, s78, v99
    v_mfma_f32_16x16x32_bf16 a[4:7], v[64:67], v[36:39], a[4:7]
    ds_read_b64_tr_b16 v[82:83], v12 offset:20480
    ds_read_b128 v[52:55], v3 offset:17408
    buffer_store_dwordx4 v[184:187], v113, s[12:15], s76 offen offset:2048 sc1
    v_accvgpr_read_b32 v188, a28
    v_mfma_f32_16x16x32_bf16 a[16:19], v[68:71], v[32:35], a[16:19]
    ds_read_b64_tr_b16 v[84:85], v13 offset:16384
    v_accvgpr_read_b32 v189, a29
    v_accvgpr_read_b32 v190, a30
    v_mfma_f32_16x16x32_bf16 a[20:23], v[68:71], v[36:39], a[20:23]
    ds_read_b64_tr_b16 v[86:87], v13 offset:20480
    ds_read_b64_tr_b16 v[88:89], v14 offset:16384
    v_accvgpr_read_b32 v191, a31
    v_and_or_b32 v188, v188, s78, v96
    v_mfma_f32_16x16x32_bf16 a[32:35], v[72:75], v[32:35], a[32:35]
    ds_read_b64_tr_b16 v[90:91], v14 offset:20480
    ds_read_b64_tr_b16 v[92:93], v15 offset:16384
    v_and_or_b32 v189, v189, s78, v97
    v_and_or_b32 v190, v190, s78, v98
    v_mfma_f32_16x16x32_bf16 a[36:39], v[72:75], v[36:39], a[36:39]
    ds_read_b64_tr_b16 v[94:95], v15 offset:20480
    v_and_or_b32 v191, v191, s78, v99
    buffer_store_dwordx4 v[188:191], v113, s[12:15], s76 offen offset:3072 sc1
    v_mfma_f32_16x16x32_bf16 a[48:51], v[76:79], v[32:35], a[48:51]
    v_accvgpr_read_b32 v192, a40
    v_accvgpr_read_b32 v193, a41
    v_mfma_f32_16x16x32_bf16 a[52:55], v[76:79], v[36:39], a[52:55]
    v_accvgpr_read_b32 v194, a42
    v_accvgpr_read_b32 v195, a43
    s_waitcnt lgkmcnt(0)
    v_mfma_f32_16x16x32_bf16 a[0:3], v[80:83], v[48:51], a[0:3]
    ds_read_b128 v[32:35], v3 offset:32768
    ds_read_b64_tr_b16 v[64:65], v12 offset:32768
    v_and_or_b32 v192, v192, s78, v96
    v_and_or_b32 v193, v193, s78, v97
    v_mfma_f32_16x16x32_bf16 a[4:7], v[80:83], v[52:55], a[4:7]
    ds_read_b64_tr_b16 v[66:67], v12 offset:36864
    ds_read_b128 v[36:39], v3 offset:33792
    v_and_or_b32 v194, v194, s78, v98
    v_and_or_b32 v195, v195, s78, v99
    v_mfma_f32_16x16x32_bf16 a[16:19], v[84:87], v[48:51], a[16:19]
    ds_read_b64_tr_b16 v[68:69], v13 offset:32768
    buffer_store_dwordx4 v[192:195], v113, s[12:15], s77 offen offset:0 sc1
    v_accvgpr_read_b32 v196, a44
    v_mfma_f32_16x16x32_bf16 a[20:23], v[84:87], v[52:55], a[20:23]
    ds_read_b64_tr_b16 v[70:71], v13 offset:36864
    ds_read_b64_tr_b16 v[72:73], v14 offset:32768
    v_accvgpr_read_b32 v197, a45
    v_accvgpr_read_b32 v198, a46
    v_mfma_f32_16x16x32_bf16 a[32:35], v[88:91], v[48:51], a[32:35]
    ds_read_b64_tr_b16 v[74:75], v14 offset:36864
    ds_read_b64_tr_b16 v[76:77], v15 offset:32768
    v_accvgpr_read_b32 v199, a47
    v_and_or_b32 v196, v196, s78, v96
    v_mfma_f32_16x16x32_bf16 a[36:39], v[88:91], v[52:55], a[36:39]
    ds_read_b64_tr_b16 v[78:79], v15 offset:36864
    v_and_or_b32 v197, v197, s78, v97
    v_and_or_b32 v198, v198, s78, v98
    v_mfma_f32_16x16x32_bf16 a[48:51], v[92:95], v[48:51], a[48:51]
    v_and_or_b32 v199, v199, s78, v99
    buffer_store_dwordx4 v[196:199], v113, s[12:15], s77 offen offset:1024 sc1
    v_mfma_f32_16x16x32_bf16 a[52:55], v[92:95], v[52:55], a[52:55]
    v_accvgpr_read_b32 v200, a56
    v_accvgpr_read_b32 v201, a57
    s_waitcnt lgkmcnt(0)
    v_mfma_f32_16x16x32_bf16 a[0:3], v[64:67], v[32:35], a[0:3]
    v_accvgpr_read_b32 v202, a58
    v_accvgpr_read_b32 v203, a59
    v_mfma_f32_16x16x32_bf16 a[4:7], v[64:67], v[36:39], a[4:7]
    v_and_or_b32 v200, v200, s78, v96
    v_and_or_b32 v201, v201, s78, v97
    v_mfma_f32_16x16x32_bf16 a[16:19], v[68:71], v[32:35], a[16:19]
    v_and_or_b32 v202, v202, s78, v98
    v_and_or_b32 v203, v203, s78, v99
    v_mfma_f32_16x16x32_bf16 a[20:23], v[68:71], v[36:39], a[20:23]
    buffer_store_dwordx4 v[200:203], v113, s[12:15], s77 offen offset:2048 sc1
    v_accvgpr_read_b32 v204, a60
    v_mfma_f32_16x16x32_bf16 a[32:35], v[72:75], v[32:35], a[32:35]
    v_accvgpr_read_b32 v205, a61
    v_accvgpr_read_b32 v206, a62
    v_mfma_f32_16x16x32_bf16 a[36:39], v[72:75], v[36:39], a[36:39]
    v_accvgpr_read_b32 v207, a63
    v_and_or_b32 v204, v204, s78, v96
    v_mfma_f32_16x16x32_bf16 a[48:51], v[76:79], v[32:35], a[48:51]
    v_and_or_b32 v205, v205, s78, v97
    v_and_or_b32 v206, v206, s78, v98
    v_mfma_f32_16x16x32_bf16 a[52:55], v[76:79], v[36:39], a[52:55]
    v_and_or_b32 v207, v207, s78, v99
    buffer_store_dwordx4 v[204:207], v113, s[12:15], s77 offen offset:3072 sc1
    s_lshl_b32 s76, s64, 4
    s_add_u32 s76, s76, s65
    s_lshl_b32 s76, s76, 2
    s_add_u32 s76, s76, s66
    s_lshl_b32 s82, s76, 13
    s_add_u32 s82, s82, 25165824
    s_add_u32 s83, s82, 4096
    s_mov_b32 s84, 0x0c0c0400
    s_mov_b32 s85, 0x04000c0c
    s_waitcnt vmcnt(8)
    v_lshlrev_b32 v192, 16, v160
    v_and_b32 v193, 0xffff0000, v160
    v_lshlrev_b32 v194, 16, v161
    v_and_b32 v195, 0xffff0000, v161
    v_lshlrev_b32 v196, 16, v162
    v_and_b32 v197, 0xffff0000, v162
    v_lshlrev_b32 v198, 16, v163
    v_and_b32 v199, 0xffff0000, v163
    v_lshlrev_b32 v200, 16, v164
    v_and_b32 v201, 0xffff0000, v164
    v_lshlrev_b32 v202, 16, v165
    v_and_b32 v203, 0xffff0000, v165
    v_lshlrev_b32 v204, 16, v166
    v_and_b32 v205, 0xffff0000, v166
    v_lshlrev_b32 v206, 16, v167
    v_and_b32 v207, 0xffff0000, v167
    buffer_load_dwordx4 v[32:35], v113, s[12:15], s82 offen offset:0 sc1
    buffer_load_dwordx4 v[36:39], v113, s[12:15], s82 offen offset:1024 sc1
    buffer_load_dwordx4 v[40:43], v113, s[12:15], s82 offen offset:2048 sc1
    buffer_load_dwordx4 v[44:47], v113, s[12:15], s82 offen offset:3072 sc1
    buffer_load_dwordx4 v[48:51], v113, s[12:15], s83 offen offset:0 sc1
    buffer_load_dwordx4 v[52:55], v113, s[12:15], s83 offen offset:1024 sc1
    buffer_load_dwordx4 v[56:59], v113, s[12:15], s83 offen offset:2048 sc1
    buffer_load_dwordx4 v[60:63], v113, s[12:15], s83 offen offset:3072 sc1
    v_lshlrev_b32 v240, 16, v128
    v_and_b32 v241, 0xffff0000, v128
    v_lshlrev_b32 v242, 16, v129
    v_and_b32 v243, 0xffff0000, v129
    v_lshlrev_b32 v244, 16, v144
    v_and_b32 v245, 0xffff0000, v144
    v_lshlrev_b32 v246, 16, v145
    v_and_b32 v247, 0xffff0000, v145
    v_pk_add_f32 v[248:249], v[240:241], v[168:169] op_sel_hi:[1,0] neg_lo:[0,1] neg_hi:[0,1]
    v_pk_add_f32 v[250:251], v[242:243], v[168:169] op_sel_hi:[1,0] neg_lo:[0,1] neg_hi:[0,1]
    v_accvgpr_read_b32 v252, a0
    v_accvgpr_read_b32 v253, a1
    v_accvgpr_read_b32 v254, a2
    v_accvgpr_read_b32 v255, a3
    v_pk_mul_f32 v[248:249], v[248:249], v[168:169] op_sel:[0,1] op_sel_hi:[1,1]
    v_pk_mul_f32 v[250:251], v[250:251], v[168:169] op_sel:[0,1] op_sel_hi:[1,1]
    v_pk_fma_f32 v[208:209], v[248:249], v[244:245], v[240:241]
    v_pk_fma_f32 v[210:211], v[250:251], v[246:247], v[242:243]
    v_pk_add_f32 v[208:209], v[208:209], v[192:193]
    v_pk_add_f32 v[210:211], v[210:211], v[194:195]
    v_pk_add_f32 v[208:209], v[208:209], v[252:253]
    v_pk_add_f32 v[210:211], v[210:211], v[254:255]
    v_lshlrev_b32 v240, 16, v130
    v_and_b32 v241, 0xffff0000, v130
    v_lshlrev_b32 v242, 16, v131
    v_and_b32 v243, 0xffff0000, v131
    v_lshlrev_b32 v244, 16, v146
    v_and_b32 v245, 0xffff0000, v146
    v_lshlrev_b32 v246, 16, v147
    v_and_b32 v247, 0xffff0000, v147
    v_pk_add_f32 v[248:249], v[240:241], v[170:171] op_sel_hi:[1,0] neg_lo:[0,1] neg_hi:[0,1]
    v_pk_add_f32 v[250:251], v[242:243], v[170:171] op_sel_hi:[1,0] neg_lo:[0,1] neg_hi:[0,1]
    v_accvgpr_read_b32 v252, a4
    v_accvgpr_read_b32 v253, a5
    v_accvgpr_read_b32 v254, a6
    v_accvgpr_read_b32 v255, a7
    v_pk_mul_f32 v[248:249], v[248:249], v[170:171] op_sel:[0,1] op_sel_hi:[1,1]
    v_pk_mul_f32 v[250:251], v[250:251], v[170:171] op_sel:[0,1] op_sel_hi:[1,1]
    v_pk_fma_f32 v[212:213], v[248:249], v[244:245], v[240:241]
    v_pk_fma_f32 v[214:215], v[250:251], v[246:247], v[242:243]
    v_pk_add_f32 v[212:213], v[212:213], v[192:193]
    v_pk_add_f32 v[214:215], v[214:215], v[194:195]
    v_pk_add_f32 v[212:213], v[212:213], v[252:253]
    v_pk_add_f32 v[214:215], v[214:215], v[254:255]
    v_lshlrev_b32 v240, 16, v132
    v_and_b32 v241, 0xffff0000, v132
    v_lshlrev_b32 v242, 16, v133
    v_and_b32 v243, 0xffff0000, v133
    v_lshlrev_b32 v244, 16, v148
    v_and_b32 v245, 0xffff0000, v148
    v_lshlrev_b32 v246, 16, v149
    v_and_b32 v247, 0xffff0000, v149
    v_pk_add_f32 v[248:249], v[240:241], v[168:169] op_sel_hi:[1,0] neg_lo:[0,1] neg_hi:[0,1]
    v_pk_add_f32 v[250:251], v[242:243], v[168:169] op_sel_hi:[1,0] neg_lo:[0,1] neg_hi:[0,1]
    v_accvgpr_read_b32 v252, a16
    v_accvgpr_read_b32 v253, a17
    v_accvgpr_read_b32 v254, a18
    v_accvgpr_read_b32 v255, a19
    v_pk_mul_f32 v[248:249], v[248:249], v[168:169] op_sel:[0,1] op_sel_hi:[1,1]
    v_pk_mul_f32 v[250:251], v[250:251], v[168:169] op_sel:[0,1] op_sel_hi:[1,1]
    v_pk_fma_f32 v[216:217], v[248:249], v[244:245], v[240:241]
    v_pk_fma_f32 v[218:219], v[250:251], v[246:247], v[242:243]
    v_pk_add_f32 v[216:217], v[216:217], v[196:197]
    v_pk_add_f32 v[218:219], v[218:219], v[198:199]
    v_pk_add_f32 v[216:217], v[216:217], v[252:253]
    v_pk_add_f32 v[218:219], v[218:219], v[254:255]
    v_lshlrev_b32 v240, 16, v134
    v_and_b32 v241, 0xffff0000, v134
    v_lshlrev_b32 v242, 16, v135
    v_and_b32 v243, 0xffff0000, v135
    v_lshlrev_b32 v244, 16, v150
    v_and_b32 v245, 0xffff0000, v150
    v_lshlrev_b32 v246, 16, v151
    v_and_b32 v247, 0xffff0000, v151
    v_pk_add_f32 v[248:249], v[240:241], v[170:171] op_sel_hi:[1,0] neg_lo:[0,1] neg_hi:[0,1]
    v_pk_add_f32 v[250:251], v[242:243], v[170:171] op_sel_hi:[1,0] neg_lo:[0,1] neg_hi:[0,1]
    v_accvgpr_read_b32 v252, a20
    v_accvgpr_read_b32 v253, a21
    v_accvgpr_read_b32 v254, a22
    v_accvgpr_read_b32 v255, a23
    v_pk_mul_f32 v[248:249], v[248:249], v[170:171] op_sel:[0,1] op_sel_hi:[1,1]
    v_pk_mul_f32 v[250:251], v[250:251], v[170:171] op_sel:[0,1] op_sel_hi:[1,1]
    v_pk_fma_f32 v[220:221], v[248:249], v[244:245], v[240:241]
    v_pk_fma_f32 v[222:223], v[250:251], v[246:247], v[242:243]
    v_pk_add_f32 v[220:221], v[220:221], v[196:197]
    v_pk_add_f32 v[222:223], v[222:223], v[198:199]
    v_pk_add_f32 v[220:221], v[220:221], v[252:253]
    v_pk_add_f32 v[222:223], v[222:223], v[254:255]
    v_lshlrev_b32 v240, 16, v136
    v_and_b32 v241, 0xffff0000, v136
    v_lshlrev_b32 v242, 16, v137
    v_and_b32 v243, 0xffff0000, v137
    v_lshlrev_b32 v244, 16, v152
    v_and_b32 v245, 0xffff0000, v152
    v_lshlrev_b32 v246, 16, v153
    v_and_b32 v247, 0xffff0000, v153
    v_pk_add_f32 v[248:249], v[240:241], v[168:169] op_sel_hi:[1,0] neg_lo:[0,1] neg_hi:[0,1]
    v_pk_add_f32 v[250:251], v[242:243], v[168:169] op_sel_hi:[1,0] neg_lo:[0,1] neg_hi:[0,1]
    v_accvgpr_read_b32 v252, a32
    v_accvgpr_read_b32 v253, a33
    v_accvgpr_read_b32 v254, a34
    v_accvgpr_read_b32 v255, a35
    v_pk_mul_f32 v[248:249], v[248:249], v[168:169] op_sel:[0,1] op_sel_hi:[1,1]
    v_pk_mul_f32 v[250:251], v[250:251], v[168:169] op_sel:[0,1] op_sel_hi:[1,1]
    v_pk_fma_f32 v[224:225], v[248:249], v[244:245], v[240:241]
    v_pk_fma_f32 v[226:227], v[250:251], v[246:247], v[242:243]
    v_pk_add_f32 v[224:225], v[224:225], v[200:201]
    v_pk_add_f32 v[226:227], v[226:227], v[202:203]
    v_pk_add_f32 v[224:225], v[224:225], v[252:253]
    v_pk_add_f32 v[226:227], v[226:227], v[254:255]
    v_lshlrev_b32 v240, 16, v138
    v_and_b32 v241, 0xffff0000, v138
    v_lshlrev_b32 v242, 16, v139
    v_and_b32 v243, 0xffff0000, v139
    v_lshlrev_b32 v244, 16, v154
    v_and_b32 v245, 0xffff0000, v154
    v_lshlrev_b32 v246, 16, v155
    v_and_b32 v247, 0xffff0000, v155
    v_pk_add_f32 v[248:249], v[240:241], v[170:171] op_sel_hi:[1,0] neg_lo:[0,1] neg_hi:[0,1]
    v_pk_add_f32 v[250:251], v[242:243], v[170:171] op_sel_hi:[1,0] neg_lo:[0,1] neg_hi:[0,1]
    v_accvgpr_read_b32 v252, a36
    v_accvgpr_read_b32 v253, a37
    v_accvgpr_read_b32 v254, a38
    v_accvgpr_read_b32 v255, a39
    v_pk_mul_f32 v[248:249], v[248:249], v[170:171] op_sel:[0,1] op_sel_hi:[1,1]
    v_pk_mul_f32 v[250:251], v[250:251], v[170:171] op_sel:[0,1] op_sel_hi:[1,1]
    v_pk_fma_f32 v[228:229], v[248:249], v[244:245], v[240:241]
    v_pk_fma_f32 v[230:231], v[250:251], v[246:247], v[242:243]
    v_pk_add_f32 v[228:229], v[228:229], v[200:201]
    v_pk_add_f32 v[230:231], v[230:231], v[202:203]
    v_pk_add_f32 v[228:229], v[228:229], v[252:253]
    v_pk_add_f32 v[230:231], v[230:231], v[254:255]
    v_lshlrev_b32 v240, 16, v140
    v_and_b32 v241, 0xffff0000, v140
    v_lshlrev_b32 v242, 16, v141
    v_and_b32 v243, 0xffff0000, v141
    v_lshlrev_b32 v244, 16, v156
    v_and_b32 v245, 0xffff0000, v156
    v_lshlrev_b32 v246, 16, v157
    v_and_b32 v247, 0xffff0000, v157
    v_pk_add_f32 v[248:249], v[240:241], v[168:169] op_sel_hi:[1,0] neg_lo:[0,1] neg_hi:[0,1]
    v_pk_add_f32 v[250:251], v[242:243], v[168:169] op_sel_hi:[1,0] neg_lo:[0,1] neg_hi:[0,1]
    v_accvgpr_read_b32 v252, a48
    v_accvgpr_read_b32 v253, a49
    v_accvgpr_read_b32 v254, a50
    v_accvgpr_read_b32 v255, a51
    v_pk_mul_f32 v[248:249], v[248:249], v[168:169] op_sel:[0,1] op_sel_hi:[1,1]
    v_pk_mul_f32 v[250:251], v[250:251], v[168:169] op_sel:[0,1] op_sel_hi:[1,1]
    v_pk_fma_f32 v[232:233], v[248:249], v[244:245], v[240:241]
    v_pk_fma_f32 v[234:235], v[250:251], v[246:247], v[242:243]
    v_pk_add_f32 v[232:233], v[232:233], v[204:205]
    v_pk_add_f32 v[234:235], v[234:235], v[206:207]
    v_pk_add_f32 v[232:233], v[232:233], v[252:253]
    v_pk_add_f32 v[234:235], v[234:235], v[254:255]
    v_lshlrev_b32 v240, 16, v142
    v_and_b32 v241, 0xffff0000, v142
    v_lshlrev_b32 v242, 16, v143
    v_and_b32 v243, 0xffff0000, v143
    v_lshlrev_b32 v244, 16, v158
    v_and_b32 v245, 0xffff0000, v158
    v_lshlrev_b32 v246, 16, v159
    v_and_b32 v247, 0xffff0000, v159
    v_pk_add_f32 v[248:249], v[240:241], v[170:171] op_sel_hi:[1,0] neg_lo:[0,1] neg_hi:[0,1]
    v_pk_add_f32 v[250:251], v[242:243], v[170:171] op_sel_hi:[1,0] neg_lo:[0,1] neg_hi:[0,1]
    v_accvgpr_read_b32 v252, a52
    v_accvgpr_read_b32 v253, a53
    v_accvgpr_read_b32 v254, a54
    v_accvgpr_read_b32 v255, a55
    v_pk_mul_f32 v[248:249], v[248:249], v[170:171] op_sel:[0,1] op_sel_hi:[1,1]
    v_pk_mul_f32 v[250:251], v[250:251], v[170:171] op_sel:[0,1] op_sel_hi:[1,1]
    v_pk_fma_f32 v[236:237], v[248:249], v[244:245], v[240:241]
    v_pk_fma_f32 v[238:239], v[250:251], v[246:247], v[242:243]
    v_pk_add_f32 v[236:237], v[236:237], v[204:205]
    v_pk_add_f32 v[238:239], v[238:239], v[206:207]
    v_pk_add_f32 v[236:237], v[236:237], v[252:253]
    v_pk_add_f32 v[238:239], v[238:239], v[254:255]
    s_mov_b32 s80, 0
    s_waitcnt vmcnt(0)
    s_branch L_xchk
L_xspin:
    buffer_load_dwordx4 v[32:35], v113, s[12:15], s82 offen offset:0 sc1
    buffer_load_dwordx4 v[36:39], v113, s[12:15], s82 offen offset:1024 sc1
    buffer_load_dwordx4 v[40:43], v113, s[12:15], s82 offen offset:2048 sc1
    buffer_load_dwordx4 v[44:47], v113, s[12:15], s82 offen offset:3072 sc1
    buffer_load_dwordx4 v[48:51], v113, s[12:15], s83 offen offset:0 sc1
    buffer_load_dwordx4 v[52:55], v113, s[12:15], s83 offen offset:1024 sc1
    buffer_load_dwordx4 v[56:59], v113, s[12:15], s83 offen offset:2048 sc1
    buffer_load_dwordx4 v[60:63], v113, s[12:15], s83 offen offset:3072 sc1
    s_waitcnt vmcnt(0)
L_xchk:
    v_perm_b32 v100, v33, v32, s84
    v_perm_b32 v101, v35, v34, s85
    v_or_b32 v100, v100, v101
    v_xor_b32 v100, s88, v100
    v_mov_b32 v102, v100
    v_perm_b32 v100, v37, v36, s84
    v_perm_b32 v101, v39, v38, s85
    v_or_b32 v100, v100, v101
    v_xor_b32 v100, s88, v100
    v_or_b32 v102, v102, v100
    v_perm_b32 v100, v41, v40, s84
    v_perm_b32 v101, v43, v42, s85
    v_or_b32 v100, v100, v101
    v_xor_b32 v100, s88, v100
    v_or_b32 v102, v102, v100
    v_perm_b32 v100, v45, v44, s84
    v_perm_b32 v101, v47, v46, s85
    v_or_b32 v100, v100, v101
    v_xor_b32 v100, s88, v100
    v_or_b32 v102, v102, v100
    v_perm_b32 v100, v49, v48, s84
    v_perm_b32 v101, v51, v50, s85
    v_or_b32 v100, v100, v101
    v_xor_b32 v100, s88, v100
    v_or_b32 v102, v102, v100
    v_perm_b32 v100, v53, v52, s84
    v_perm_b32 v101, v55, v54, s85
    v_or_b32 v100, v100, v101
    v_xor_b32 v100, s88, v100
    v_or_b32 v102, v102, v100
    v_perm_b32 v100, v57, v56, s84
    v_perm_b32 v101, v59, v58, s85
    v_or_b32 v100, v100, v101
    v_xor_b32 v100, s88, v100
    v_or_b32 v102, v102, v100
    v_perm_b32 v100, v61, v60, s84
    v_perm_b32 v101, v63, v62, s85
    v_or_b32 v100, v100, v101
    v_xor_b32 v100, s88, v100
    v_or_b32 v102, v102, v100
    v_cmp_ne_u32 vcc, 0, v102
    s_add_u32 s80, s80, 1
    s_cmp_gt_u32 s80, 0x8000
    s_cbranch_scc1 L_xdone
    s_cbranch_vccnz L_xspin
L_xdone:
    v_and_b32 v32, 0xffffff00, v32
    v_and_b32 v33, 0xffffff00, v33
    v_and_b32 v34, 0xffffff00, v34
    v_and_b32 v35, 0xffffff00, v35
    v_pk_add_f32 v[208:209], v[208:209], v[32:33]
    v_pk_add_f32 v[210:211], v[210:211], v[34:35]
    v_cvt_pk_bf16_f32 v64, v208, v209
    v_cvt_pk_bf16_f32 v65, v210, v211
    buffer_store_dwordx2 v[64:65], v115, s[48:51], 0 offen offset:0
    v_and_b32 v36, 0xffffff00, v36
    v_and_b32 v37, 0xffffff00, v37
    v_and_b32 v38, 0xffffff00, v38
    v_and_b32 v39, 0xffffff00, v39
    v_pk_add_f32 v[212:213], v[212:213], v[36:37]
    v_pk_add_f32 v[214:215], v[214:215], v[38:39]
    v_cvt_pk_bf16_f32 v66, v212, v213
    v_cvt_pk_bf16_f32 v67, v214, v215
    buffer_store_dwordx2 v[66:67], v116, s[48:51], 0 offen offset:0
    v_and_b32 v40, 0xffffff00, v40
    v_and_b32 v41, 0xffffff00, v41
    v_and_b32 v42, 0xffffff00, v42
    v_and_b32 v43, 0xffffff00, v43
    v_pk_add_f32 v[216:217], v[216:217], v[40:41]
    v_pk_add_f32 v[218:219], v[218:219], v[42:43]
    v_cvt_pk_bf16_f32 v68, v216, v217
    v_cvt_pk_bf16_f32 v69, v218, v219
    buffer_store_dwordx2 v[68:69], v115, s[48:51], 0 offen offset:32
    v_and_b32 v44, 0xffffff00, v44
    v_and_b32 v45, 0xffffff00, v45
    v_and_b32 v46, 0xffffff00, v46
    v_and_b32 v47, 0xffffff00, v47
    v_pk_add_f32 v[220:221], v[220:221], v[44:45]
    v_pk_add_f32 v[222:223], v[222:223], v[46:47]
    v_cvt_pk_bf16_f32 v70, v220, v221
    v_cvt_pk_bf16_f32 v71, v222, v223
    buffer_store_dwordx2 v[70:71], v116, s[48:51], 0 offen offset:32
    v_and_b32 v48, 0xffffff00, v48
    v_and_b32 v49, 0xffffff00, v49
    v_and_b32 v50, 0xffffff00, v50
    v_and_b32 v51, 0xffffff00, v51
    v_pk_add_f32 v[224:225], v[224:225], v[48:49]
    v_pk_add_f32 v[226:227], v[226:227], v[50:51]
    v_cvt_pk_bf16_f32 v72, v224, v225
    v_cvt_pk_bf16_f32 v73, v226, v227
    buffer_store_dwordx2 v[72:73], v115, s[48:51], 0 offen offset:64
    v_and_b32 v52, 0xffffff00, v52
    v_and_b32 v53, 0xffffff00, v53
    v_and_b32 v54, 0xffffff00, v54
    v_and_b32 v55, 0xffffff00, v55
    v_pk_add_f32 v[228:229], v[228:229], v[52:53]
    v_pk_add_f32 v[230:231], v[230:231], v[54:55]
    v_cvt_pk_bf16_f32 v74, v228, v229
    v_cvt_pk_bf16_f32 v75, v230, v231
    buffer_store_dwordx2 v[74:75], v116, s[48:51], 0 offen offset:64
    v_and_b32 v56, 0xffffff00, v56
    v_and_b32 v57, 0xffffff00, v57
    v_and_b32 v58, 0xffffff00, v58
    v_and_b32 v59, 0xffffff00, v59
    v_pk_add_f32 v[232:233], v[232:233], v[56:57]
    v_pk_add_f32 v[234:235], v[234:235], v[58:59]
    v_cvt_pk_bf16_f32 v76, v232, v233
    v_cvt_pk_bf16_f32 v77, v234, v235
    buffer_store_dwordx2 v[76:77], v115, s[48:51], 0 offen offset:96
    v_and_b32 v60, 0xffffff00, v60
    v_and_b32 v61, 0xffffff00, v61
    v_and_b32 v62, 0xffffff00, v62
    v_and_b32 v63, 0xffffff00, v63
    v_pk_add_f32 v[236:237], v[236:237], v[60:61]
    v_pk_add_f32 v[238:239], v[238:239], v[62:63]
    v_cvt_pk_bf16_f32 v78, v236, v237
    v_cvt_pk_bf16_f32 v79, v238, v239
    buffer_store_dwordx2 v[78:79], v116, s[48:51], 0 offen offset:96
L_end:
    s_endpgm
.section .rodata,"a"
.p2align 6
.amdhsa_kernel parallel_sum__ssm_conv_h3__mixer_channel_mlp__prompt_kernel
  .amdhsa_next_free_vgpr 512
  .amdhsa_next_free_sgpr 102
  .amdhsa_accum_offset 256
  .amdhsa_group_segment_fixed_size 0
  .amdhsa_kernarg_size 112
  .amdhsa_user_sgpr_count 2
  .amdhsa_user_sgpr_kernarg_segment_ptr 1
  .amdhsa_system_sgpr_workgroup_id_x 1
.end_amdhsa_kernel
```
